```python
import torch

def _softmax(x, axis=-1):
    return torch.softmax(x, dim=axis)
def _gelu(x):
    return torch.nn.functional.gelu(x, approximate="tanh")
def _silu(x):
    return torch.nn.functional.silu(x)
def _sigmoid(x):
    return torch.sigmoid(x)
def _layernorm(x, axis=-1, eps=1e-5):
    m = x.mean(dim=axis, keepdim=True)
    v = x.var(dim=axis, keepdim=True, unbiased=False)
    return (x - m) / torch.sqrt(v + eps)
def _scatter_add(tgt, idx, src, axis=0):
    return tgt.clone().index_add_(axis, idx, src)
def _segment_sum(src, seg, n):
    out = torch.zeros((n,) + src.shape[1:], dtype=src.dtype)
    return out.index_add_(0, seg, src)
def _pad(x, pw):
    flat = tuple(v for pair in reversed(pw) for v in pair)
    return torch.nn.functional.pad(x, flat)

kernel_name = 'concat_heads__ssm_conv_h3__spectral_fnet__prompt'

def setup_inputs():

    _w = (lambda a: (lambda t: t.to(torch.bfloat16) if t.is_floating_point() else t)(torch.as_tensor(a)))
    def _A_setup():
        B, S, D = 1, 2048, 1024
        ks = 4
        return {
            "q": _w((lambda *s: torch.randn(*s, dtype=torch.bfloat16) * 0.05)(B, S, D)),
            "k": _w((lambda *s: torch.randn(*s, dtype=torch.bfloat16) * 3.2)(B, S, D)),
            "v": _w((lambda *s: torch.randn(*s, dtype=torch.bfloat16) * 3.2)(B, S, D)),
            "shift_k": _w((lambda *s: torch.randn(*s, dtype=torch.bfloat16) * 3.2)(D, ks) * 0.5),
            "ssm_k": _w((lambda *s: torch.randn(*s, dtype=torch.bfloat16) * 3.2)(D, S) * (1.0 / S ** 0.5)),
            "ssm_D": _w((lambda *s: torch.randn(*s, dtype=torch.bfloat16) * 3.2)(D)),
        }
    _A_in = _A_setup()

    def _B_setup():
        B, S, D = 1, 2048, 1024
        ns = torch.arange(S)[:, None] * torch.arange(S)[None, :]
        nd = torch.arange(D)[:, None] * torch.arange(D)[None, :]
        Ws_re = torch.cos(-2.0 * torch.pi * ns / S).to(float)
        Ws_im = torch.sin(-2.0 * torch.pi * ns / S).to(float)
        Wd_re = torch.cos(-2.0 * torch.pi * nd / D).to(float)
        Wd_im = torch.sin(-2.0 * torch.pi * nd / D).to(float)
        return {
            "x": _w((lambda *s: torch.randn(*s, dtype=torch.bfloat16) * 0.05)(B, S, D)),
            "dft_seq_re": _w(Ws_re),
            "dft_seq_im": _w(Ws_im),
            "dft_hid_re": _w(Wd_re),
            "dft_hid_im": _w(Wd_im),
        }
    _B_in = _B_setup()

    return {
        "A_q": _A_in["q"],
        "A_k": _A_in["k"],
        "A_v": _A_in["v"],
        "A_shift_k": _A_in["shift_k"],
        "A_ssm_k": _A_in["ssm_k"],
        "A_ssm_D": _A_in["ssm_D"],
        "B_x": _B_in["x"],
        "B_dft_seq_re": _B_in["dft_seq_re"],
        "B_dft_seq_im": _B_in["dft_seq_im"],
        "B_dft_hid_re": _B_in["dft_hid_re"],
        "B_dft_hid_im": _B_in["dft_hid_im"],
    }

def reference(A_q, A_k, A_v, A_shift_k, A_ssm_k, A_ssm_D, B_x, B_dft_seq_re, B_dft_seq_im, B_dft_hid_re, B_dft_hid_im):
    def _A_ref(q, k, v, shift_k, ssm_k, ssm_D):
        B, S, D = q.shape
        ks = shift_k.shape[-1]
        k_pad = _pad(k, ((0, 0), (ks - 1, 0), (0, 0)))
        k_shift = torch.zeros_like(k)
        for t in range(ks):
            k_shift = k_shift + k_pad[:, t:t + S, :] * shift_k[:, ks - 1 - t][None, None, :]
        kv = k_shift * v
        L = 2 * S
        kv_pad = _pad(kv, ((0, 0), (0, S), (0, 0)))
        kf_pad = _pad(ssm_k, ((0, 0), (0, S)))
        kv_f = (lambda x, axes=(-2,-1): torch.fft.rfft2(x.float(), dim=axes))(kv_pad[:, None, :, :], axes=(1, 2))
        kf_f = (lambda x, axes=(-2,-1): torch.fft.rfft2(x.float(), dim=axes))(kf_pad[:, None, :], axes=(1, 2))
        kf_f = (lambda x, *d: x.permute(*d))(kf_f, 1, 2, 0)
        y_f = kv_f * kf_f[None, :, :, :]
        y = (lambda x, s, axes=(-2,-1): torch.fft.irfft2(x, s=s, dim=axes).to(torch.bfloat16))(y_f, (1, L), axes=(1, 2))[:, 0, :S, :]
        y = y + kv * ssm_D[None, None, :]
        return q * y

    def _B_ref(x, dft_seq_re, dft_seq_im, dft_hid_re, dft_hid_im):
        a = torch.einsum("bsd,ed->bse", x, dft_hid_re)
        b = torch.einsum("bsd,ed->bse", x, dft_hid_im)
        y = torch.einsum("ts,bse->bte", dft_seq_re, a) - torch.einsum("ts,bse->bte", dft_seq_im, b)
        return y

    a = _A_ref(A_q, A_k, A_v, A_shift_k, A_ssm_k, A_ssm_D)
    b = _B_ref(B_x, B_dft_seq_re, B_dft_seq_im, B_dft_hid_re, B_dft_hid_im)
    return torch.concatenate([a, b], axis=-1)
```

```asm
; @launch grid=(256,1,1) block=(256,1,1) lds=150592
.amdgcn_target "amdgcn-amd-amdhsa--gfx950"
.text
.globl concat_heads__ssm_conv_h3__spectral_fnet__prompt_kernel
.p2align 8
.type concat_heads__ssm_conv_h3__spectral_fnet__prompt_kernel,@function
concat_heads__ssm_conv_h3__spectral_fnet__prompt_kernel:
s_cmp_ge_u32 s2, 256
s_cbranch_scc1 L_end
s_load_dwordx16 s[4:19], s[0:1], 0
s_load_dwordx2 s[20:21], s[0:1], 88
s_load_dwordx2 s[22:23], s[0:1], 104
v_lshrrev_b32 v1, 6, v0
v_and_b32 v0, 63, v0
s_getpc_b64 s[70:71]
L_pc0:
v_readfirstlane_b32 s26, v1
v_lshlrev_b32 v236, 4, v0
s_lshr_b32 s65, s2, 3
s_lshl_b32 s65, s65, 2
s_add_u32 s65, s65, s26
s_and_b32 s65, s65, 31
s_lshl_b32 s65, s65, 10
s_min_u32 s65, s65, L_code_end-L_pc0-1024
s_add_u32 s70, s70, s65
s_addc_u32 s71, s71, 0
global_load_dwordx4 v[228:231], v236, s[70:71]
s_getpc_b64 s[74:75]
s_add_u32 s74, s74, L_tables-.
s_addc_u32 s75, s75, 0
s_mov_b32 s60, s74
s_mov_b32 s61, s75
s_mov_b32 s62, 57344
s_mov_b32 s63, 0x20000
s_getreg_b32 s30, hwreg(HW_REG_XCC_ID, 0, 4)
s_and_b32 s24, s2, 7
s_lshr_b32 s25, s2, 3
s_lshr_b32 s64, s25, 4
s_lshl_b32 s35, s24, 3
s_lshr_b32 s65, s25, 2
s_add_u32 s35, s35, s65
s_and_b32 s3, s25, 3
s_lshl_b32 s24, s24, 1
s_add_u32 s24, s24, s64
s_and_b32 s25, s25, 15
s_lshl_b32 s31, s2, 2
s_add_u32 s31, s31, s26
s_sub_u32 s32, 2048, s31
s_cmp_eq_u32 s31, 0
s_cselect_b32 s32, 1024, s32
v_and_b32 v2, 7, v0
v_lshrrev_b32 v3, 3, v0
s_lshl_b32 s64, s25, 7
s_lshl_b32 s65, s26, 5
s_add_u32 s64, s64, s65
v_lshl_add_u32 v4, v3, 2, s64
s_lshl_b32 s65, s24, 7
v_lshl_add_u32 v5, v2, 4, s65
v_lshl_add_u32 v234, v4, 11, v5
v_add_u32 v7, 0xffffe800, v234
v_add_u32 v8, 0xfffff000, v234
v_add_u32 v9, 0xfffff800, v234
s_lshl_b32 s65, s24, 18
v_lshl_add_u32 v11, v3, 15, s65
v_lshl_add_u32 v12, v2, 2, s64
v_lshlrev_b32 v12, 1, v12
v_add_u32 v232, v11, v12
v_sub_u32 v225, v11, v12
v_add_u32 v225, 4088, v225
v_lshlrev_b32 v239, 5, v2
v_lshl_or_b32 v239, v3, 2, v239
v_lshl_add_u32 v233, v4, 12, v5
v_and_b32 v2, 15, v0
v_lshrrev_b32 v3, 4, v0
s_waitcnt lgkmcnt(0)
s_mov_b32 s44, s10
s_mov_b32 s45, s11
s_mov_b32 s46, 8192
s_mov_b32 s47, 0x20000
v_lshlrev_b32 v10, 3, v0
s_lshl_b32 s65, s24, 9
buffer_load_dwordx2 v[92:93], v10, s[44:47], s65 offen
s_mov_b32 s36, s6
s_mov_b32 s37, s7
s_mov_b32 s38, 4194304
s_mov_b32 s39, 0x20000
s_mov_b32 s40, s8
s_mov_b32 s41, s9
s_mov_b32 s42, 4194304
s_mov_b32 s43, 0x20000
s_movk_i32 s68, 0x1000
buffer_load_dwordx4 v[16:19], v7, s[36:39], 0 offen nt
buffer_load_dwordx4 v[20:23], v8, s[36:39], 0 offen nt
buffer_load_dwordx4 v[24:27], v9, s[36:39], 0 offen nt
buffer_load_dwordx4 v[28:31], v234, s[36:39], 0 offen offset:0 nt
buffer_load_dwordx4 v[32:35], v234, s[36:39], 0 offen offset:2048 nt
buffer_load_dwordx4 v[36:39], v234, s[36:39], s68 offen offset:0 nt
buffer_load_dwordx4 v[40:43], v234, s[36:39], s68 offen offset:2048 nt
buffer_load_dwordx4 v[44:47], v234, s[40:43], 0 offen offset:0 nt
buffer_load_dwordx4 v[48:51], v234, s[40:43], 0 offen offset:2048 nt
buffer_load_dwordx4 v[52:55], v234, s[40:43], s68 offen offset:0 nt
buffer_load_dwordx4 v[56:59], v234, s[40:43], s68 offen offset:2048 nt
s_lshl_b32 s29, s24, 6
s_lshl_b32 s65, s25, 2
s_add_u32 s29, s29, s65
s_add_u32 s29, s29, s26
s_add_u32 s72, s22, 12582912
s_addc_u32 s73, s23, 0
s_load_dword s27, s[72:73], 0
s_lshl_b32 s65, s29, 1
s_and_b32 s65, s65, 0xfffffffc
s_load_dword s34, s[14:15], s65
s_mov_b32 s52, s16
s_mov_b32 s53, s17
s_mov_b32 s54, 4194304
s_mov_b32 s55, 0x20000
s_lshl_b32 s66, s31, 11
s_lshl_b32 s67, s32, 11
buffer_load_dwordx4 v[76:79], v236, s[52:55], s66 offen offset:0 nt
buffer_load_dwordx4 v[80:83], v236, s[52:55], s66 offen offset:1024 nt
buffer_load_dwordx4 v[84:87], v236, s[52:55], s67 offen offset:0 nt
buffer_load_dwordx4 v[88:91], v236, s[52:55], s67 offen offset:1024 nt
s_mov_b32 s56, s72
s_mov_b32 s57, s73
s_mov_b32 s58, 32768
s_mov_b32 s59, 0x20000
s_lshl_b32 s65, s24, 8
v_lshl_add_u32 v235, v0, 2, s65
s_movk_i32 s66, 8192
buffer_load_dword v237, v235, s[56:59], s66 offen sc1
s_movk_i32 s66, 12288
buffer_load_dword v238, v235, s[56:59], s66 offen sc1
s_mul_i32 s33, s26, 17664
s_mov_b32 s48, s22
s_mov_b32 s49, s23
s_mov_b32 s50, 4194304
s_mov_b32 s51, 0x20000
s_lshl_b32 s65, s24, 18
s_lshl_b32 s66, s25, 8
s_sub_u32 s65, s65, s66
s_and_b32 s66, s26, 1
s_lshl_b32 s66, s66, 7
s_add_u32 s65, s65, s66
s_add_u32 s65, s65, 3840
s_lshr_b32 s66, s26, 1
s_lshl_b32 s66, s66, 17
s_add_u32 s65, s65, s66
v_lshl_add_u32 v226, v0, 12, s65
v_cmp_gt_u32 vcc, 32, v0
v_mov_b32 v9, 0x7ffffff0
s_nop 0
v_cndmask_b32 v226, v9, v226, vcc
v_mov_b32 v9, 150528
v_mov_b32 v10, 0
ds_write_b32 v9, v10
ds_write_b32 v9, v10 offset:4
s_waitcnt lgkmcnt(0)
s_add_u32 s27, s27, 1
s_cmp_lg_u32 s26, 0
s_cbranch_scc1 Lnp_1
s_lshl_b32 s64, s24, 7
s_lshl_b32 s65, s25, 3
s_add_u32 s64, s64, s65
s_add_u32 s64, s64, 4096
v_mov_b32 v13, s64
v_mov_b32 v14, s27
v_mov_b32 v15, s30
s_mov_b64 exec, 1
buffer_store_dwordx2 v[14:15], v13, s[56:59], 0 offen sc1
s_mov_b64 exec, -1
Lnp_1:
s_and_b32 s64, s29, 1
s_lshl_b32 s65, s34, 16
s_and_b32 s34, s34, 0xffff0000
s_cmp_eq_u32 s64, 0
s_cselect_b32 s34, s65, s34
v_add_u32 v5, 95232, v236
s_cmp_eq_u32 s31, 0
s_cselect_b32 s64, 2, 1
s_lshl_b32 s64, s64, 10
v_add_u32 v12, s64, v5
s_mul_i32 s65, s26, 6144
s_add_u32 s65, s65, 70656
v_lshrrev_b32 v6, 2, v0
v_mul_u32_u24 v6, 96, v6
v_and_b32 v8, 3, v0
v_lshl_add_u32 v6, v8, 4, v6
v_add_u32 v6, s65, v6
v_bfe_u32 v7, v0, 2, 2
v_lshl_add_u32 v7, v3, 2, v7
v_mul_u32_u24 v7, 96, v7
v_and_b32 v8, 3, v0
v_lshl_add_u32 v7, v8, 3, v7
v_add_u32 v7, s65, v7
s_waitcnt vmcnt(17)
v_and_b32 v10, 7, v0
v_lshlrev_b32 v10, 5, v10
ds_bpermute_b32 v60, v10, v92 offset:0
ds_bpermute_b32 v61, v10, v93 offset:0
ds_bpermute_b32 v62, v10, v92 offset:4
ds_bpermute_b32 v63, v10, v93 offset:4
ds_bpermute_b32 v64, v10, v92 offset:8
ds_bpermute_b32 v65, v10, v93 offset:8
ds_bpermute_b32 v66, v10, v92 offset:12
ds_bpermute_b32 v67, v10, v93 offset:12
ds_bpermute_b32 v68, v10, v92 offset:16
ds_bpermute_b32 v69, v10, v93 offset:16
ds_bpermute_b32 v70, v10, v92 offset:20
ds_bpermute_b32 v71, v10, v93 offset:20
ds_bpermute_b32 v72, v10, v92 offset:24
ds_bpermute_b32 v73, v10, v93 offset:24
ds_bpermute_b32 v74, v10, v92 offset:28
ds_bpermute_b32 v75, v10, v93 offset:28
s_waitcnt vmcnt(6) lgkmcnt(0)
s_lshl_b32 s64, s26, 10
s_add_u32 m0, s64, 95232
s_add_u32 s65, s64, 0
buffer_load_dwordx4 v236, s[60:63], s65 offen lds
s_add_u32 m0, s64, 99328
s_add_u32 s65, s64, 4096
buffer_load_dwordx4 v236, s[60:63], s65 offen lds
s_add_u32 m0, s64, 103424
s_add_u32 s65, s64, 8192
buffer_load_dwordx4 v236, s[60:63], s65 offen lds
s_add_u32 m0, s64, 107520
s_add_u32 s65, s64, 12288
buffer_load_dwordx4 v236, s[60:63], s65 offen lds
s_add_u32 m0, s64, 111616
s_add_u32 s65, s64, 16384
buffer_load_dwordx4 v236, s[60:63], s65 offen lds
v_lshlrev_b32 v112, 16, v16
v_and_b32 v113, 0xffff0000, v16
v_lshlrev_b32 v114, 16, v20
v_and_b32 v115, 0xffff0000, v20
v_lshlrev_b32 v116, 16, v24
v_and_b32 v117, 0xffff0000, v24
v_lshlrev_b32 v118, 16, v28
v_and_b32 v119, 0xffff0000, v28
v_lshlrev_b32 v120, 16, v32
v_and_b32 v121, 0xffff0000, v32
v_lshlrev_b32 v122, 16, v36
v_and_b32 v123, 0xffff0000, v36
v_lshlrev_b32 v124, 16, v40
v_and_b32 v125, 0xffff0000, v40
v_lshlrev_b32 v126, 16, v60
v_and_b32 v128, 0xffff0000, v60
v_lshlrev_b32 v130, 16, v61
v_and_b32 v132, 0xffff0000, v61
v_lshlrev_b32 v127, 16, v62
v_and_b32 v129, 0xffff0000, v62
v_lshlrev_b32 v131, 16, v63
v_and_b32 v133, 0xffff0000, v63
v_lshlrev_b32 v134, 16, v44
v_and_b32 v135, 0xffff0000, v44
v_lshlrev_b32 v136, 16, v48
v_and_b32 v137, 0xffff0000, v48
v_lshlrev_b32 v138, 16, v52
v_and_b32 v139, 0xffff0000, v52
v_lshlrev_b32 v140, 16, v56
v_and_b32 v141, 0xffff0000, v56
v_pk_mul_f32 v[142:143], v[132:133], v[112:113]
v_pk_mul_f32 v[144:145], v[132:133], v[114:115]
v_pk_mul_f32 v[146:147], v[132:133], v[116:117]
v_pk_mul_f32 v[148:149], v[132:133], v[118:119]
v_pk_fma_f32 v[142:143], v[130:131], v[114:115], v[142:143]
v_pk_fma_f32 v[144:145], v[130:131], v[116:117], v[144:145]
v_pk_fma_f32 v[146:147], v[130:131], v[118:119], v[146:147]
v_pk_fma_f32 v[148:149], v[130:131], v[120:121], v[148:149]
v_pk_fma_f32 v[142:143], v[128:129], v[116:117], v[142:143]
v_pk_fma_f32 v[144:145], v[128:129], v[118:119], v[144:145]
v_pk_fma_f32 v[146:147], v[128:129], v[120:121], v[146:147]
v_pk_fma_f32 v[148:149], v[128:129], v[122:123], v[148:149]
v_pk_fma_f32 v[142:143], v[126:127], v[118:119], v[142:143]
v_pk_fma_f32 v[144:145], v[126:127], v[120:121], v[144:145]
v_pk_fma_f32 v[146:147], v[126:127], v[122:123], v[146:147]
v_pk_fma_f32 v[148:149], v[126:127], v[124:125], v[148:149]
v_pk_mul_f32 v[142:143], v[142:143], v[134:135]
v_pk_mul_f32 v[144:145], v[144:145], v[136:137]
v_pk_mul_f32 v[146:147], v[146:147], v[138:139]
v_pk_mul_f32 v[148:149], v[148:149], v[140:141]
v_cvt_pk_bf16_f32 v240, v148, v146
v_cvt_pk_bf16_f32 v241, v144, v142
v_cvt_pk_bf16_f32 v242, v149, v147
v_cvt_pk_bf16_f32 v243, v145, v143
ds_bpermute_b32 v240, v239, v240
ds_bpermute_b32 v241, v239, v241
ds_bpermute_b32 v242, v239, v242
ds_bpermute_b32 v243, v239, v243
v_lshlrev_b32 v112, 16, v17
v_and_b32 v113, 0xffff0000, v17
v_lshlrev_b32 v114, 16, v21
v_and_b32 v115, 0xffff0000, v21
v_lshlrev_b32 v116, 16, v25
v_and_b32 v117, 0xffff0000, v25
v_lshlrev_b32 v118, 16, v29
v_and_b32 v119, 0xffff0000, v29
v_lshlrev_b32 v120, 16, v33
v_and_b32 v121, 0xffff0000, v33
v_lshlrev_b32 v122, 16, v37
v_and_b32 v123, 0xffff0000, v37
v_lshlrev_b32 v124, 16, v41
v_and_b32 v125, 0xffff0000, v41
v_lshlrev_b32 v126, 16, v64
v_and_b32 v128, 0xffff0000, v64
v_lshlrev_b32 v130, 16, v65
v_and_b32 v132, 0xffff0000, v65
v_lshlrev_b32 v127, 16, v66
v_and_b32 v129, 0xffff0000, v66
v_lshlrev_b32 v131, 16, v67
v_and_b32 v133, 0xffff0000, v67
v_lshlrev_b32 v134, 16, v45
v_and_b32 v135, 0xffff0000, v45
v_lshlrev_b32 v136, 16, v49
v_and_b32 v137, 0xffff0000, v49
v_lshlrev_b32 v138, 16, v53
v_and_b32 v139, 0xffff0000, v53
v_lshlrev_b32 v140, 16, v57
v_and_b32 v141, 0xffff0000, v57
v_pk_mul_f32 v[142:143], v[132:133], v[112:113]
v_pk_mul_f32 v[144:145], v[132:133], v[114:115]
v_pk_mul_f32 v[146:147], v[132:133], v[116:117]
v_pk_mul_f32 v[148:149], v[132:133], v[118:119]
v_pk_fma_f32 v[142:143], v[130:131], v[114:115], v[142:143]
v_pk_fma_f32 v[144:145], v[130:131], v[116:117], v[144:145]
v_pk_fma_f32 v[146:147], v[130:131], v[118:119], v[146:147]
v_pk_fma_f32 v[148:149], v[130:131], v[120:121], v[148:149]
v_pk_fma_f32 v[142:143], v[128:129], v[116:117], v[142:143]
v_pk_fma_f32 v[144:145], v[128:129], v[118:119], v[144:145]
v_pk_fma_f32 v[146:147], v[128:129], v[120:121], v[146:147]
v_pk_fma_f32 v[148:149], v[128:129], v[122:123], v[148:149]
v_pk_fma_f32 v[142:143], v[126:127], v[118:119], v[142:143]
v_pk_fma_f32 v[144:145], v[126:127], v[120:121], v[144:145]
v_pk_fma_f32 v[146:147], v[126:127], v[122:123], v[146:147]
v_pk_fma_f32 v[148:149], v[126:127], v[124:125], v[148:149]
v_pk_mul_f32 v[142:143], v[142:143], v[134:135]
v_pk_mul_f32 v[144:145], v[144:145], v[136:137]
v_pk_mul_f32 v[146:147], v[146:147], v[138:139]
v_pk_mul_f32 v[148:149], v[148:149], v[140:141]
v_cvt_pk_bf16_f32 v244, v148, v146
v_cvt_pk_bf16_f32 v245, v144, v142
v_cvt_pk_bf16_f32 v246, v149, v147
v_cvt_pk_bf16_f32 v247, v145, v143
ds_bpermute_b32 v244, v239, v244
ds_bpermute_b32 v245, v239, v245
ds_bpermute_b32 v246, v239, v246
ds_bpermute_b32 v247, v239, v247
v_lshlrev_b32 v112, 16, v18
v_and_b32 v113, 0xffff0000, v18
v_lshlrev_b32 v114, 16, v22
v_and_b32 v115, 0xffff0000, v22
v_lshlrev_b32 v116, 16, v26
v_and_b32 v117, 0xffff0000, v26
v_lshlrev_b32 v118, 16, v30
v_and_b32 v119, 0xffff0000, v30
v_lshlrev_b32 v120, 16, v34
v_and_b32 v121, 0xffff0000, v34
v_lshlrev_b32 v122, 16, v38
v_and_b32 v123, 0xffff0000, v38
v_lshlrev_b32 v124, 16, v42
v_and_b32 v125, 0xffff0000, v42
v_lshlrev_b32 v126, 16, v68
v_and_b32 v128, 0xffff0000, v68
v_lshlrev_b32 v130, 16, v69
v_and_b32 v132, 0xffff0000, v69
v_lshlrev_b32 v127, 16, v70
v_and_b32 v129, 0xffff0000, v70
v_lshlrev_b32 v131, 16, v71
v_and_b32 v133, 0xffff0000, v71
v_lshlrev_b32 v134, 16, v46
v_and_b32 v135, 0xffff0000, v46
v_lshlrev_b32 v136, 16, v50
v_and_b32 v137, 0xffff0000, v50
v_lshlrev_b32 v138, 16, v54
v_and_b32 v139, 0xffff0000, v54
v_lshlrev_b32 v140, 16, v58
v_and_b32 v141, 0xffff0000, v58
v_pk_mul_f32 v[142:143], v[132:133], v[112:113]
v_pk_mul_f32 v[144:145], v[132:133], v[114:115]
v_pk_mul_f32 v[146:147], v[132:133], v[116:117]
v_pk_mul_f32 v[148:149], v[132:133], v[118:119]
v_pk_fma_f32 v[142:143], v[130:131], v[114:115], v[142:143]
v_pk_fma_f32 v[144:145], v[130:131], v[116:117], v[144:145]
v_pk_fma_f32 v[146:147], v[130:131], v[118:119], v[146:147]
v_pk_fma_f32 v[148:149], v[130:131], v[120:121], v[148:149]
v_pk_fma_f32 v[142:143], v[128:129], v[116:117], v[142:143]
v_pk_fma_f32 v[144:145], v[128:129], v[118:119], v[144:145]
v_pk_fma_f32 v[146:147], v[128:129], v[120:121], v[146:147]
v_pk_fma_f32 v[148:149], v[128:129], v[122:123], v[148:149]
v_pk_fma_f32 v[142:143], v[126:127], v[118:119], v[142:143]
v_pk_fma_f32 v[144:145], v[126:127], v[120:121], v[144:145]
v_pk_fma_f32 v[146:147], v[126:127], v[122:123], v[146:147]
v_pk_fma_f32 v[148:149], v[126:127], v[124:125], v[148:149]
v_pk_mul_f32 v[142:143], v[142:143], v[134:135]
v_pk_mul_f32 v[144:145], v[144:145], v[136:137]
v_pk_mul_f32 v[146:147], v[146:147], v[138:139]
v_pk_mul_f32 v[148:149], v[148:149], v[140:141]
v_cvt_pk_bf16_f32 v248, v148, v146
v_cvt_pk_bf16_f32 v249, v144, v142
v_cvt_pk_bf16_f32 v250, v149, v147
v_cvt_pk_bf16_f32 v251, v145, v143
ds_bpermute_b32 v248, v239, v248
ds_bpermute_b32 v249, v239, v249
ds_bpermute_b32 v250, v239, v250
ds_bpermute_b32 v251, v239, v251
v_lshlrev_b32 v112, 16, v19
v_and_b32 v113, 0xffff0000, v19
v_lshlrev_b32 v114, 16, v23
v_and_b32 v115, 0xffff0000, v23
v_lshlrev_b32 v116, 16, v27
v_and_b32 v117, 0xffff0000, v27
v_lshlrev_b32 v118, 16, v31
v_and_b32 v119, 0xffff0000, v31
v_lshlrev_b32 v120, 16, v35
v_and_b32 v121, 0xffff0000, v35
v_lshlrev_b32 v122, 16, v39
v_and_b32 v123, 0xffff0000, v39
v_lshlrev_b32 v124, 16, v43
v_and_b32 v125, 0xffff0000, v43
v_lshlrev_b32 v126, 16, v72
v_and_b32 v128, 0xffff0000, v72
v_lshlrev_b32 v130, 16, v73
v_and_b32 v132, 0xffff0000, v73
v_lshlrev_b32 v127, 16, v74
v_and_b32 v129, 0xffff0000, v74
v_lshlrev_b32 v131, 16, v75
v_and_b32 v133, 0xffff0000, v75
v_lshlrev_b32 v134, 16, v47
v_and_b32 v135, 0xffff0000, v47
v_lshlrev_b32 v136, 16, v51
v_and_b32 v137, 0xffff0000, v51
v_lshlrev_b32 v138, 16, v55
v_and_b32 v139, 0xffff0000, v55
v_lshlrev_b32 v140, 16, v59
v_and_b32 v141, 0xffff0000, v59
v_pk_mul_f32 v[142:143], v[132:133], v[112:113]
v_pk_mul_f32 v[144:145], v[132:133], v[114:115]
v_pk_mul_f32 v[146:147], v[132:133], v[116:117]
v_pk_mul_f32 v[148:149], v[132:133], v[118:119]
v_pk_fma_f32 v[142:143], v[130:131], v[114:115], v[142:143]
v_pk_fma_f32 v[144:145], v[130:131], v[116:117], v[144:145]
v_pk_fma_f32 v[146:147], v[130:131], v[118:119], v[146:147]
v_pk_fma_f32 v[148:149], v[130:131], v[120:121], v[148:149]
v_pk_fma_f32 v[142:143], v[128:129], v[116:117], v[142:143]
v_pk_fma_f32 v[144:145], v[128:129], v[118:119], v[144:145]
v_pk_fma_f32 v[146:147], v[128:129], v[120:121], v[146:147]
v_pk_fma_f32 v[148:149], v[128:129], v[122:123], v[148:149]
v_pk_fma_f32 v[142:143], v[126:127], v[118:119], v[142:143]
v_pk_fma_f32 v[144:145], v[126:127], v[120:121], v[144:145]
v_pk_fma_f32 v[146:147], v[126:127], v[122:123], v[146:147]
v_pk_fma_f32 v[148:149], v[126:127], v[124:125], v[148:149]
v_pk_mul_f32 v[142:143], v[142:143], v[134:135]
v_pk_mul_f32 v[144:145], v[144:145], v[136:137]
v_pk_mul_f32 v[146:147], v[146:147], v[138:139]
v_pk_mul_f32 v[148:149], v[148:149], v[140:141]
v_cvt_pk_bf16_f32 v252, v148, v146
v_cvt_pk_bf16_f32 v253, v144, v142
v_cvt_pk_bf16_f32 v254, v149, v147
v_cvt_pk_bf16_f32 v255, v145, v143
ds_bpermute_b32 v252, v239, v252
ds_bpermute_b32 v253, v239, v253
ds_bpermute_b32 v254, v239, v254
ds_bpermute_b32 v255, v239, v255
s_waitcnt lgkmcnt(0)
s_mov_b32 s65, 0
buffer_store_dwordx2 v[240:241], v225, s[48:51], s65 offen
s_mov_b32 s65, 4096
buffer_store_dwordx2 v[242:243], v225, s[48:51], s65 offen
s_mov_b32 s65, 8192
buffer_store_dwordx2 v[244:245], v225, s[48:51], s65 offen
s_mov_b32 s65, 12288
buffer_store_dwordx2 v[246:247], v225, s[48:51], s65 offen
s_mov_b32 s65, 16384
buffer_store_dwordx2 v[248:249], v225, s[48:51], s65 offen
s_mov_b32 s65, 20480
buffer_store_dwordx2 v[250:251], v225, s[48:51], s65 offen
s_mov_b32 s65, 24576
buffer_store_dwordx2 v[252:253], v225, s[48:51], s65 offen
s_mov_b32 s65, 28672
buffer_store_dwordx2 v[254:255], v225, s[48:51], s65 offen
s_waitcnt vmcnt(8)
s_barrier
s_lshl_b32 s70, s24, 7
s_add_u32 s70, s70, 4096
v_and_b32 v13, 15, v0
v_lshlrev_b32 v13, 3, v13
buffer_load_dwordx2 v[14:15], v13, s[56:59], s70 offen sc1
buffer_load_dword v237, v226, s[48:51], 0 offen sc1 nt
ds_read_b128 v[140:143], v5 offset:0
ds_read_b128 v[144:147], v5 offset:1024
ds_read_b128 v[148:151], v5 offset:2048
ds_read_b128 v[152:155], v5 offset:3072
v_lshlrev_b32 v108, 16, v76
v_and_b32 v109, 0xffff0000, v76
v_lshlrev_b32 v110, 16, v84
v_and_b32 v111, 0xffff0000, v84
v_pk_add_f32 v[16:17], v[108:109], v[110:111]
v_pk_add_f32 v[18:19], v[108:109], v[110:111] neg_lo:[0,1] neg_hi:[0,1]
v_cvt_pk_bf16_f32 v92, v16, v17
v_cvt_pk_bf16_f32 v100, v18, v19
v_lshlrev_b32 v112, 16, v77
v_and_b32 v113, 0xffff0000, v77
v_lshlrev_b32 v114, 16, v85
v_and_b32 v115, 0xffff0000, v85
v_pk_add_f32 v[20:21], v[112:113], v[114:115]
v_pk_add_f32 v[22:23], v[112:113], v[114:115] neg_lo:[0,1] neg_hi:[0,1]
v_cvt_pk_bf16_f32 v93, v20, v21
v_cvt_pk_bf16_f32 v101, v22, v23
v_lshlrev_b32 v108, 16, v78
v_and_b32 v109, 0xffff0000, v78
v_lshlrev_b32 v110, 16, v86
v_and_b32 v111, 0xffff0000, v86
v_pk_add_f32 v[16:17], v[108:109], v[110:111]
v_pk_add_f32 v[18:19], v[108:109], v[110:111] neg_lo:[0,1] neg_hi:[0,1]
v_cvt_pk_bf16_f32 v94, v16, v17
v_cvt_pk_bf16_f32 v102, v18, v19
v_lshlrev_b32 v112, 16, v79
v_and_b32 v113, 0xffff0000, v79
v_lshlrev_b32 v114, 16, v87
v_and_b32 v115, 0xffff0000, v87
v_pk_add_f32 v[20:21], v[112:113], v[114:115]
v_pk_add_f32 v[22:23], v[112:113], v[114:115] neg_lo:[0,1] neg_hi:[0,1]
v_cvt_pk_bf16_f32 v95, v20, v21
v_cvt_pk_bf16_f32 v103, v22, v23
ds_write_b128 v6, v[92:95] offset:0
ds_write_b128 v6, v[100:103] offset:3072
v_lshlrev_b32 v108, 16, v80
v_and_b32 v109, 0xffff0000, v80
v_lshlrev_b32 v110, 16, v88
v_and_b32 v111, 0xffff0000, v88
v_pk_add_f32 v[16:17], v[108:109], v[110:111]
v_pk_add_f32 v[18:19], v[108:109], v[110:111] neg_lo:[0,1] neg_hi:[0,1]
v_cvt_pk_bf16_f32 v96, v16, v17
v_cvt_pk_bf16_f32 v104, v18, v19
v_lshlrev_b32 v112, 16, v81
v_and_b32 v113, 0xffff0000, v81
v_lshlrev_b32 v114, 16, v89
v_and_b32 v115, 0xffff0000, v89
v_pk_add_f32 v[20:21], v[112:113], v[114:115]
v_pk_add_f32 v[22:23], v[112:113], v[114:115] neg_lo:[0,1] neg_hi:[0,1]
v_cvt_pk_bf16_f32 v97, v20, v21
v_cvt_pk_bf16_f32 v105, v22, v23
v_lshlrev_b32 v108, 16, v82
v_and_b32 v109, 0xffff0000, v82
v_lshlrev_b32 v110, 16, v90
v_and_b32 v111, 0xffff0000, v90
v_pk_add_f32 v[16:17], v[108:109], v[110:111]
v_pk_add_f32 v[18:19], v[108:109], v[110:111] neg_lo:[0,1] neg_hi:[0,1]
v_cvt_pk_bf16_f32 v98, v16, v17
v_cvt_pk_bf16_f32 v106, v18, v19
v_lshlrev_b32 v112, 16, v83
v_and_b32 v113, 0xffff0000, v83
v_lshlrev_b32 v114, 16, v91
v_and_b32 v115, 0xffff0000, v91
v_pk_add_f32 v[20:21], v[112:113], v[114:115]
v_pk_add_f32 v[22:23], v[112:113], v[114:115] neg_lo:[0,1] neg_hi:[0,1]
v_cvt_pk_bf16_f32 v99, v20, v21
v_cvt_pk_bf16_f32 v107, v22, v23
ds_write_b128 v6, v[96:99] offset:1536
ds_write_b128 v6, v[104:107] offset:4608
s_lshl_b32 s64, s29, 12
s_add_u32 s36, s12, s64
s_addc_u32 s37, s13, 0
s_mov_b32 s38, 4096
s_mov_b32 s39, 0x20000
s_add_u32 m0, s33, 13568
ds_read_b128 v[172:175], v5 offset:4096
ds_read_b128 v[176:179], v5 offset:5120
buffer_load_dwordx4 v236, s[36:39], 0 offen offset:0 nt lds
ds_read_b128 v[180:183], v5 offset:6144
ds_read_b128 v[184:187], v5 offset:7168
buffer_load_dwordx4 v236, s[36:39], 0 offen offset:1024 nt lds
ds_read_b128 v[188:191], v5 offset:8192
ds_read_b128 v[192:195], v5 offset:9216
buffer_load_dwordx4 v236, s[36:39], 0 offen offset:2048 nt lds
ds_read_b128 v[196:199], v5 offset:10240
ds_read_b128 v[200:203], v5 offset:11264
buffer_load_dwordx4 v236, s[36:39], 0 offen offset:3072 nt lds
s_waitcnt lgkmcnt(8)
ds_read_b64_tr_b16 v[156:157], v7 offset:0
ds_read_b64_tr_b16 v[158:159], v7 offset:1536
ds_read_b64_tr_b16 v[160:161], v7 offset:32
ds_read_b64_tr_b16 v[162:163], v7 offset:1568
ds_read_b64_tr_b16 v[164:165], v7 offset:3072
ds_read_b64_tr_b16 v[166:167], v7 offset:4608
ds_read_b64_tr_b16 v[168:169], v7 offset:3104
ds_read_b64_tr_b16 v[170:171], v7 offset:4640
v_mov_b32 v40, 0
v_mov_b32 v41, 0
v_mov_b32 v42, 0
v_mov_b32 v43, 0
v_and_b32 v8, 31, v0
v_lshl_add_u32 v8, v8, 4, s33
s_waitcnt lgkmcnt(0)
v_mfma_f32_16x16x32_bf16 v[76:79], v[156:159], v[140:143], 0
v_mfma_f32_16x16x32_bf16 v[80:83], v[156:159], v[144:147], 0
v_mfma_f32_16x16x32_bf16 v[84:87], v[156:159], v[148:151], 0
v_mfma_f32_16x16x32_bf16 v[88:91], v[156:159], v[152:155], 0
v_mfma_f32_16x16x32_bf16 v[92:95], v[160:163], v[140:143], 0
v_mfma_f32_16x16x32_bf16 v[96:99], v[160:163], v[144:147], 0
v_mfma_f32_16x16x32_bf16 v[100:103], v[160:163], v[148:151], 0
v_mfma_f32_16x16x32_bf16 v[104:107], v[160:163], v[152:155], 0
v_mfma_f32_16x16x32_bf16 v[108:111], v[164:167], v[140:143], 0
v_mfma_f32_16x16x32_bf16 v[112:115], v[164:167], v[144:147], 0
v_mfma_f32_16x16x32_bf16 v[116:119], v[164:167], v[148:151], 0
v_mfma_f32_16x16x32_bf16 v[120:123], v[164:167], v[152:155], 0
v_mfma_f32_16x16x32_bf16 v[124:127], v[168:171], v[140:143], 0
v_mfma_f32_16x16x32_bf16 v[128:131], v[168:171], v[144:147], 0
v_mfma_f32_16x16x32_bf16 v[132:135], v[168:171], v[148:151], 0
v_mfma_f32_16x16x32_bf16 v[136:139], v[168:171], v[152:155], 0
ds_read_b128 v[140:143], v5 offset:12288
ds_read_b128 v[144:147], v5 offset:13312
ds_read_b128 v[148:151], v5 offset:16384
ds_read_b128 v[152:155], v5 offset:17408
ds_read_b128 v[156:159], v12 offset:12288
ds_read_b128 v[160:163], v12 offset:13312
ds_read_b128 v[164:167], v12 offset:16384
ds_read_b128 v[168:171], v12 offset:17408
ds_write_b128 v8, v[40:43] offset:4096
ds_write_b128 v8, v[40:43] offset:8736
v_and_b32 v8, 15, v0
v_lshl_add_u32 v11, v8, 2, s33
ds_write_b32 v11, v40 offset:13504
v_pk_mul_f32 v[16:17], v[76:77], v[172:173]
v_pk_mul_f32 v[20:21], v[80:81], v[172:173]
v_pk_mul_f32 v[18:19], v[78:79], v[174:175]
v_pk_mul_f32 v[22:23], v[82:83], v[174:175]
v_pk_fma_f32 v[16:17], v[80:81], v[176:177], v[16:17]
v_pk_fma_f32 v[20:21], v[76:77], v[176:177], v[20:21] neg_lo:[1,0,0] neg_hi:[1,0,0]
v_pk_fma_f32 v[18:19], v[82:83], v[178:179], v[18:19]
v_pk_fma_f32 v[22:23], v[78:79], v[178:179], v[22:23] neg_lo:[1,0,0] neg_hi:[1,0,0]
v_cvt_pk_bf16_f32 v76, v16, v17
v_cvt_pk_bf16_f32 v80, v20, v21
v_cvt_pk_bf16_f32 v77, v18, v19
v_cvt_pk_bf16_f32 v81, v22, v23
v_pk_mul_f32 v[24:25], v[92:93], v[188:189]
v_pk_mul_f32 v[28:29], v[96:97], v[188:189]
v_pk_mul_f32 v[26:27], v[94:95], v[190:191]
v_pk_mul_f32 v[30:31], v[98:99], v[190:191]
v_pk_fma_f32 v[24:25], v[96:97], v[192:193], v[24:25]
v_pk_fma_f32 v[28:29], v[92:93], v[192:193], v[28:29] neg_lo:[1,0,0] neg_hi:[1,0,0]
v_pk_fma_f32 v[26:27], v[98:99], v[194:195], v[26:27]
v_pk_fma_f32 v[30:31], v[94:95], v[194:195], v[30:31] neg_lo:[1,0,0] neg_hi:[1,0,0]
v_cvt_pk_bf16_f32 v78, v24, v25
v_cvt_pk_bf16_f32 v82, v28, v29
v_cvt_pk_bf16_f32 v79, v26, v27
v_cvt_pk_bf16_f32 v83, v30, v31
v_pk_mul_f32 v[16:17], v[84:85], v[180:181]
v_pk_mul_f32 v[20:21], v[88:89], v[180:181]
v_pk_mul_f32 v[18:19], v[86:87], v[182:183]
v_pk_mul_f32 v[22:23], v[90:91], v[182:183]
v_pk_fma_f32 v[16:17], v[88:89], v[184:185], v[16:17]
v_pk_fma_f32 v[20:21], v[84:85], v[184:185], v[20:21] neg_lo:[1,0,0] neg_hi:[1,0,0]
v_pk_fma_f32 v[18:19], v[90:91], v[186:187], v[18:19]
v_pk_fma_f32 v[22:23], v[86:87], v[186:187], v[22:23] neg_lo:[1,0,0] neg_hi:[1,0,0]
v_cvt_pk_bf16_f32 v84, v16, v17
v_cvt_pk_bf16_f32 v88, v20, v21
v_cvt_pk_bf16_f32 v85, v18, v19
v_cvt_pk_bf16_f32 v89, v22, v23
v_pk_mul_f32 v[24:25], v[100:101], v[196:197]
v_pk_mul_f32 v[28:29], v[104:105], v[196:197]
v_pk_mul_f32 v[26:27], v[102:103], v[198:199]
v_pk_mul_f32 v[30:31], v[106:107], v[198:199]
v_pk_fma_f32 v[24:25], v[104:105], v[200:201], v[24:25]
v_pk_fma_f32 v[28:29], v[100:101], v[200:201], v[28:29] neg_lo:[1,0,0] neg_hi:[1,0,0]
v_pk_fma_f32 v[26:27], v[106:107], v[202:203], v[26:27]
v_pk_fma_f32 v[30:31], v[102:103], v[202:203], v[30:31] neg_lo:[1,0,0] neg_hi:[1,0,0]
v_cvt_pk_bf16_f32 v86, v24, v25
v_cvt_pk_bf16_f32 v90, v28, v29
v_cvt_pk_bf16_f32 v87, v26, v27
v_cvt_pk_bf16_f32 v91, v30, v31
s_waitcnt vmcnt(5)
v_cmp_ne_u32 vcc, s27, v14
s_nop 4
s_cbranch_vccnz Lr_2
Lrj_3:
v_cmp_ne_u32 vcc, s30, v15
s_nop 0
s_or_b32 s64, vcc_lo, vcc_hi
s_cmp_eq_u32 s64, 0
s_cselect_b32 s28, 1, 0
s_lshl_b32 s64, s24, 8
s_lshl_b32 s65, s25, 4
s_add_u32 s64, s64, s65
s_lshl_b32 s65, s26, 2
s_add_u32 s71, s64, s65
v_mov_b32 v9, s71
v_mov_b32 v10, s27
s_movk_i32 s66, 8192
s_cmp_eq_u32 s28, 0
s_cbranch_scc1 Lg_6
s_mov_b64 exec, 1
buffer_store_dword v10, v9, s[56:59], s66 offen
s_mov_b64 exec, -1
Lj_7:
s_add_u32 m0, s33, 9344
v_add_u32 v9, 4, v236
buffer_load_dwordx4 v9, s[36:39], 0 offen offset:0 lds
buffer_load_dwordx4 v9, s[36:39], 0 offen offset:1024 lds
buffer_load_dwordx4 v9, s[36:39], 0 offen offset:2048 lds
buffer_load_dwordx4 v9, s[36:39], 0 offen offset:3072 lds
v_mov_b32 v10, 0
buffer_load_dword v227, v10, s[36:39], 0 offen
v_pk_mul_f32 v[16:17], v[108:109], v[172:173]
v_pk_mul_f32 v[20:21], v[112:113], v[172:173]
v_pk_mul_f32 v[18:19], v[110:111], v[174:175]
v_pk_mul_f32 v[22:23], v[114:115], v[174:175]
v_pk_fma_f32 v[16:17], v[112:113], v[176:177], v[16:17]
v_pk_fma_f32 v[20:21], v[108:109], v[176:177], v[20:21] neg_lo:[1,0,0] neg_hi:[1,0,0]
v_pk_fma_f32 v[18:19], v[114:115], v[178:179], v[18:19]
v_pk_fma_f32 v[22:23], v[110:111], v[178:179], v[22:23] neg_lo:[1,0,0] neg_hi:[1,0,0]
v_cvt_pk_bf16_f32 v108, v16, v17
v_cvt_pk_bf16_f32 v112, v20, v21
v_cvt_pk_bf16_f32 v109, v18, v19
v_cvt_pk_bf16_f32 v113, v22, v23
v_pk_mul_f32 v[24:25], v[124:125], v[188:189]
v_pk_mul_f32 v[28:29], v[128:129], v[188:189]
v_pk_mul_f32 v[26:27], v[126:127], v[190:191]
v_pk_mul_f32 v[30:31], v[130:131], v[190:191]
v_pk_fma_f32 v[24:25], v[128:129], v[192:193], v[24:25]
v_pk_fma_f32 v[28:29], v[124:125], v[192:193], v[28:29] neg_lo:[1,0,0] neg_hi:[1,0,0]
v_pk_fma_f32 v[26:27], v[130:131], v[194:195], v[26:27]
v_pk_fma_f32 v[30:31], v[126:127], v[194:195], v[30:31] neg_lo:[1,0,0] neg_hi:[1,0,0]
v_cvt_pk_bf16_f32 v110, v24, v25
v_cvt_pk_bf16_f32 v114, v28, v29
v_cvt_pk_bf16_f32 v111, v26, v27
v_cvt_pk_bf16_f32 v115, v30, v31
v_pk_mul_f32 v[16:17], v[116:117], v[180:181]
v_pk_mul_f32 v[20:21], v[120:121], v[180:181]
v_pk_mul_f32 v[18:19], v[118:119], v[182:183]
v_pk_mul_f32 v[22:23], v[122:123], v[182:183]
v_pk_fma_f32 v[16:17], v[120:121], v[184:185], v[16:17]
v_pk_fma_f32 v[20:21], v[116:117], v[184:185], v[20:21] neg_lo:[1,0,0] neg_hi:[1,0,0]
v_pk_fma_f32 v[18:19], v[122:123], v[186:187], v[18:19]
v_pk_fma_f32 v[22:23], v[118:119], v[186:187], v[22:23] neg_lo:[1,0,0] neg_hi:[1,0,0]
v_cvt_pk_bf16_f32 v116, v16, v17
v_cvt_pk_bf16_f32 v120, v20, v21
v_cvt_pk_bf16_f32 v117, v18, v19
v_cvt_pk_bf16_f32 v121, v22, v23
v_pk_mul_f32 v[24:25], v[132:133], v[196:197]
v_pk_mul_f32 v[28:29], v[136:137], v[196:197]
v_pk_mul_f32 v[26:27], v[134:135], v[198:199]
v_pk_mul_f32 v[30:31], v[138:139], v[198:199]
v_pk_fma_f32 v[24:25], v[136:137], v[200:201], v[24:25]
v_pk_fma_f32 v[28:29], v[132:133], v[200:201], v[28:29] neg_lo:[1,0,0] neg_hi:[1,0,0]
v_pk_fma_f32 v[26:27], v[138:139], v[202:203], v[26:27]
v_pk_fma_f32 v[30:31], v[134:135], v[202:203], v[30:31] neg_lo:[1,0,0] neg_hi:[1,0,0]
v_cvt_pk_bf16_f32 v118, v24, v25
v_cvt_pk_bf16_f32 v122, v28, v29
v_cvt_pk_bf16_f32 v119, v26, v27
v_cvt_pk_bf16_f32 v123, v30, v31
s_waitcnt lgkmcnt(0)
v_mfma_f32_16x16x32_bf16 v[172:175], v[76:79], v[140:143], 0
v_mfma_f32_16x16x32_bf16 v[172:175], v[80:83], v[144:147], v[172:175]
v_mfma_f32_16x16x32_bf16 v[188:191], v[108:111], v[156:159], 0
v_mfma_f32_16x16x32_bf16 v[188:191], v[112:115], v[160:163], v[188:191]
v_mfma_f32_16x16x32_bf16 v[176:179], v[84:87], v[140:143], 0
v_mfma_f32_16x16x32_bf16 v[176:179], v[88:91], v[144:147], v[176:179]
v_mfma_f32_16x16x32_bf16 v[192:195], v[116:119], v[156:159], 0
v_mfma_f32_16x16x32_bf16 v[192:195], v[120:123], v[160:163], v[192:195]
v_mfma_f32_16x16x32_bf16 v[180:183], v[76:79], v[148:151], 0
v_mfma_f32_16x16x32_bf16 v[180:183], v[80:83], v[152:155], v[180:183]
v_mfma_f32_16x16x32_bf16 v[196:199], v[108:111], v[164:167], 0
v_mfma_f32_16x16x32_bf16 v[196:199], v[112:115], v[168:171], v[196:199]
v_mfma_f32_16x16x32_bf16 v[184:187], v[84:87], v[148:151], 0
v_mfma_f32_16x16x32_bf16 v[184:187], v[88:91], v[152:155], v[184:187]
v_mfma_f32_16x16x32_bf16 v[200:203], v[116:119], v[164:167], 0
v_mfma_f32_16x16x32_bf16 v[200:203], v[120:123], v[168:171], v[200:203]
v_and_b32 v8, 7, v2
v_and_b32 v9, 1, v3
s_lshl_b32 s64, s26, 1
s_sub_u32 s65, 6, s64
v_or_b32 v10, s64, v9
v_xor_b32 v10, v10, v8
v_or_b32 v12, s65, v9
v_xor_b32 v12, v12, v8
v_lshlrev_b32 v8, 1, v2
v_lshrrev_b32 v9, 1, v3
v_add_u32 v8, v8, v9
v_lshlrev_b32 v8, 7, v8
v_lshl_add_u32 v10, v10, 4, v8
v_lshl_add_u32 v12, v12, 4, v8
v_add_u32 v10, 115712, v10
v_add_u32 v12, 123904, v12
v_pk_add_f32 v[16:17], v[172:173], v[188:189] neg_lo:[0,1] neg_hi:[0,1]
v_pk_add_f32 v[20:21], v[172:173], v[188:189]
v_pk_add_f32 v[18:19], v[174:175], v[190:191] neg_lo:[0,1] neg_hi:[0,1]
v_pk_add_f32 v[22:23], v[174:175], v[190:191]
v_cvt_pk_bf16_f32 v204, v16, v17
v_cvt_pk_bf16_f32 v208, v20, v21
v_cvt_pk_bf16_f32 v205, v18, v19
v_cvt_pk_bf16_f32 v209, v22, v23
v_pk_add_f32 v[16:17], v[176:177], v[192:193] neg_lo:[0,1] neg_hi:[0,1]
v_pk_add_f32 v[20:21], v[176:177], v[192:193]
v_pk_add_f32 v[18:19], v[178:179], v[194:195] neg_lo:[0,1] neg_hi:[0,1]
v_pk_add_f32 v[22:23], v[178:179], v[194:195]
v_cvt_pk_bf16_f32 v206, v16, v17
v_cvt_pk_bf16_f32 v210, v20, v21
v_cvt_pk_bf16_f32 v207, v18, v19
v_cvt_pk_bf16_f32 v211, v22, v23
ds_write_b128 v10, v[204:207] offset:0
ds_write_b128 v12, v[208:211] offset:0
v_pk_add_f32 v[16:17], v[180:181], v[196:197] neg_lo:[0,1] neg_hi:[0,1]
v_pk_add_f32 v[20:21], v[180:181], v[196:197]
v_pk_add_f32 v[18:19], v[182:183], v[198:199] neg_lo:[0,1] neg_hi:[0,1]
v_pk_add_f32 v[22:23], v[182:183], v[198:199]
v_cvt_pk_bf16_f32 v212, v16, v17
v_cvt_pk_bf16_f32 v216, v20, v21
v_cvt_pk_bf16_f32 v213, v18, v19
v_cvt_pk_bf16_f32 v217, v22, v23
v_pk_add_f32 v[16:17], v[184:185], v[200:201] neg_lo:[0,1] neg_hi:[0,1]
v_pk_add_f32 v[20:21], v[184:185], v[200:201]
v_pk_add_f32 v[18:19], v[186:187], v[202:203] neg_lo:[0,1] neg_hi:[0,1]
v_pk_add_f32 v[22:23], v[186:187], v[202:203]
v_cvt_pk_bf16_f32 v214, v16, v17
v_cvt_pk_bf16_f32 v218, v20, v21
v_cvt_pk_bf16_f32 v215, v18, v19
v_cvt_pk_bf16_f32 v219, v22, v23
ds_write_b128 v10, v[212:215] offset:4096
ds_write_b128 v12, v[216:219] offset:4096
s_movk_i32 s70, 8192
buffer_load_dword v13, v235, s[56:59], s70 offen sc1
v_lshrrev_b32 v8, 3, v0
v_and_b32 v9, 7, v0
v_lshrrev_b32 v10, 1, v8
v_xor_b32 v10, v10, v9
s_lshr_b32 s64, s26, 1
s_lshl_b32 s64, s64, 13
s_and_b32 s65, s26, 1
s_lshl_b32 s65, s65, 12
s_add_u32 s64, s64, s65
s_add_u32 s64, s64, 115712
v_lshlrev_b32 v14, 7, v8
v_add_u32 v14, s64, v14
v_xor_b32 v12, 4, v10
v_lshl_add_u32 v10, v10, 4, v14
v_lshl_add_u32 v12, v12, 4, v14
s_lshl_b32 s64, s2, 7
s_sub_u32 s65, 65440, s64
s_cmp_ge_u32 s26, 2
s_cselect_b32 s64, s65, s64
s_and_b32 s65, s26, 1
s_lshl_b32 s65, s65, 21
s_add_u32 s64, s64, s65
v_lshlrev_b32 v224, 16, v8
v_lshl_add_u32 v224, v9, 4, v224
v_add_u32 v224, s64, v224
s_cmp_ge_u32 s26, 2
s_cselect_b32 s64, 0, 1
s_or_b32 s64, s64, s2
s_cmp_eq_u32 s64, 0
s_cselect_b32 s64, 6, 8
v_cmp_le_u32 vcc, s64, v9
v_add_u32 v14, 4294934528, v224
s_nop 0
v_cndmask_b32 v224, v224, v14, vcc
s_waitcnt lgkmcnt(0)
s_barrier
ds_read_b128 v[204:207], v10 offset:0
ds_read_b128 v[208:211], v12 offset:1024
ds_read_b128 v[212:215], v10 offset:2048
ds_read_b128 v[216:219], v12 offset:3072
v_and_b32 v6, 1, v0
v_mul_u32_u24 v6, 4640, v6
v_bfe_u32 v7, v0, 1, 3
v_lshlrev_b32 v7, 6, v7
v_sub_u32 v6, v6, v7
v_lshrrev_b32 v7, 4, v0
v_lshl_add_u32 v6, v7, 4, v6
s_add_u32 s64, s33, 448
v_add_u32 v6, s64, v6
v_and_b32 v8, 15, v0
v_and_b32 v9, 1, v0
v_mul_u32_u24 v9, 4228, v9
v_lshl_add_u32 v8, v8, 2, v9
v_lshl_add_u32 v8, v7, 4, v8
s_add_u32 s64, s33, 9280
v_add_u32 v8, s64, v8
v_add_u32 v5, s33, v236
s_lshl_b32 s64, s29, 12
s_add_u32 s40, s22, s64
s_addc_u32 s41, s23, 0
s_mov_b32 s42, 4096
s_mov_b32 s43, 0x20000
s_cmp_eq_u32 s28, 0
s_cselect_b32 s75, 4194304, 0
s_add_u32 s64, s64, s75
s_add_u32 s52, s22, s64
s_addc_u32 s53, s23, 0
s_mov_b32 s54, 4096
s_mov_b32 s55, 0x20000
s_waitcnt vmcnt(0)
v_cmp_ne_u32 vcc, s27, v13
s_nop 4
s_cbranch_vccnz Lr_8
Lrj_9:
buffer_load_dwordx4 v[16:19], v236, s[40:43], 0 offen offset:0 sc1
buffer_load_dwordx4 v[20:23], v236, s[40:43], 0 offen offset:1024 sc1
buffer_load_dwordx4 v[24:27], v236, s[40:43], 0 offen offset:2048 sc1
buffer_load_dwordx4 v[28:31], v236, s[40:43], 0 offen offset:3072 sc1
s_add_u32 s44, s22, 8388608
s_addc_u32 s45, s23, 0
s_mov_b32 s46, 4194304
s_mov_b32 s47, 0x20000
s_waitcnt lgkmcnt(0)
s_mov_b32 s66, 0
buffer_store_dwordx4 v[204:207], v224, s[44:47], s66 offen sc1
s_mov_b32 s66, 524288
buffer_store_dwordx4 v[208:211], v224, s[44:47], s66 offen sc1
s_mov_b32 s66, 1048576
buffer_store_dwordx4 v[212:215], v224, s[44:47], s66 offen sc1
s_mov_b32 s66, 1572864
buffer_store_dwordx4 v[216:219], v224, s[44:47], s66 offen sc1
v_and_b32 v9, 15, v0
v_cmp_eq_u32 vcc, 15, v9
s_nop 1
v_cndmask_b32 v9, 0, v227, vcc
ds_write_b32 v11, v9 offset:9280
s_waitcnt vmcnt(4)
v_mov_b32_dpp v32, v16 wave_shl:1 row_mask:0xf bank_mask:0xf bound_ctrl:0
v_readlane_b32 s64, v20, 0
s_nop 1
v_writelane_b32 v32, s64, 63
v_mov_b32_dpp v33, v20 wave_shl:1 row_mask:0xf bank_mask:0xf bound_ctrl:0
v_readlane_b32 s64, v24, 0
s_nop 1
v_writelane_b32 v33, s64, 63
v_mov_b32_dpp v34, v24 wave_shl:1 row_mask:0xf bank_mask:0xf bound_ctrl:0
v_readlane_b32 s64, v28, 0
s_nop 1
v_writelane_b32 v34, s64, 63
v_mov_b32_dpp v35, v28 wave_shl:1 row_mask:0xf bank_mask:0xf bound_ctrl:0
ds_write_b128 v5, v[16:19] offset:4640
v_alignbit_b32 v44, v17, v16, 16
v_alignbit_b32 v45, v18, v17, 16
v_alignbit_b32 v46, v19, v18, 16
v_alignbit_b32 v47, v32, v19, 16
ds_write_b128 v5, v[44:47] offset:0
ds_write_b128 v5, v[20:23] offset:5664
v_alignbit_b32 v48, v21, v20, 16
v_alignbit_b32 v49, v22, v21, 16
v_alignbit_b32 v50, v23, v22, 16
v_alignbit_b32 v51, v33, v23, 16
ds_write_b128 v5, v[48:51] offset:1024
ds_write_b128 v5, v[24:27] offset:6688
v_alignbit_b32 v44, v25, v24, 16
v_alignbit_b32 v45, v26, v25, 16
v_alignbit_b32 v46, v27, v26, 16
v_alignbit_b32 v47, v34, v27, 16
ds_write_b128 v5, v[44:47] offset:2048
ds_write_b128 v5, v[28:31] offset:7712
v_alignbit_b32 v48, v29, v28, 16
v_alignbit_b32 v49, v30, v29, 16
v_alignbit_b32 v50, v31, v30, 16
v_alignbit_b32 v51, v35, v31, 16
ds_write_b128 v5, v[48:51] offset:3072
s_waitcnt lgkmcnt(0)
ds_read_b64 v[80:81], v8 offset:0
ds_read_b64 v[82:83], v8 offset:8
ds_read_b128 v[48:51], v6 offset:3584
ds_read_b64 v[84:85], v8 offset:512
ds_read_b64 v[86:87], v8 offset:520
ds_read_b128 v[52:55], v6 offset:3072
ds_read_b64 v[88:89], v8 offset:1024
ds_read_b64 v[90:91], v8 offset:1032
ds_read_b128 v[56:59], v6 offset:2560
ds_read_b64 v[92:93], v8 offset:1536
ds_read_b64 v[94:95], v8 offset:1544
ds_read_b128 v[60:63], v6 offset:2048
ds_read_b64 v[96:97], v8 offset:2048
ds_read_b64 v[98:99], v8 offset:2056
ds_read_b128 v[64:67], v6 offset:1536
ds_read_b64 v[100:101], v8 offset:2560
ds_read_b64 v[102:103], v8 offset:2568
ds_read_b128 v[68:71], v6 offset:1024
ds_read_b64 v[104:105], v8 offset:3072
ds_read_b64 v[106:107], v8 offset:3080
ds_read_b128 v[72:75], v6 offset:512
ds_read_b64 v[108:109], v8 offset:3584
ds_read_b64 v[110:111], v8 offset:3592
ds_read_b128 v[76:79], v6 offset:0
s_waitcnt lgkmcnt(0)
v_mfma_f32_16x16x32_bf16 v[16:19], v[48:51], v[80:83], 0
ds_read_b64 v[144:145], v8 offset:64
v_mfma_f32_16x16x32_bf16 v[20:23], v[52:55], v[80:83], 0
ds_read_b64 v[146:147], v8 offset:72
v_mfma_f32_16x16x32_bf16 v[24:27], v[56:59], v[80:83], 0
ds_read_b128 v[112:115], v6 offset:3648
v_mfma_f32_16x16x32_bf16 v[28:31], v[60:63], v[80:83], 0
ds_read_b64 v[148:149], v8 offset:576
v_mfma_f32_16x16x32_bf16 v[32:35], v[64:67], v[80:83], 0
ds_read_b64 v[150:151], v8 offset:584
v_mfma_f32_16x16x32_bf16 v[36:39], v[68:71], v[80:83], 0
ds_read_b128 v[116:119], v6 offset:3136
v_mfma_f32_16x16x32_bf16 v[40:43], v[72:75], v[80:83], 0
ds_read_b64 v[152:153], v8 offset:1088
v_mfma_f32_16x16x32_bf16 v[44:47], v[76:79], v[80:83], 0
ds_read_b64 v[154:155], v8 offset:1096
s_movk_i32 s68, 0x1000
s_mov_b32 s36, s4
s_mov_b32 s37, s5
s_mov_b32 s38, 4194304
s_mov_b32 s39, 0x20000
v_mfma_f32_16x16x32_bf16 v[20:23], v[48:51], v[84:87], v[20:23]
ds_read_b128 v[120:123], v6 offset:2624
buffer_load_dwordx4 v[240:243], v234, s[36:39], 0 offen offset:0 nt
v_mfma_f32_16x16x32_bf16 v[24:27], v[52:55], v[84:87], v[24:27]
ds_read_b64 v[156:157], v8 offset:1600
buffer_load_dwordx4 v[244:247], v234, s[36:39], 0 offen offset:2048 nt
v_mfma_f32_16x16x32_bf16 v[28:31], v[56:59], v[84:87], v[28:31]
ds_read_b64 v[158:159], v8 offset:1608
buffer_load_dwordx4 v[248:251], v234, s[36:39], s68 offen offset:0 nt
v_mfma_f32_16x16x32_bf16 v[32:35], v[60:63], v[84:87], v[32:35]
ds_read_b128 v[124:127], v6 offset:2112
buffer_load_dwordx4 v[252:255], v234, s[36:39], s68 offen offset:2048 nt
v_mfma_f32_16x16x32_bf16 v[36:39], v[64:67], v[84:87], v[36:39]
ds_read_b64 v[160:161], v8 offset:2112
v_mfma_f32_16x16x32_bf16 v[40:43], v[68:71], v[84:87], v[40:43]
ds_read_b64 v[162:163], v8 offset:2120
v_mfma_f32_16x16x32_bf16 v[44:47], v[72:75], v[84:87], v[44:47]
ds_read_b128 v[128:131], v6 offset:1600
v_mfma_f32_16x16x32_bf16 v[24:27], v[48:51], v[88:91], v[24:27]
ds_read_b64 v[164:165], v8 offset:2624
v_mfma_f32_16x16x32_bf16 v[28:31], v[52:55], v[88:91], v[28:31]
ds_read_b64 v[166:167], v8 offset:2632
v_mfma_f32_16x16x32_bf16 v[32:35], v[56:59], v[88:91], v[32:35]
ds_read_b128 v[132:135], v6 offset:1088
v_mfma_f32_16x16x32_bf16 v[36:39], v[60:63], v[88:91], v[36:39]
ds_read_b64 v[168:169], v8 offset:3136
v_mfma_f32_16x16x32_bf16 v[40:43], v[64:67], v[88:91], v[40:43]
ds_read_b64 v[170:171], v8 offset:3144
v_mfma_f32_16x16x32_bf16 v[44:47], v[68:71], v[88:91], v[44:47]
ds_read_b128 v[136:139], v6 offset:576
v_mfma_f32_16x16x32_bf16 v[28:31], v[48:51], v[92:95], v[28:31]
ds_read_b64 v[172:173], v8 offset:3648
v_mfma_f32_16x16x32_bf16 v[32:35], v[52:55], v[92:95], v[32:35]
ds_read_b64 v[174:175], v8 offset:3656
v_mfma_f32_16x16x32_bf16 v[36:39], v[56:59], v[92:95], v[36:39]
ds_read_b128 v[140:143], v6 offset:64
v_mfma_f32_16x16x32_bf16 v[40:43], v[60:63], v[92:95], v[40:43]
v_mfma_f32_16x16x32_bf16 v[44:47], v[64:67], v[92:95], v[44:47]
v_mfma_f32_16x16x32_bf16 v[32:35], v[48:51], v[96:99], v[32:35]
v_mfma_f32_16x16x32_bf16 v[36:39], v[52:55], v[96:99], v[36:39]
v_mfma_f32_16x16x32_bf16 v[40:43], v[56:59], v[96:99], v[40:43]
v_mfma_f32_16x16x32_bf16 v[44:47], v[60:63], v[96:99], v[44:47]
v_mfma_f32_16x16x32_bf16 v[36:39], v[48:51], v[100:103], v[36:39]
v_mfma_f32_16x16x32_bf16 v[40:43], v[52:55], v[100:103], v[40:43]
v_mfma_f32_16x16x32_bf16 v[44:47], v[56:59], v[100:103], v[44:47]
v_mfma_f32_16x16x32_bf16 v[40:43], v[48:51], v[104:107], v[40:43]
v_mfma_f32_16x16x32_bf16 v[44:47], v[52:55], v[104:107], v[44:47]
v_mfma_f32_16x16x32_bf16 v[44:47], v[48:51], v[108:111], v[44:47]
s_waitcnt lgkmcnt(0)
v_mfma_f32_16x16x32_bf16 v[16:19], v[112:115], v[144:147], v[16:19]
ds_read_b64 v[80:81], v8 offset:128
v_mfma_f32_16x16x32_bf16 v[20:23], v[116:119], v[144:147], v[20:23]
ds_read_b64 v[82:83], v8 offset:136
v_mfma_f32_16x16x32_bf16 v[24:27], v[120:123], v[144:147], v[24:27]
ds_read_b128 v[48:51], v6 offset:3712
v_mfma_f32_16x16x32_bf16 v[28:31], v[124:127], v[144:147], v[28:31]
ds_read_b64 v[84:85], v8 offset:640
v_mfma_f32_16x16x32_bf16 v[32:35], v[128:131], v[144:147], v[32:35]
ds_read_b64 v[86:87], v8 offset:648
v_mfma_f32_16x16x32_bf16 v[36:39], v[132:135], v[144:147], v[36:39]
ds_read_b128 v[52:55], v6 offset:3200
v_mfma_f32_16x16x32_bf16 v[40:43], v[136:139], v[144:147], v[40:43]
ds_read_b64 v[88:89], v8 offset:1152
v_mfma_f32_16x16x32_bf16 v[44:47], v[140:143], v[144:147], v[44:47]
ds_read_b64 v[90:91], v8 offset:1160
s_lshl_b32 s64, s26, 10
s_lshl_b32 s65, s3, 12
s_add_u32 s65, s65, s64
v_mfma_f32_16x16x32_bf16 v[20:23], v[112:115], v[148:151], v[20:23]
ds_read_b128 v[56:59], v6 offset:2688
s_add_u32 m0, s64, 138240
s_add_u32 s66, s65, 20480
buffer_load_dwordx4 v236, s[60:63], s66 offen lds
v_mfma_f32_16x16x32_bf16 v[24:27], v[116:119], v[148:151], v[24:27]
ds_read_b64 v[92:93], v8 offset:1664
s_add_u32 m0, s64, 142336
s_add_u32 s66, s65, 36864
buffer_load_dwordx4 v236, s[60:63], s66 offen lds
v_mfma_f32_16x16x32_bf16 v[28:31], v[120:123], v[148:151], v[28:31]
ds_read_b64 v[94:95], v8 offset:1672
s_add_u32 m0, s64, 146432
s_add_u32 s66, s64, 53248
buffer_load_dwordx4 v236, s[60:63], s66 offen lds
v_mfma_f32_16x16x32_bf16 v[32:35], v[124:127], v[148:151], v[32:35]
ds_read_b128 v[60:63], v6 offset:2176
v_mfma_f32_16x16x32_bf16 v[36:39], v[128:131], v[148:151], v[36:39]
ds_read_b64 v[96:97], v8 offset:2176
v_mfma_f32_16x16x32_bf16 v[40:43], v[132:135], v[148:151], v[40:43]
ds_read_b64 v[98:99], v8 offset:2184
v_mfma_f32_16x16x32_bf16 v[44:47], v[136:139], v[148:151], v[44:47]
ds_read_b128 v[64:67], v6 offset:1664
v_mfma_f32_16x16x32_bf16 v[24:27], v[112:115], v[152:155], v[24:27]
ds_read_b64 v[100:101], v8 offset:2688
v_mfma_f32_16x16x32_bf16 v[28:31], v[116:119], v[152:155], v[28:31]
ds_read_b64 v[102:103], v8 offset:2696
v_mfma_f32_16x16x32_bf16 v[32:35], v[120:123], v[152:155], v[32:35]
ds_read_b128 v[68:71], v6 offset:1152
v_mfma_f32_16x16x32_bf16 v[36:39], v[124:127], v[152:155], v[36:39]
ds_read_b64 v[104:105], v8 offset:3200
v_mfma_f32_16x16x32_bf16 v[40:43], v[128:131], v[152:155], v[40:43]
ds_read_b64 v[106:107], v8 offset:3208
v_mfma_f32_16x16x32_bf16 v[44:47], v[132:135], v[152:155], v[44:47]
ds_read_b128 v[72:75], v6 offset:640
v_mfma_f32_16x16x32_bf16 v[28:31], v[112:115], v[156:159], v[28:31]
ds_read_b64 v[108:109], v8 offset:3712
v_mfma_f32_16x16x32_bf16 v[32:35], v[116:119], v[156:159], v[32:35]
ds_read_b64 v[110:111], v8 offset:3720
v_mfma_f32_16x16x32_bf16 v[36:39], v[120:123], v[156:159], v[36:39]
ds_read_b128 v[76:79], v6 offset:128
v_mfma_f32_16x16x32_bf16 v[40:43], v[124:127], v[156:159], v[40:43]
v_mfma_f32_16x16x32_bf16 v[44:47], v[128:131], v[156:159], v[44:47]
v_mfma_f32_16x16x32_bf16 v[32:35], v[112:115], v[160:163], v[32:35]
v_mfma_f32_16x16x32_bf16 v[36:39], v[116:119], v[160:163], v[36:39]
v_mfma_f32_16x16x32_bf16 v[40:43], v[120:123], v[160:163], v[40:43]
v_mfma_f32_16x16x32_bf16 v[44:47], v[124:127], v[160:163], v[44:47]
v_mfma_f32_16x16x32_bf16 v[36:39], v[112:115], v[164:167], v[36:39]
v_mfma_f32_16x16x32_bf16 v[40:43], v[116:119], v[164:167], v[40:43]
v_mfma_f32_16x16x32_bf16 v[44:47], v[120:123], v[164:167], v[44:47]
v_mfma_f32_16x16x32_bf16 v[40:43], v[112:115], v[168:171], v[40:43]
v_mfma_f32_16x16x32_bf16 v[44:47], v[116:119], v[168:171], v[44:47]
v_mfma_f32_16x16x32_bf16 v[44:47], v[112:115], v[172:175], v[44:47]
s_waitcnt lgkmcnt(0)
s_waitcnt vmcnt(7)
v_mov_b32 v9, 150528
v_mov_b32 v12, 1
v_mov_b32 v10, s27
s_mov_b64 exec, 1
ds_add_rtn_u32 v12, v9, v12
s_waitcnt lgkmcnt(0)
v_readfirstlane_b32 s64, v12
s_nop 0
s_cmp_lg_u32 s64, 3
s_cbranch_scc1 Lf2_12
s_lshr_b32 s64, s2, 4
s_lshl_b32 s64, s64, 7
s_and_b32 s65, s2, 15
s_lshl_b32 s65, s65, 2
s_add_u32 s64, s64, s65
s_add_u32 s64, s64, 16384
v_mov_b32 v9, s64
buffer_store_dword v10, v9, s[56:59], 0 offen sc1
Lf2_12:
s_mov_b64 exec, -1
v_mfma_f32_16x16x32_bf16 v[16:19], v[48:51], v[80:83], v[16:19]
ds_read_b64 v[144:145], v8 offset:192
v_mfma_f32_16x16x32_bf16 v[20:23], v[52:55], v[80:83], v[20:23]
ds_read_b64 v[146:147], v8 offset:200
v_mfma_f32_16x16x32_bf16 v[24:27], v[56:59], v[80:83], v[24:27]
ds_read_b128 v[112:115], v6 offset:3776
v_mfma_f32_16x16x32_bf16 v[28:31], v[60:63], v[80:83], v[28:31]
ds_read_b64 v[148:149], v8 offset:704
v_mfma_f32_16x16x32_bf16 v[32:35], v[64:67], v[80:83], v[32:35]
ds_read_b64 v[150:151], v8 offset:712
v_mfma_f32_16x16x32_bf16 v[36:39], v[68:71], v[80:83], v[36:39]
ds_read_b128 v[116:119], v6 offset:3264
v_mfma_f32_16x16x32_bf16 v[40:43], v[72:75], v[80:83], v[40:43]
ds_read_b64 v[152:153], v8 offset:1216
v_mfma_f32_16x16x32_bf16 v[44:47], v[76:79], v[80:83], v[44:47]
ds_read_b64 v[154:155], v8 offset:1224
v_mfma_f32_16x16x32_bf16 v[20:23], v[48:51], v[84:87], v[20:23]
ds_read_b128 v[120:123], v6 offset:2752
v_mfma_f32_16x16x32_bf16 v[24:27], v[52:55], v[84:87], v[24:27]
ds_read_b64 v[156:157], v8 offset:1728
v_mfma_f32_16x16x32_bf16 v[28:31], v[56:59], v[84:87], v[28:31]
ds_read_b64 v[158:159], v8 offset:1736
v_mfma_f32_16x16x32_bf16 v[32:35], v[60:63], v[84:87], v[32:35]
ds_read_b128 v[124:127], v6 offset:2240
v_mfma_f32_16x16x32_bf16 v[36:39], v[64:67], v[84:87], v[36:39]
ds_read_b64 v[160:161], v8 offset:2240
v_mfma_f32_16x16x32_bf16 v[40:43], v[68:71], v[84:87], v[40:43]
ds_read_b64 v[162:163], v8 offset:2248
v_mfma_f32_16x16x32_bf16 v[44:47], v[72:75], v[84:87], v[44:47]
ds_read_b128 v[128:131], v6 offset:1728
v_mfma_f32_16x16x32_bf16 v[24:27], v[48:51], v[88:91], v[24:27]
ds_read_b64 v[164:165], v8 offset:2752
v_mfma_f32_16x16x32_bf16 v[28:31], v[52:55], v[88:91], v[28:31]
ds_read_b64 v[166:167], v8 offset:2760
v_mfma_f32_16x16x32_bf16 v[32:35], v[56:59], v[88:91], v[32:35]
ds_read_b128 v[132:135], v6 offset:1216
v_mfma_f32_16x16x32_bf16 v[36:39], v[60:63], v[88:91], v[36:39]
ds_read_b64 v[168:169], v8 offset:3264
v_mfma_f32_16x16x32_bf16 v[40:43], v[64:67], v[88:91], v[40:43]
ds_read_b64 v[170:171], v8 offset:3272
v_mfma_f32_16x16x32_bf16 v[44:47], v[68:71], v[88:91], v[44:47]
ds_read_b128 v[136:139], v6 offset:704
v_mfma_f32_16x16x32_bf16 v[28:31], v[48:51], v[92:95], v[28:31]
ds_read_b64 v[172:173], v8 offset:3776
v_mfma_f32_16x16x32_bf16 v[32:35], v[52:55], v[92:95], v[32:35]
ds_read_b64 v[174:175], v8 offset:3784
v_mfma_f32_16x16x32_bf16 v[36:39], v[56:59], v[92:95], v[36:39]
ds_read_b128 v[140:143], v6 offset:192
v_mfma_f32_16x16x32_bf16 v[40:43], v[60:63], v[92:95], v[40:43]
v_mfma_f32_16x16x32_bf16 v[44:47], v[64:67], v[92:95], v[44:47]
v_mfma_f32_16x16x32_bf16 v[32:35], v[48:51], v[96:99], v[32:35]
v_mfma_f32_16x16x32_bf16 v[36:39], v[52:55], v[96:99], v[36:39]
v_mfma_f32_16x16x32_bf16 v[40:43], v[56:59], v[96:99], v[40:43]
v_mfma_f32_16x16x32_bf16 v[44:47], v[60:63], v[96:99], v[44:47]
v_mfma_f32_16x16x32_bf16 v[36:39], v[48:51], v[100:103], v[36:39]
v_mfma_f32_16x16x32_bf16 v[40:43], v[52:55], v[100:103], v[40:43]
v_mfma_f32_16x16x32_bf16 v[44:47], v[56:59], v[100:103], v[44:47]
v_mfma_f32_16x16x32_bf16 v[40:43], v[48:51], v[104:107], v[40:43]
v_mfma_f32_16x16x32_bf16 v[44:47], v[52:55], v[104:107], v[44:47]
v_mfma_f32_16x16x32_bf16 v[44:47], v[48:51], v[108:111], v[44:47]
s_waitcnt lgkmcnt(0)
v_mfma_f32_16x16x32_bf16 v[16:19], v[112:115], v[144:147], v[16:19]
ds_read_b64 v[80:81], v8 offset:256
v_mfma_f32_16x16x32_bf16 v[20:23], v[116:119], v[144:147], v[20:23]
ds_read_b64 v[82:83], v8 offset:264
v_mfma_f32_16x16x32_bf16 v[24:27], v[120:123], v[144:147], v[24:27]
ds_read_b128 v[48:51], v6 offset:3840
v_mfma_f32_16x16x32_bf16 v[28:31], v[124:127], v[144:147], v[28:31]
ds_read_b64 v[84:85], v8 offset:768
v_mfma_f32_16x16x32_bf16 v[32:35], v[128:131], v[144:147], v[32:35]
ds_read_b64 v[86:87], v8 offset:776
v_mfma_f32_16x16x32_bf16 v[36:39], v[132:135], v[144:147], v[36:39]
ds_read_b128 v[52:55], v6 offset:3328
v_mfma_f32_16x16x32_bf16 v[40:43], v[136:139], v[144:147], v[40:43]
ds_read_b64 v[88:89], v8 offset:1280
v_mfma_f32_16x16x32_bf16 v[44:47], v[140:143], v[144:147], v[44:47]
ds_read_b64 v[90:91], v8 offset:1288
v_mfma_f32_16x16x32_bf16 v[20:23], v[112:115], v[148:151], v[20:23]
ds_read_b128 v[56:59], v6 offset:2816
v_mfma_f32_16x16x32_bf16 v[24:27], v[116:119], v[148:151], v[24:27]
ds_read_b64 v[92:93], v8 offset:1792
v_mfma_f32_16x16x32_bf16 v[28:31], v[120:123], v[148:151], v[28:31]
ds_read_b64 v[94:95], v8 offset:1800
v_mfma_f32_16x16x32_bf16 v[32:35], v[124:127], v[148:151], v[32:35]
ds_read_b128 v[60:63], v6 offset:2304
v_mfma_f32_16x16x32_bf16 v[36:39], v[128:131], v[148:151], v[36:39]
ds_read_b64 v[96:97], v8 offset:2304
v_mfma_f32_16x16x32_bf16 v[40:43], v[132:135], v[148:151], v[40:43]
ds_read_b64 v[98:99], v8 offset:2312
v_mfma_f32_16x16x32_bf16 v[44:47], v[136:139], v[148:151], v[44:47]
ds_read_b128 v[64:67], v6 offset:1792
v_mfma_f32_16x16x32_bf16 v[24:27], v[112:115], v[152:155], v[24:27]
ds_read_b64 v[100:101], v8 offset:2816
v_mfma_f32_16x16x32_bf16 v[28:31], v[116:119], v[152:155], v[28:31]
ds_read_b64 v[102:103], v8 offset:2824
v_mfma_f32_16x16x32_bf16 v[32:35], v[120:123], v[152:155], v[32:35]
ds_read_b128 v[68:71], v6 offset:1280
v_mfma_f32_16x16x32_bf16 v[36:39], v[124:127], v[152:155], v[36:39]
ds_read_b64 v[104:105], v8 offset:3328
v_mfma_f32_16x16x32_bf16 v[40:43], v[128:131], v[152:155], v[40:43]
ds_read_b64 v[106:107], v8 offset:3336
v_mfma_f32_16x16x32_bf16 v[44:47], v[132:135], v[152:155], v[44:47]
ds_read_b128 v[72:75], v6 offset:768
v_mfma_f32_16x16x32_bf16 v[28:31], v[112:115], v[156:159], v[28:31]
ds_read_b64 v[108:109], v8 offset:3840
v_mfma_f32_16x16x32_bf16 v[32:35], v[116:119], v[156:159], v[32:35]
ds_read_b64 v[110:111], v8 offset:3848
v_mfma_f32_16x16x32_bf16 v[36:39], v[120:123], v[156:159], v[36:39]
ds_read_b128 v[76:79], v6 offset:256
v_mfma_f32_16x16x32_bf16 v[40:43], v[124:127], v[156:159], v[40:43]
v_mfma_f32_16x16x32_bf16 v[44:47], v[128:131], v[156:159], v[44:47]
v_mfma_f32_16x16x32_bf16 v[32:35], v[112:115], v[160:163], v[32:35]
v_mfma_f32_16x16x32_bf16 v[36:39], v[116:119], v[160:163], v[36:39]
v_mfma_f32_16x16x32_bf16 v[40:43], v[120:123], v[160:163], v[40:43]
v_mfma_f32_16x16x32_bf16 v[44:47], v[124:127], v[160:163], v[44:47]
v_mfma_f32_16x16x32_bf16 v[36:39], v[112:115], v[164:167], v[36:39]
v_mfma_f32_16x16x32_bf16 v[40:43], v[116:119], v[164:167], v[40:43]
v_mfma_f32_16x16x32_bf16 v[44:47], v[120:123], v[164:167], v[44:47]
v_mfma_f32_16x16x32_bf16 v[40:43], v[112:115], v[168:171], v[40:43]
v_mfma_f32_16x16x32_bf16 v[44:47], v[116:119], v[168:171], v[44:47]
v_mfma_f32_16x16x32_bf16 v[44:47], v[112:115], v[172:175], v[44:47]
s_waitcnt lgkmcnt(0)
v_mfma_f32_16x16x32_bf16 v[16:19], v[48:51], v[80:83], v[16:19]
ds_read_b64 v[144:145], v8 offset:320
v_mfma_f32_16x16x32_bf16 v[20:23], v[52:55], v[80:83], v[20:23]
ds_read_b64 v[146:147], v8 offset:328
v_mfma_f32_16x16x32_bf16 v[24:27], v[56:59], v[80:83], v[24:27]
ds_read_b128 v[112:115], v6 offset:3904
v_mfma_f32_16x16x32_bf16 v[28:31], v[60:63], v[80:83], v[28:31]
ds_read_b64 v[148:149], v8 offset:832
v_mfma_f32_16x16x32_bf16 v[32:35], v[64:67], v[80:83], v[32:35]
ds_read_b64 v[150:151], v8 offset:840
v_mfma_f32_16x16x32_bf16 v[36:39], v[68:71], v[80:83], v[36:39]
ds_read_b128 v[116:119], v6 offset:3392
v_mfma_f32_16x16x32_bf16 v[40:43], v[72:75], v[80:83], v[40:43]
ds_read_b64 v[152:153], v8 offset:1344
v_mfma_f32_16x16x32_bf16 v[44:47], v[76:79], v[80:83], v[44:47]
ds_read_b64 v[154:155], v8 offset:1352
v_mfma_f32_16x16x32_bf16 v[20:23], v[48:51], v[84:87], v[20:23]
ds_read_b128 v[120:123], v6 offset:2880
v_mfma_f32_16x16x32_bf16 v[24:27], v[52:55], v[84:87], v[24:27]
ds_read_b64 v[156:157], v8 offset:1856
v_mfma_f32_16x16x32_bf16 v[28:31], v[56:59], v[84:87], v[28:31]
ds_read_b64 v[158:159], v8 offset:1864
v_mfma_f32_16x16x32_bf16 v[32:35], v[60:63], v[84:87], v[32:35]
ds_read_b128 v[124:127], v6 offset:2368
v_mfma_f32_16x16x32_bf16 v[36:39], v[64:67], v[84:87], v[36:39]
ds_read_b64 v[160:161], v8 offset:2368
v_mfma_f32_16x16x32_bf16 v[40:43], v[68:71], v[84:87], v[40:43]
ds_read_b64 v[162:163], v8 offset:2376
v_mfma_f32_16x16x32_bf16 v[44:47], v[72:75], v[84:87], v[44:47]
ds_read_b128 v[128:131], v6 offset:1856
v_mfma_f32_16x16x32_bf16 v[24:27], v[48:51], v[88:91], v[24:27]
ds_read_b64 v[164:165], v8 offset:2880
v_mfma_f32_16x16x32_bf16 v[28:31], v[52:55], v[88:91], v[28:31]
ds_read_b64 v[166:167], v8 offset:2888
v_mfma_f32_16x16x32_bf16 v[32:35], v[56:59], v[88:91], v[32:35]
ds_read_b128 v[132:135], v6 offset:1344
v_mfma_f32_16x16x32_bf16 v[36:39], v[60:63], v[88:91], v[36:39]
ds_read_b64 v[168:169], v8 offset:3392
v_mfma_f32_16x16x32_bf16 v[40:43], v[64:67], v[88:91], v[40:43]
ds_read_b64 v[170:171], v8 offset:3400
v_mfma_f32_16x16x32_bf16 v[44:47], v[68:71], v[88:91], v[44:47]
ds_read_b128 v[136:139], v6 offset:832
v_mfma_f32_16x16x32_bf16 v[28:31], v[48:51], v[92:95], v[28:31]
ds_read_b64 v[172:173], v8 offset:3904
v_mfma_f32_16x16x32_bf16 v[32:35], v[52:55], v[92:95], v[32:35]
ds_read_b64 v[174:175], v8 offset:3912
v_mfma_f32_16x16x32_bf16 v[36:39], v[56:59], v[92:95], v[36:39]
ds_read_b128 v[140:143], v6 offset:320
v_mfma_f32_16x16x32_bf16 v[40:43], v[60:63], v[92:95], v[40:43]
v_mfma_f32_16x16x32_bf16 v[44:47], v[64:67], v[92:95], v[44:47]
v_mfma_f32_16x16x32_bf16 v[32:35], v[48:51], v[96:99], v[32:35]
v_mfma_f32_16x16x32_bf16 v[36:39], v[52:55], v[96:99], v[36:39]
v_mfma_f32_16x16x32_bf16 v[40:43], v[56:59], v[96:99], v[40:43]
v_mfma_f32_16x16x32_bf16 v[44:47], v[60:63], v[96:99], v[44:47]
v_mfma_f32_16x16x32_bf16 v[36:39], v[48:51], v[100:103], v[36:39]
v_mfma_f32_16x16x32_bf16 v[40:43], v[52:55], v[100:103], v[40:43]
v_mfma_f32_16x16x32_bf16 v[44:47], v[56:59], v[100:103], v[44:47]
v_mfma_f32_16x16x32_bf16 v[40:43], v[48:51], v[104:107], v[40:43]
v_mfma_f32_16x16x32_bf16 v[44:47], v[52:55], v[104:107], v[44:47]
v_mfma_f32_16x16x32_bf16 v[44:47], v[48:51], v[108:111], v[44:47]
s_waitcnt lgkmcnt(0)
v_mfma_f32_16x16x32_bf16 v[16:19], v[112:115], v[144:147], v[16:19]
ds_read_b64 v[80:81], v8 offset:384
v_mfma_f32_16x16x32_bf16 v[20:23], v[116:119], v[144:147], v[20:23]
ds_read_b64 v[82:83], v8 offset:392
v_mfma_f32_16x16x32_bf16 v[24:27], v[120:123], v[144:147], v[24:27]
ds_read_b128 v[48:51], v6 offset:3968
v_mfma_f32_16x16x32_bf16 v[28:31], v[124:127], v[144:147], v[28:31]
ds_read_b64 v[84:85], v8 offset:896
v_mfma_f32_16x16x32_bf16 v[32:35], v[128:131], v[144:147], v[32:35]
ds_read_b64 v[86:87], v8 offset:904
v_mfma_f32_16x16x32_bf16 v[36:39], v[132:135], v[144:147], v[36:39]
ds_read_b128 v[52:55], v6 offset:3456
v_mfma_f32_16x16x32_bf16 v[40:43], v[136:139], v[144:147], v[40:43]
ds_read_b64 v[88:89], v8 offset:1408
v_mfma_f32_16x16x32_bf16 v[44:47], v[140:143], v[144:147], v[44:47]
ds_read_b64 v[90:91], v8 offset:1416
v_mfma_f32_16x16x32_bf16 v[20:23], v[112:115], v[148:151], v[20:23]
ds_read_b128 v[56:59], v6 offset:2944
v_mfma_f32_16x16x32_bf16 v[24:27], v[116:119], v[148:151], v[24:27]
ds_read_b64 v[92:93], v8 offset:1920
v_mfma_f32_16x16x32_bf16 v[28:31], v[120:123], v[148:151], v[28:31]
ds_read_b64 v[94:95], v8 offset:1928
v_mfma_f32_16x16x32_bf16 v[32:35], v[124:127], v[148:151], v[32:35]
ds_read_b128 v[60:63], v6 offset:2432
v_mfma_f32_16x16x32_bf16 v[36:39], v[128:131], v[148:151], v[36:39]
ds_read_b64 v[96:97], v8 offset:2432
v_mfma_f32_16x16x32_bf16 v[40:43], v[132:135], v[148:151], v[40:43]
ds_read_b64 v[98:99], v8 offset:2440
v_mfma_f32_16x16x32_bf16 v[44:47], v[136:139], v[148:151], v[44:47]
ds_read_b128 v[64:67], v6 offset:1920
v_mfma_f32_16x16x32_bf16 v[24:27], v[112:115], v[152:155], v[24:27]
ds_read_b64 v[100:101], v8 offset:2944
v_mfma_f32_16x16x32_bf16 v[28:31], v[116:119], v[152:155], v[28:31]
ds_read_b64 v[102:103], v8 offset:2952
v_mfma_f32_16x16x32_bf16 v[32:35], v[120:123], v[152:155], v[32:35]
ds_read_b128 v[68:71], v6 offset:1408
v_mfma_f32_16x16x32_bf16 v[36:39], v[124:127], v[152:155], v[36:39]
ds_read_b64 v[104:105], v8 offset:3456
v_mfma_f32_16x16x32_bf16 v[40:43], v[128:131], v[152:155], v[40:43]
ds_read_b64 v[106:107], v8 offset:3464
v_mfma_f32_16x16x32_bf16 v[44:47], v[132:135], v[152:155], v[44:47]
ds_read_b128 v[72:75], v6 offset:896
v_mfma_f32_16x16x32_bf16 v[28:31], v[112:115], v[156:159], v[28:31]
ds_read_b64 v[108:109], v8 offset:3968
v_mfma_f32_16x16x32_bf16 v[32:35], v[116:119], v[156:159], v[32:35]
ds_read_b64 v[110:111], v8 offset:3976
v_mfma_f32_16x16x32_bf16 v[36:39], v[120:123], v[156:159], v[36:39]
ds_read_b128 v[76:79], v6 offset:384
v_mfma_f32_16x16x32_bf16 v[40:43], v[124:127], v[156:159], v[40:43]
v_mfma_f32_16x16x32_bf16 v[44:47], v[128:131], v[156:159], v[44:47]
v_mfma_f32_16x16x32_bf16 v[32:35], v[112:115], v[160:163], v[32:35]
v_mfma_f32_16x16x32_bf16 v[36:39], v[116:119], v[160:163], v[36:39]
v_mfma_f32_16x16x32_bf16 v[40:43], v[120:123], v[160:163], v[40:43]
v_mfma_f32_16x16x32_bf16 v[44:47], v[124:127], v[160:163], v[44:47]
v_mfma_f32_16x16x32_bf16 v[36:39], v[112:115], v[164:167], v[36:39]
v_mfma_f32_16x16x32_bf16 v[40:43], v[116:119], v[164:167], v[40:43]
v_mfma_f32_16x16x32_bf16 v[44:47], v[120:123], v[164:167], v[44:47]
v_mfma_f32_16x16x32_bf16 v[40:43], v[112:115], v[168:171], v[40:43]
v_mfma_f32_16x16x32_bf16 v[44:47], v[116:119], v[168:171], v[44:47]
v_mfma_f32_16x16x32_bf16 v[44:47], v[112:115], v[172:175], v[44:47]
s_waitcnt lgkmcnt(0)
v_mfma_f32_16x16x32_bf16 v[16:19], v[48:51], v[80:83], v[16:19]
ds_read_b64 v[144:145], v8 offset:448
v_mfma_f32_16x16x32_bf16 v[20:23], v[52:55], v[80:83], v[20:23]
ds_read_b64 v[146:147], v8 offset:456
v_mfma_f32_16x16x32_bf16 v[24:27], v[56:59], v[80:83], v[24:27]
ds_read_b128 v[112:115], v6 offset:4032
v_mfma_f32_16x16x32_bf16 v[28:31], v[60:63], v[80:83], v[28:31]
ds_read_b64 v[148:149], v8 offset:960
v_mfma_f32_16x16x32_bf16 v[32:35], v[64:67], v[80:83], v[32:35]
ds_read_b64 v[150:151], v8 offset:968
v_mfma_f32_16x16x32_bf16 v[36:39], v[68:71], v[80:83], v[36:39]
ds_read_b128 v[116:119], v6 offset:3520
v_mfma_f32_16x16x32_bf16 v[40:43], v[72:75], v[80:83], v[40:43]
ds_read_b64 v[152:153], v8 offset:1472
v_mfma_f32_16x16x32_bf16 v[44:47], v[76:79], v[80:83], v[44:47]
ds_read_b64 v[154:155], v8 offset:1480
v_mfma_f32_16x16x32_bf16 v[20:23], v[48:51], v[84:87], v[20:23]
ds_read_b128 v[120:123], v6 offset:3008
v_mfma_f32_16x16x32_bf16 v[24:27], v[52:55], v[84:87], v[24:27]
ds_read_b64 v[156:157], v8 offset:1984
v_mfma_f32_16x16x32_bf16 v[28:31], v[56:59], v[84:87], v[28:31]
ds_read_b64 v[158:159], v8 offset:1992
v_mfma_f32_16x16x32_bf16 v[32:35], v[60:63], v[84:87], v[32:35]
ds_read_b128 v[124:127], v6 offset:2496
v_mfma_f32_16x16x32_bf16 v[36:39], v[64:67], v[84:87], v[36:39]
ds_read_b64 v[160:161], v8 offset:2496
v_mfma_f32_16x16x32_bf16 v[40:43], v[68:71], v[84:87], v[40:43]
ds_read_b64 v[162:163], v8 offset:2504
v_mfma_f32_16x16x32_bf16 v[44:47], v[72:75], v[84:87], v[44:47]
ds_read_b128 v[128:131], v6 offset:1984
v_mfma_f32_16x16x32_bf16 v[24:27], v[48:51], v[88:91], v[24:27]
ds_read_b64 v[164:165], v8 offset:3008
v_mfma_f32_16x16x32_bf16 v[28:31], v[52:55], v[88:91], v[28:31]
ds_read_b64 v[166:167], v8 offset:3016
v_mfma_f32_16x16x32_bf16 v[32:35], v[56:59], v[88:91], v[32:35]
ds_read_b128 v[132:135], v6 offset:1472
v_mfma_f32_16x16x32_bf16 v[36:39], v[60:63], v[88:91], v[36:39]
ds_read_b64 v[168:169], v8 offset:3520
v_mfma_f32_16x16x32_bf16 v[40:43], v[64:67], v[88:91], v[40:43]
ds_read_b64 v[170:171], v8 offset:3528
v_mfma_f32_16x16x32_bf16 v[44:47], v[68:71], v[88:91], v[44:47]
ds_read_b128 v[136:139], v6 offset:960
v_mfma_f32_16x16x32_bf16 v[28:31], v[48:51], v[92:95], v[28:31]
ds_read_b64 v[172:173], v8 offset:4032
v_mfma_f32_16x16x32_bf16 v[32:35], v[52:55], v[92:95], v[32:35]
ds_read_b64 v[174:175], v8 offset:4040
v_mfma_f32_16x16x32_bf16 v[36:39], v[56:59], v[92:95], v[36:39]
ds_read_b128 v[140:143], v6 offset:448
v_mfma_f32_16x16x32_bf16 v[40:43], v[60:63], v[92:95], v[40:43]
v_mfma_f32_16x16x32_bf16 v[44:47], v[64:67], v[92:95], v[44:47]
v_mfma_f32_16x16x32_bf16 v[32:35], v[48:51], v[96:99], v[32:35]
v_mfma_f32_16x16x32_bf16 v[36:39], v[52:55], v[96:99], v[36:39]
v_mfma_f32_16x16x32_bf16 v[40:43], v[56:59], v[96:99], v[40:43]
v_mfma_f32_16x16x32_bf16 v[44:47], v[60:63], v[96:99], v[44:47]
v_mfma_f32_16x16x32_bf16 v[36:39], v[48:51], v[100:103], v[36:39]
v_mfma_f32_16x16x32_bf16 v[40:43], v[52:55], v[100:103], v[40:43]
v_mfma_f32_16x16x32_bf16 v[44:47], v[56:59], v[100:103], v[44:47]
v_mfma_f32_16x16x32_bf16 v[40:43], v[48:51], v[104:107], v[40:43]
v_mfma_f32_16x16x32_bf16 v[44:47], v[52:55], v[104:107], v[44:47]
v_mfma_f32_16x16x32_bf16 v[44:47], v[48:51], v[108:111], v[44:47]
s_waitcnt lgkmcnt(0)
v_mfma_f32_16x16x32_bf16 v[16:19], v[112:115], v[144:147], v[16:19]
v_mfma_f32_16x16x32_bf16 v[20:23], v[116:119], v[144:147], v[20:23]
v_mfma_f32_16x16x32_bf16 v[24:27], v[120:123], v[144:147], v[24:27]
v_mfma_f32_16x16x32_bf16 v[28:31], v[124:127], v[144:147], v[28:31]
v_mfma_f32_16x16x32_bf16 v[32:35], v[128:131], v[144:147], v[32:35]
v_mfma_f32_16x16x32_bf16 v[36:39], v[132:135], v[144:147], v[36:39]
v_mfma_f32_16x16x32_bf16 v[40:43], v[136:139], v[144:147], v[40:43]
v_mfma_f32_16x16x32_bf16 v[44:47], v[140:143], v[144:147], v[44:47]
v_mfma_f32_16x16x32_bf16 v[20:23], v[112:115], v[148:151], v[20:23]
v_mfma_f32_16x16x32_bf16 v[24:27], v[116:119], v[148:151], v[24:27]
v_mfma_f32_16x16x32_bf16 v[28:31], v[120:123], v[148:151], v[28:31]
v_mfma_f32_16x16x32_bf16 v[32:35], v[124:127], v[148:151], v[32:35]
v_mfma_f32_16x16x32_bf16 v[36:39], v[128:131], v[148:151], v[36:39]
v_mfma_f32_16x16x32_bf16 v[40:43], v[132:135], v[148:151], v[40:43]
v_mfma_f32_16x16x32_bf16 v[44:47], v[136:139], v[148:151], v[44:47]
v_mfma_f32_16x16x32_bf16 v[24:27], v[112:115], v[152:155], v[24:27]
v_mfma_f32_16x16x32_bf16 v[28:31], v[116:119], v[152:155], v[28:31]
v_mfma_f32_16x16x32_bf16 v[32:35], v[120:123], v[152:155], v[32:35]
v_mfma_f32_16x16x32_bf16 v[36:39], v[124:127], v[152:155], v[36:39]
v_mfma_f32_16x16x32_bf16 v[40:43], v[128:131], v[152:155], v[40:43]
v_mfma_f32_16x16x32_bf16 v[44:47], v[132:135], v[152:155], v[44:47]
v_mfma_f32_16x16x32_bf16 v[28:31], v[112:115], v[156:159], v[28:31]
v_mfma_f32_16x16x32_bf16 v[32:35], v[116:119], v[156:159], v[32:35]
v_mfma_f32_16x16x32_bf16 v[36:39], v[120:123], v[156:159], v[36:39]
v_mfma_f32_16x16x32_bf16 v[40:43], v[124:127], v[156:159], v[40:43]
v_mfma_f32_16x16x32_bf16 v[44:47], v[128:131], v[156:159], v[44:47]
v_mfma_f32_16x16x32_bf16 v[32:35], v[112:115], v[160:163], v[32:35]
v_mfma_f32_16x16x32_bf16 v[36:39], v[116:119], v[160:163], v[36:39]
v_mfma_f32_16x16x32_bf16 v[40:43], v[120:123], v[160:163], v[40:43]
v_mfma_f32_16x16x32_bf16 v[44:47], v[124:127], v[160:163], v[44:47]
v_mfma_f32_16x16x32_bf16 v[36:39], v[112:115], v[164:167], v[36:39]
v_mfma_f32_16x16x32_bf16 v[40:43], v[116:119], v[164:167], v[40:43]
v_mfma_f32_16x16x32_bf16 v[44:47], v[120:123], v[164:167], v[44:47]
v_mfma_f32_16x16x32_bf16 v[40:43], v[112:115], v[168:171], v[40:43]
v_mfma_f32_16x16x32_bf16 v[44:47], v[116:119], v[168:171], v[44:47]
v_mfma_f32_16x16x32_bf16 v[44:47], v[112:115], v[172:175], v[44:47]
s_mov_b32 s69, 0
v_and_b32 v2, 15, v0
v_lshrrev_b32 v3, 4, v0
v_lshlrev_b32 v4, 2, v2
v_lshl_add_u32 v4, v3, 7, v4
s_add_u32 s64, s33, 5084
v_sub_u32 v5, s64, v4
ds_read_b32 v48, v5 offset:3648
ds_read_b32 v49, v5 offset:3584
ds_read_b32 v50, v5 offset:3136
ds_read_b32 v51, v5 offset:3072
ds_read_b32 v52, v5 offset:2624
ds_read_b32 v53, v5 offset:2560
ds_read_b32 v54, v5 offset:2112
ds_read_b32 v55, v5 offset:2048
ds_read_b32 v56, v5 offset:1600
ds_read_b32 v57, v5 offset:1536
ds_read_b32 v58, v5 offset:1088
ds_read_b32 v59, v5 offset:1024
ds_read_b32 v60, v5 offset:576
ds_read_b32 v61, v5 offset:512
ds_read_b32 v62, v5 offset:64
ds_read_b32 v63, v5 offset:0
s_waitcnt lgkmcnt(8)
v_and_b32 v64, 0xffff0000, v48
v_lshlrev_b32 v65, 16, v48
v_and_b32 v66, 0xffff0000, v49
v_lshlrev_b32 v67, 16, v49
v_fmac_f32 v16, s34, v64
v_fmac_f32 v17, s34, v65
v_fmac_f32 v18, s34, v66
v_fmac_f32 v19, s34, v67
v_cvt_pk_bf16_f32 v80, v16, v17
v_cvt_pk_bf16_f32 v81, v18, v19
v_and_b32 v68, 0xffff0000, v50
v_lshlrev_b32 v69, 16, v50
v_and_b32 v70, 0xffff0000, v51
v_lshlrev_b32 v71, 16, v51
v_fmac_f32 v20, s34, v68
v_fmac_f32 v21, s34, v69
v_fmac_f32 v22, s34, v70
v_fmac_f32 v23, s34, v71
v_cvt_pk_bf16_f32 v82, v20, v21
v_cvt_pk_bf16_f32 v83, v22, v23
v_and_b32 v64, 0xffff0000, v52
v_lshlrev_b32 v65, 16, v52
v_and_b32 v66, 0xffff0000, v53
v_lshlrev_b32 v67, 16, v53
v_fmac_f32 v24, s34, v64
v_fmac_f32 v25, s34, v65
v_fmac_f32 v26, s34, v66
v_fmac_f32 v27, s34, v67
v_cvt_pk_bf16_f32 v84, v24, v25
v_cvt_pk_bf16_f32 v85, v26, v27
v_and_b32 v68, 0xffff0000, v54
v_lshlrev_b32 v69, 16, v54
v_and_b32 v70, 0xffff0000, v55
v_lshlrev_b32 v71, 16, v55
v_fmac_f32 v28, s34, v68
v_fmac_f32 v29, s34, v69
v_fmac_f32 v30, s34, v70
v_fmac_f32 v31, s34, v71
v_cvt_pk_bf16_f32 v86, v28, v29
v_cvt_pk_bf16_f32 v87, v30, v31
s_waitcnt lgkmcnt(0)
v_and_b32 v64, 0xffff0000, v56
v_lshlrev_b32 v65, 16, v56
v_and_b32 v66, 0xffff0000, v57
v_lshlrev_b32 v67, 16, v57
v_fmac_f32 v32, s34, v64
v_fmac_f32 v33, s34, v65
v_fmac_f32 v34, s34, v66
v_fmac_f32 v35, s34, v67
v_cvt_pk_bf16_f32 v88, v32, v33
v_cvt_pk_bf16_f32 v89, v34, v35
v_and_b32 v68, 0xffff0000, v58
v_lshlrev_b32 v69, 16, v58
v_and_b32 v70, 0xffff0000, v59
v_lshlrev_b32 v71, 16, v59
v_fmac_f32 v36, s34, v68
v_fmac_f32 v37, s34, v69
v_fmac_f32 v38, s34, v70
v_fmac_f32 v39, s34, v71
v_cvt_pk_bf16_f32 v90, v36, v37
v_cvt_pk_bf16_f32 v91, v38, v39
v_and_b32 v64, 0xffff0000, v60
v_lshlrev_b32 v65, 16, v60
v_and_b32 v66, 0xffff0000, v61
v_lshlrev_b32 v67, 16, v61
v_fmac_f32 v40, s34, v64
v_fmac_f32 v41, s34, v65
v_fmac_f32 v42, s34, v66
v_fmac_f32 v43, s34, v67
v_cvt_pk_bf16_f32 v92, v40, v41
v_cvt_pk_bf16_f32 v93, v42, v43
v_and_b32 v68, 0xffff0000, v62
v_lshlrev_b32 v69, 16, v62
v_and_b32 v70, 0xffff0000, v63
v_lshlrev_b32 v71, 16, v63
v_fmac_f32 v44, s34, v68
v_fmac_f32 v45, s34, v69
v_fmac_f32 v46, s34, v70
v_fmac_f32 v47, s34, v71
v_cvt_pk_bf16_f32 v94, v44, v45
v_cvt_pk_bf16_f32 v95, v46, v47
s_cmp_eq_u32 s28, 0
s_cbranch_scc1 Lg_13
buffer_store_dword v80, v4, s[52:55], 0 offen offset:0
buffer_store_dword v81, v4, s[52:55], 0 offen offset:64
buffer_store_dword v82, v4, s[52:55], 0 offen offset:512
buffer_store_dword v83, v4, s[52:55], 0 offen offset:576
buffer_store_dword v84, v4, s[52:55], 0 offen offset:1024
buffer_store_dword v85, v4, s[52:55], 0 offen offset:1088
buffer_store_dword v86, v4, s[52:55], 0 offen offset:1536
buffer_store_dword v87, v4, s[52:55], 0 offen offset:1600
buffer_store_dword v88, v4, s[52:55], 0 offen offset:2048
buffer_store_dword v89, v4, s[52:55], 0 offen offset:2112
buffer_store_dword v90, v4, s[52:55], 0 offen offset:2560
buffer_store_dword v91, v4, s[52:55], 0 offen offset:2624
buffer_store_dword v92, v4, s[52:55], 0 offen offset:3072
buffer_store_dword v93, v4, s[52:55], 0 offen offset:3136
buffer_store_dword v94, v4, s[52:55], 0 offen offset:3584
buffer_store_dword v95, v4, s[52:55], 0 offen offset:3648
Lj_14:
s_mov_b32 s44, s20
s_mov_b32 s45, s21
s_mov_b32 s46, 8388608
s_mov_b32 s47, 0x20000
s_waitcnt vmcnt(0)
v_mov_b32 v10, s71
v_mov_b32 v11, s27
s_movk_i32 s66, 12288
s_cmp_eq_u32 s28, 0
s_cbranch_scc1 Lg_15
s_mov_b64 exec, 1
buffer_store_dword v11, v10, s[56:59], s66 offen
s_mov_b64 exec, -1
Lj_16:
s_cmp_lg_u32 s26, 0
s_cbranch_scc1 Lf2w_17
v_lshrrev_b32 v9, 2, v0
v_lshlrev_b32 v9, 7, v9
v_and_b32 v10, 3, v0
v_lshl_add_u32 v11, v10, 4, v9
s_movk_i32 s70, 16384
s_mov_b32 s68, 0x100000
Lp_18:
buffer_load_dwordx4 v[176:179], v11, s[56:59], s70 offen sc1
s_waitcnt vmcnt(0)
v_xor_b32 v176, s27, v176
v_xor_b32 v177, s27, v177
v_xor_b32 v178, s27, v178
v_xor_b32 v179, s27, v179
v_or3_b32 v176, v176, v177, v178
v_or_b32 v176, v176, v179
v_cmp_ne_u32 vcc, 0, v176
s_nop 4
s_cbranch_vccz Lok_19
s_sleep 2
s_sub_u32 s68, s68, 1
s_cmp_lg_u32 s68, 0
s_cbranch_scc1 Lp_18
Lok_19:
Lf2w_17:
s_barrier
s_lshl_b32 s64, s35, 16
s_add_u32 s64, s64, 8388608
s_add_u32 s40, s22, s64
s_addc_u32 s41, s23, 0
s_mov_b32 s42, 65536
s_mov_b32 s43, 0x20000
s_mul_i32 s64, s26, 16896
s_add_u32 s64, s64, 70656
s_lshl_b32 s65, s26, 14
s_add_u32 m0, s64, 0
s_add_u32 s66, s65, 0
buffer_load_dwordx4 v236, s[40:43], s66 offen sc1 lds
s_add_u32 m0, s64, 1056
s_add_u32 s66, s65, 1024
buffer_load_dwordx4 v236, s[40:43], s66 offen sc1 lds
s_add_u32 m0, s64, 2112
s_add_u32 s66, s65, 2048
buffer_load_dwordx4 v236, s[40:43], s66 offen sc1 lds
s_add_u32 m0, s64, 3168
s_add_u32 s66, s65, 3072
buffer_load_dwordx4 v236, s[40:43], s66 offen sc1 lds
s_add_u32 m0, s64, 4224
s_add_u32 s66, s65, 4096
buffer_load_dwordx4 v236, s[40:43], s66 offen sc1 lds
s_add_u32 m0, s64, 5280
s_add_u32 s66, s65, 5120
buffer_load_dwordx4 v236, s[40:43], s66 offen sc1 lds
s_add_u32 m0, s64, 6336
s_add_u32 s66, s65, 6144
buffer_load_dwordx4 v236, s[40:43], s66 offen sc1 lds
s_add_u32 m0, s64, 7392
s_add_u32 s66, s65, 7168
buffer_load_dwordx4 v236, s[40:43], s66 offen sc1 lds
s_add_u32 m0, s64, 8448
s_add_u32 s66, s65, 8192
buffer_load_dwordx4 v236, s[40:43], s66 offen sc1 lds
s_add_u32 m0, s64, 9504
s_add_u32 s66, s65, 9216
buffer_load_dwordx4 v236, s[40:43], s66 offen sc1 lds
s_add_u32 m0, s64, 10560
s_add_u32 s66, s65, 10240
buffer_load_dwordx4 v236, s[40:43], s66 offen sc1 lds
s_add_u32 m0, s64, 11616
s_add_u32 s66, s65, 11264
buffer_load_dwordx4 v236, s[40:43], s66 offen sc1 lds
s_add_u32 m0, s64, 12672
s_add_u32 s66, s65, 12288
buffer_load_dwordx4 v236, s[40:43], s66 offen sc1 lds
s_add_u32 m0, s64, 13728
s_add_u32 s66, s65, 13312
buffer_load_dwordx4 v236, s[40:43], s66 offen sc1 lds
s_add_u32 m0, s64, 14784
s_add_u32 s66, s65, 14336
buffer_load_dwordx4 v236, s[40:43], s66 offen sc1 lds
s_add_u32 m0, s64, 15840
s_add_u32 s66, s65, 15360
buffer_load_dwordx4 v236, s[40:43], s66 offen sc1 lds
s_add_u32 s48, s22, s75
s_addc_u32 s49, s23, 0
s_mov_b32 s50, 4194304
s_mov_b32 s51, 0x20000
s_movk_i32 s70, 12288
buffer_load_dword v13, v235, s[56:59], s70 offen sc1
v_lshrrev_b32 v232, 2, v0
v_lshlrev_b32 v232, 12, v232
v_and_b32 v12, 3, v0
v_lshl_add_u32 v232, v12, 4, v232
s_lshl_b32 s72, s24, 18
s_lshl_b32 s64, s25, 8
s_add_u32 s72, s72, s64
s_lshl_b32 s64, s26, 6
s_add_u32 s72, s72, s64
s_mul_i32 s73, s26, 4224
s_add_u32 s73, s73, 36864
v_add_u32 v5, 138240, v236
v_bfe_u32 v7, v0, 2, 2
v_lshl_add_u32 v7, v3, 2, v7
v_mul_u32_u24 v7, 1056, v7
v_and_b32 v8, 3, v0
v_lshl_add_u32 v7, v8, 3, v7
s_lshl_b32 s67, s26, 8
s_add_u32 s64, s67, 70656
v_add_u32 v7, s64, v7
s_lshl_b32 s64, s26, 10
s_add_u32 s64, s64, 142336
v_lshl_add_u32 v6, v3, 4, s64
v_lshlrev_b32 v9, 13, v3
v_lshl_add_u32 v9, v2, 4, v9
s_add_u32 s64, s67, 0
v_add_u32 v9, s64, v9
s_waitcnt vmcnt(1)
s_barrier
ds_read_b128 v[16:19], v5 offset:0
ds_read_b128 v[20:23], v5 offset:1024
ds_read_b128 v[24:27], v5 offset:2048
ds_read_b128 v[28:31], v5 offset:3072
ds_read_b64_tr_b16 v[192:193], v7 offset:0
ds_read_b64_tr_b16 v[194:195], v7 offset:16896
ds_read_b64_tr_b16 v[196:197], v7 offset:33792
ds_read_b64_tr_b16 v[198:199], v7 offset:50688
ds_read_b64_tr_b16 v[200:201], v7 offset:32
ds_read_b64_tr_b16 v[202:203], v7 offset:16928
ds_read_b64_tr_b16 v[204:205], v7 offset:33824
ds_read_b64_tr_b16 v[206:207], v7 offset:50720
ds_read_b128 v[32:35], v6 offset:0
ds_read_b128 v[36:39], v6 offset:64
ds_read_b128 v[40:43], v6 offset:128
ds_read_b128 v[44:47], v6 offset:192
s_waitcnt lgkmcnt(8)
v_mfma_f32_16x16x32_bf16 v[128:131], v[16:19], v[192:195], 0
v_mfma_f32_16x16x32_bf16 v[132:135], v[20:23], v[192:195], 0
v_mfma_f32_16x16x32_bf16 v[128:131], v[24:27], v[196:199], v[128:131]
v_mfma_f32_16x16x32_bf16 v[132:135], v[28:31], v[196:199], v[132:135]
ds_read_b64_tr_b16 v[208:209], v7 offset:64
ds_read_b64_tr_b16 v[210:211], v7 offset:16960
ds_read_b64_tr_b16 v[212:213], v7 offset:33856
ds_read_b64_tr_b16 v[214:215], v7 offset:50752
ds_read_b128 v[48:51], v6 offset:256
ds_read_b128 v[52:55], v6 offset:320
s_waitcnt lgkmcnt(10)
v_mfma_f32_16x16x32_bf16 v[136:139], v[16:19], v[200:203], 0
v_mfma_f32_16x16x32_bf16 v[140:143], v[20:23], v[200:203], 0
v_mfma_f32_16x16x32_bf16 v[136:139], v[24:27], v[204:207], v[136:139]
v_mfma_f32_16x16x32_bf16 v[140:143], v[28:31], v[204:207], v[140:143]
ds_read_b64_tr_b16 v[192:193], v7 offset:96
ds_read_b64_tr_b16 v[194:195], v7 offset:16992
ds_read_b64_tr_b16 v[196:197], v7 offset:33888
ds_read_b64_tr_b16 v[198:199], v7 offset:50784
ds_read_b128 v[56:59], v6 offset:384
ds_read_b128 v[60:63], v6 offset:448
s_waitcnt vmcnt(0)
v_cmp_ne_u32 vcc, s27, v13
s_nop 4
s_cbranch_vccnz Lr_20
Lrj_21:
s_add_u32 m0, s73, 0
s_add_u32 s66, s72, 0
buffer_load_dwordx4 v232, s[48:51], s66 offen sc1 lds
s_add_u32 m0, s73, 1056
s_add_u32 s66, s72, 65536
buffer_load_dwordx4 v232, s[48:51], s66 offen sc1 lds
s_add_u32 m0, s73, 2112
s_add_u32 s66, s72, 131072
buffer_load_dwordx4 v232, s[48:51], s66 offen sc1 lds
s_add_u32 m0, s73, 3168
s_add_u32 s66, s72, 196608
buffer_load_dwordx4 v232, s[48:51], s66 offen sc1 lds
s_waitcnt lgkmcnt(8)
v_mfma_f32_16x16x32_bf16 v[144:147], v[16:19], v[208:211], 0
v_mfma_f32_16x16x32_bf16 v[148:151], v[20:23], v[208:211], 0
v_mfma_f32_16x16x32_bf16 v[144:147], v[24:27], v[212:215], v[144:147]
v_mfma_f32_16x16x32_bf16 v[148:151], v[28:31], v[212:215], v[148:151]
ds_read_b64_tr_b16 v[200:201], v7 offset:128
ds_read_b64_tr_b16 v[202:203], v7 offset:17024
ds_read_b64_tr_b16 v[204:205], v7 offset:33920
ds_read_b64_tr_b16 v[206:207], v7 offset:50816
ds_read_b128 v[64:67], v6 offset:512
ds_read_b128 v[68:71], v6 offset:576
s_waitcnt lgkmcnt(15)
v_pk_mul_f32 v[216:217], v[128:129], v[32:33]
v_pk_mul_f32 v[228:229], v[132:133], v[32:33]
v_pk_mul_f32 v[218:219], v[130:131], v[34:35]
v_pk_mul_f32 v[230:231], v[134:135], v[34:35]
v_pk_fma_f32 v[216:217], v[132:133], v[36:37], v[216:217]
v_pk_fma_f32 v[128:129], v[128:129], v[36:37], v[228:229] neg_lo:[1,0,0] neg_hi:[1,0,0]
v_pk_fma_f32 v[218:219], v[134:135], v[38:39], v[218:219]
v_pk_fma_f32 v[130:131], v[130:131], v[38:39], v[230:231] neg_lo:[1,0,0] neg_hi:[1,0,0]
s_waitcnt lgkmcnt(8)
v_mfma_f32_16x16x32_bf16 v[152:155], v[16:19], v[192:195], 0
v_mfma_f32_16x16x32_bf16 v[156:159], v[20:23], v[192:195], 0
v_mfma_f32_16x16x32_bf16 v[152:155], v[24:27], v[196:199], v[152:155]
v_mfma_f32_16x16x32_bf16 v[156:159], v[28:31], v[196:199], v[156:159]
ds_read_b64_tr_b16 v[208:209], v7 offset:160
ds_read_b64_tr_b16 v[210:211], v7 offset:17056
ds_read_b64_tr_b16 v[212:213], v7 offset:33952
ds_read_b64_tr_b16 v[214:215], v7 offset:50848
ds_read_b128 v[72:75], v6 offset:640
ds_read_b128 v[76:79], v6 offset:704
s_waitcnt lgkmcnt(15)
v_pk_mul_f32 v[220:221], v[136:137], v[40:41]
v_pk_mul_f32 v[228:229], v[140:141], v[40:41]
v_pk_mul_f32 v[222:223], v[138:139], v[42:43]
v_pk_mul_f32 v[230:231], v[142:143], v[42:43]
v_pk_fma_f32 v[220:221], v[140:141], v[44:45], v[220:221]
v_pk_fma_f32 v[136:137], v[136:137], v[44:45], v[228:229] neg_lo:[1,0,0] neg_hi:[1,0,0]
v_pk_fma_f32 v[222:223], v[142:143], v[46:47], v[222:223]
v_pk_fma_f32 v[138:139], v[138:139], v[46:47], v[230:231] neg_lo:[1,0,0] neg_hi:[1,0,0]
v_cvt_pk_bf16_f32 v96, v216, v220
v_cvt_pk_bf16_f32 v100, v128, v136
v_cvt_pk_bf16_f32 v104, v217, v221
v_cvt_pk_bf16_f32 v108, v129, v137
v_cvt_pk_bf16_f32 v112, v218, v222
v_cvt_pk_bf16_f32 v116, v130, v138
v_cvt_pk_bf16_f32 v120, v219, v223
v_cvt_pk_bf16_f32 v124, v131, v139
s_waitcnt lgkmcnt(8)
v_mfma_f32_16x16x32_bf16 v[160:163], v[16:19], v[200:203], 0
v_mfma_f32_16x16x32_bf16 v[164:167], v[20:23], v[200:203], 0
v_mfma_f32_16x16x32_bf16 v[160:163], v[24:27], v[204:207], v[160:163]
v_mfma_f32_16x16x32_bf16 v[164:167], v[28:31], v[204:207], v[164:167]
ds_read_b64_tr_b16 v[192:193], v7 offset:192
ds_read_b64_tr_b16 v[194:195], v7 offset:17088
ds_read_b64_tr_b16 v[196:197], v7 offset:33984
ds_read_b64_tr_b16 v[198:199], v7 offset:50880
ds_read_b128 v[80:83], v6 offset:768
ds_read_b128 v[84:87], v6 offset:832
s_waitcnt lgkmcnt(15)
v_pk_mul_f32 v[216:217], v[144:145], v[48:49]
v_pk_mul_f32 v[228:229], v[148:149], v[48:49]
v_pk_mul_f32 v[218:219], v[146:147], v[50:51]
v_pk_mul_f32 v[230:231], v[150:151], v[50:51]
v_pk_fma_f32 v[216:217], v[148:149], v[52:53], v[216:217]
v_pk_fma_f32 v[144:145], v[144:145], v[52:53], v[228:229] neg_lo:[1,0,0] neg_hi:[1,0,0]
v_pk_fma_f32 v[218:219], v[150:151], v[54:55], v[218:219]
v_pk_fma_f32 v[146:147], v[146:147], v[54:55], v[230:231] neg_lo:[1,0,0] neg_hi:[1,0,0]
s_waitcnt lgkmcnt(8)
v_mfma_f32_16x16x32_bf16 v[168:171], v[16:19], v[208:211], 0
v_mfma_f32_16x16x32_bf16 v[172:175], v[20:23], v[208:211], 0
v_mfma_f32_16x16x32_bf16 v[168:171], v[24:27], v[212:215], v[168:171]
v_mfma_f32_16x16x32_bf16 v[172:175], v[28:31], v[212:215], v[172:175]
ds_read_b64_tr_b16 v[200:201], v7 offset:224
ds_read_b64_tr_b16 v[202:203], v7 offset:17120
ds_read_b64_tr_b16 v[204:205], v7 offset:34016
ds_read_b64_tr_b16 v[206:207], v7 offset:50912
ds_read_b128 v[88:91], v6 offset:896
ds_read_b128 v[92:95], v6 offset:960
s_waitcnt lgkmcnt(15)
v_pk_mul_f32 v[220:221], v[152:153], v[56:57]
v_pk_mul_f32 v[228:229], v[156:157], v[56:57]
v_pk_mul_f32 v[222:223], v[154:155], v[58:59]
v_pk_mul_f32 v[230:231], v[158:159], v[58:59]
v_pk_fma_f32 v[220:221], v[156:157], v[60:61], v[220:221]
v_pk_fma_f32 v[152:153], v[152:153], v[60:61], v[228:229] neg_lo:[1,0,0] neg_hi:[1,0,0]
v_pk_fma_f32 v[222:223], v[158:159], v[62:63], v[222:223]
v_pk_fma_f32 v[154:155], v[154:155], v[62:63], v[230:231] neg_lo:[1,0,0] neg_hi:[1,0,0]
v_cvt_pk_bf16_f32 v97, v216, v220
v_cvt_pk_bf16_f32 v101, v144, v152
v_cvt_pk_bf16_f32 v105, v217, v221
v_cvt_pk_bf16_f32 v109, v145, v153
v_cvt_pk_bf16_f32 v113, v218, v222
v_cvt_pk_bf16_f32 v117, v146, v154
v_cvt_pk_bf16_f32 v121, v219, v223
v_cvt_pk_bf16_f32 v125, v147, v155
s_waitcnt lgkmcnt(8)
v_mfma_f32_16x16x32_bf16 v[176:179], v[16:19], v[192:195], 0
v_mfma_f32_16x16x32_bf16 v[180:183], v[20:23], v[192:195], 0
v_mfma_f32_16x16x32_bf16 v[176:179], v[24:27], v[196:199], v[176:179]
v_mfma_f32_16x16x32_bf16 v[180:183], v[28:31], v[196:199], v[180:183]
s_waitcnt lgkmcnt(15)
v_pk_mul_f32 v[216:217], v[160:161], v[64:65]
v_pk_mul_f32 v[228:229], v[164:165], v[64:65]
v_pk_mul_f32 v[218:219], v[162:163], v[66:67]
v_pk_mul_f32 v[230:231], v[166:167], v[66:67]
v_pk_fma_f32 v[216:217], v[164:165], v[68:69], v[216:217]
v_pk_fma_f32 v[160:161], v[160:161], v[68:69], v[228:229] neg_lo:[1,0,0] neg_hi:[1,0,0]
v_pk_fma_f32 v[218:219], v[166:167], v[70:71], v[218:219]
v_pk_fma_f32 v[162:163], v[162:163], v[70:71], v[230:231] neg_lo:[1,0,0] neg_hi:[1,0,0]
s_waitcnt lgkmcnt(2)
v_mfma_f32_16x16x32_bf16 v[184:187], v[16:19], v[200:203], 0
v_mfma_f32_16x16x32_bf16 v[188:191], v[20:23], v[200:203], 0
v_mfma_f32_16x16x32_bf16 v[184:187], v[24:27], v[204:207], v[184:187]
v_mfma_f32_16x16x32_bf16 v[188:191], v[28:31], v[204:207], v[188:191]
s_waitcnt lgkmcnt(12)
v_pk_mul_f32 v[220:221], v[168:169], v[72:73]
v_pk_mul_f32 v[228:229], v[172:173], v[72:73]
v_pk_mul_f32 v[222:223], v[170:171], v[74:75]
v_pk_mul_f32 v[230:231], v[174:175], v[74:75]
v_pk_fma_f32 v[220:221], v[172:173], v[76:77], v[220:221]
v_pk_fma_f32 v[168:169], v[168:169], v[76:77], v[228:229] neg_lo:[1,0,0] neg_hi:[1,0,0]
v_pk_fma_f32 v[222:223], v[174:175], v[78:79], v[222:223]
v_pk_fma_f32 v[170:171], v[170:171], v[78:79], v[230:231] neg_lo:[1,0,0] neg_hi:[1,0,0]
v_cvt_pk_bf16_f32 v98, v216, v220
v_cvt_pk_bf16_f32 v102, v160, v168
v_cvt_pk_bf16_f32 v106, v217, v221
v_cvt_pk_bf16_f32 v110, v161, v169
v_cvt_pk_bf16_f32 v114, v218, v222
v_cvt_pk_bf16_f32 v118, v162, v170
v_cvt_pk_bf16_f32 v122, v219, v223
v_cvt_pk_bf16_f32 v126, v163, v171
ds_read_b128 v[16:19], v5 offset:8192
ds_read_b128 v[20:23], v5 offset:9216
ds_read_b128 v[24:27], v5 offset:10240
ds_read_b128 v[28:31], v5 offset:11264
s_waitcnt lgkmcnt(4)
v_pk_mul_f32 v[216:217], v[176:177], v[80:81]
v_pk_mul_f32 v[228:229], v[180:181], v[80:81]
v_pk_mul_f32 v[218:219], v[178:179], v[82:83]
v_pk_mul_f32 v[230:231], v[182:183], v[82:83]
v_pk_fma_f32 v[216:217], v[180:181], v[84:85], v[216:217]
v_pk_fma_f32 v[176:177], v[176:177], v[84:85], v[228:229] neg_lo:[1,0,0] neg_hi:[1,0,0]
v_pk_fma_f32 v[218:219], v[182:183], v[86:87], v[218:219]
v_pk_fma_f32 v[178:179], v[178:179], v[86:87], v[230:231] neg_lo:[1,0,0] neg_hi:[1,0,0]
v_pk_mul_f32 v[220:221], v[184:185], v[88:89]
v_pk_mul_f32 v[228:229], v[188:189], v[88:89]
v_pk_mul_f32 v[222:223], v[186:187], v[90:91]
v_pk_mul_f32 v[230:231], v[190:191], v[90:91]
v_pk_fma_f32 v[220:221], v[188:189], v[92:93], v[220:221]
v_pk_fma_f32 v[184:185], v[184:185], v[92:93], v[228:229] neg_lo:[1,0,0] neg_hi:[1,0,0]
v_pk_fma_f32 v[222:223], v[190:191], v[94:95], v[222:223]
v_pk_fma_f32 v[186:187], v[186:187], v[94:95], v[230:231] neg_lo:[1,0,0] neg_hi:[1,0,0]
v_cvt_pk_bf16_f32 v99, v216, v220
v_cvt_pk_bf16_f32 v103, v176, v184
v_cvt_pk_bf16_f32 v107, v217, v221
v_cvt_pk_bf16_f32 v111, v177, v185
v_cvt_pk_bf16_f32 v115, v218, v222
v_cvt_pk_bf16_f32 v119, v178, v186
v_cvt_pk_bf16_f32 v123, v219, v223
v_cvt_pk_bf16_f32 v127, v179, v187
ds_write_b128 v9, v[96:99] offset:0
ds_write_b128 v9, v[100:103] offset:1024
ds_write_b128 v9, v[104:107] offset:2048
ds_write_b128 v9, v[108:111] offset:3072
ds_write_b128 v9, v[112:115] offset:4096
ds_write_b128 v9, v[116:119] offset:5120
ds_write_b128 v9, v[120:123] offset:6144
ds_write_b128 v9, v[124:127] offset:7168
s_lshl_b32 s64, s26, 13
s_add_u32 s64, s64, 0
v_add_u32 v10, s64, v236
v_lshrrev_b32 v11, 2, v0
v_lshlrev_b32 v11, 18, v11
v_and_b32 v12, 3, v0
v_lshl_add_u32 v11, v12, 3, v11
v_lshlrev_b32 v12, 6, v12
v_and_b32 v13, 60, v0
v_or_b32 v12, v12, v13
s_lshl_b32 s64, s3, 4
s_lshl_b32 s65, s26, 2
s_add_u32 s64, s64, s65
s_lshl_b32 s64, s64, 12
s_lshl_b32 s65, s35, 5
s_add_u32 s64, s64, s65
s_add_u32 s67, s64, 2048
s_waitcnt lgkmcnt(0)
s_barrier
ds_read_b128 v[32:35], v10 offset:0
ds_read_b128 v[36:39], v10 offset:1024
ds_read_b128 v[40:43], v10 offset:2048
ds_read_b128 v[44:47], v10 offset:3072
ds_read_b128 v[48:51], v10 offset:4096
ds_read_b128 v[52:55], v10 offset:5120
ds_read_b128 v[56:59], v10 offset:6144
ds_read_b128 v[60:63], v10 offset:7168
s_waitcnt lgkmcnt(6)
v_mfma_f32_16x16x32_bf16 v[64:67], v[32:35], v[16:19], 0
v_mfma_f32_16x16x32_bf16 v[64:67], v[36:39], v[20:23], v[64:67]
v_mfma_f32_16x16x32_bf16 v[68:71], v[32:35], v[24:27], 0
v_mfma_f32_16x16x32_bf16 v[68:71], v[36:39], v[28:31], v[68:71]
s_waitcnt lgkmcnt(4)
v_mfma_f32_16x16x32_bf16 v[72:75], v[40:43], v[16:19], 0
v_mfma_f32_16x16x32_bf16 v[72:75], v[44:47], v[20:23], v[72:75]
v_mfma_f32_16x16x32_bf16 v[76:79], v[40:43], v[24:27], 0
v_mfma_f32_16x16x32_bf16 v[76:79], v[44:47], v[28:31], v[76:79]
s_waitcnt lgkmcnt(2)
v_mfma_f32_16x16x32_bf16 v[80:83], v[48:51], v[16:19], 0
v_mfma_f32_16x16x32_bf16 v[80:83], v[52:55], v[20:23], v[80:83]
v_mfma_f32_16x16x32_bf16 v[84:87], v[48:51], v[24:27], 0
v_mfma_f32_16x16x32_bf16 v[84:87], v[52:55], v[28:31], v[84:87]
s_waitcnt lgkmcnt(0)
v_mfma_f32_16x16x32_bf16 v[88:91], v[56:59], v[16:19], 0
v_mfma_f32_16x16x32_bf16 v[88:91], v[60:63], v[20:23], v[88:91]
v_mfma_f32_16x16x32_bf16 v[92:95], v[56:59], v[24:27], 0
v_mfma_f32_16x16x32_bf16 v[92:95], v[60:63], v[28:31], v[92:95]
v_cvt_pk_bf16_f32 v96, v64, v65
v_cvt_pk_bf16_f32 v97, v66, v67
ds_bpermute_b32 v96, v12, v96
ds_bpermute_b32 v97, v12, v97
v_cvt_pk_bf16_f32 v98, v68, v69
v_cvt_pk_bf16_f32 v99, v70, v71
ds_bpermute_b32 v98, v12, v98
ds_bpermute_b32 v99, v12, v99
v_cvt_pk_bf16_f32 v100, v72, v73
v_cvt_pk_bf16_f32 v101, v74, v75
ds_bpermute_b32 v100, v12, v100
ds_bpermute_b32 v101, v12, v101
v_cvt_pk_bf16_f32 v102, v76, v77
v_cvt_pk_bf16_f32 v103, v78, v79
ds_bpermute_b32 v102, v12, v102
ds_bpermute_b32 v103, v12, v103
v_cvt_pk_bf16_f32 v104, v80, v81
v_cvt_pk_bf16_f32 v105, v82, v83
ds_bpermute_b32 v104, v12, v104
ds_bpermute_b32 v105, v12, v105
v_cvt_pk_bf16_f32 v106, v84, v85
v_cvt_pk_bf16_f32 v107, v86, v87
ds_bpermute_b32 v106, v12, v106
ds_bpermute_b32 v107, v12, v107
v_cvt_pk_bf16_f32 v108, v88, v89
v_cvt_pk_bf16_f32 v109, v90, v91
ds_bpermute_b32 v108, v12, v108
ds_bpermute_b32 v109, v12, v109
v_cvt_pk_bf16_f32 v110, v92, v93
v_cvt_pk_bf16_f32 v111, v94, v95
ds_bpermute_b32 v110, v12, v110
ds_bpermute_b32 v111, v12, v111
s_waitcnt lgkmcnt(14)
s_add_u32 s65, s67, 0
buffer_store_dwordx2 v[96:97], v11, s[44:47], s65 offen
s_waitcnt lgkmcnt(12)
s_add_u32 s65, s67, 4194304
buffer_store_dwordx2 v[98:99], v11, s[44:47], s65 offen
s_waitcnt lgkmcnt(10)
s_add_u32 s65, s67, 4096
buffer_store_dwordx2 v[100:101], v11, s[44:47], s65 offen
s_waitcnt lgkmcnt(8)
s_add_u32 s65, s67, 4198400
buffer_store_dwordx2 v[102:103], v11, s[44:47], s65 offen
s_waitcnt lgkmcnt(6)
s_add_u32 s65, s67, 8192
buffer_store_dwordx2 v[104:105], v11, s[44:47], s65 offen
s_waitcnt lgkmcnt(4)
s_add_u32 s65, s67, 4202496
buffer_store_dwordx2 v[106:107], v11, s[44:47], s65 offen
s_waitcnt lgkmcnt(2)
s_add_u32 s65, s67, 12288
buffer_store_dwordx2 v[108:109], v11, s[44:47], s65 offen
s_waitcnt lgkmcnt(0)
s_add_u32 s65, s67, 4206592
buffer_store_dwordx2 v[110:111], v11, s[44:47], s65 offen
v_and_b32 v8, 7, v0
v_lshrrev_b32 v9, 1, v8
v_mul_u32_u24 v9, 1056, v9
v_and_b32 v8, 1, v8
v_lshl_add_u32 v9, v8, 9, v9
v_lshrrev_b32 v8, 3, v0
v_lshl_add_u32 v9, v8, 3, v9
v_add_u32 v9, s73, v9
s_waitcnt vmcnt(8)
ds_read_b64 v[112:113], v9 offset:0
ds_read_b64 v[114:115], v9 offset:64
ds_read_b64 v[116:117], v9 offset:128
ds_read_b64 v[118:119], v9 offset:192
ds_read_b64 v[120:121], v9 offset:256
ds_read_b64 v[122:123], v9 offset:320
ds_read_b64 v[124:125], v9 offset:384
ds_read_b64 v[126:127], v9 offset:448
s_waitcnt lgkmcnt(0)
v_lshlrev_b32 v128, 16, v112
v_lshlrev_b32 v129, 16, v114
v_lshlrev_b32 v130, 16, v240
v_and_b32 v131, 0xffff0000, v240
v_pk_mul_f32 v[130:131], v[130:131], v[128:129]
v_cvt_pk_bf16_f32 v144, v130, v131
v_lshlrev_b32 v132, 16, v116
v_lshlrev_b32 v133, 16, v118
v_lshlrev_b32 v134, 16, v241
v_and_b32 v135, 0xffff0000, v241
v_pk_mul_f32 v[134:135], v[134:135], v[132:133]
v_cvt_pk_bf16_f32 v145, v134, v135
v_lshlrev_b32 v128, 16, v120
v_lshlrev_b32 v129, 16, v122
v_lshlrev_b32 v130, 16, v242
v_and_b32 v131, 0xffff0000, v242
v_pk_mul_f32 v[130:131], v[130:131], v[128:129]
v_cvt_pk_bf16_f32 v146, v130, v131
v_lshlrev_b32 v132, 16, v124
v_lshlrev_b32 v133, 16, v126
v_lshlrev_b32 v134, 16, v243
v_and_b32 v135, 0xffff0000, v243
v_pk_mul_f32 v[134:135], v[134:135], v[132:133]
v_cvt_pk_bf16_f32 v147, v134, v135
s_mov_b32 s65, 0
buffer_store_dwordx4 v[144:147], v233, s[44:47], s65 offen sc1
v_and_b32 v128, 0xffff0000, v112
v_and_b32 v129, 0xffff0000, v114
v_lshlrev_b32 v130, 16, v244
v_and_b32 v131, 0xffff0000, v244
v_pk_mul_f32 v[130:131], v[130:131], v[128:129]
v_cvt_pk_bf16_f32 v148, v130, v131
v_and_b32 v132, 0xffff0000, v116
v_and_b32 v133, 0xffff0000, v118
v_lshlrev_b32 v134, 16, v245
v_and_b32 v135, 0xffff0000, v245
v_pk_mul_f32 v[134:135], v[134:135], v[132:133]
v_cvt_pk_bf16_f32 v149, v134, v135
v_and_b32 v128, 0xffff0000, v120
v_and_b32 v129, 0xffff0000, v122
v_lshlrev_b32 v130, 16, v246
v_and_b32 v131, 0xffff0000, v246
v_pk_mul_f32 v[130:131], v[130:131], v[128:129]
v_cvt_pk_bf16_f32 v150, v130, v131
v_and_b32 v132, 0xffff0000, v124
v_and_b32 v133, 0xffff0000, v126
v_lshlrev_b32 v134, 16, v247
v_and_b32 v135, 0xffff0000, v247
v_pk_mul_f32 v[134:135], v[134:135], v[132:133]
v_cvt_pk_bf16_f32 v151, v134, v135
s_mov_b32 s65, 4096
buffer_store_dwordx4 v[148:151], v233, s[44:47], s65 offen sc1
v_lshlrev_b32 v128, 16, v113
v_lshlrev_b32 v129, 16, v115
v_lshlrev_b32 v130, 16, v248
v_and_b32 v131, 0xffff0000, v248
v_pk_mul_f32 v[130:131], v[130:131], v[128:129]
v_cvt_pk_bf16_f32 v152, v130, v131
v_lshlrev_b32 v132, 16, v117
v_lshlrev_b32 v133, 16, v119
v_lshlrev_b32 v134, 16, v249
v_and_b32 v135, 0xffff0000, v249
v_pk_mul_f32 v[134:135], v[134:135], v[132:133]
v_cvt_pk_bf16_f32 v153, v134, v135
v_lshlrev_b32 v128, 16, v121
v_lshlrev_b32 v129, 16, v123
v_lshlrev_b32 v130, 16, v250
v_and_b32 v131, 0xffff0000, v250
v_pk_mul_f32 v[130:131], v[130:131], v[128:129]
v_cvt_pk_bf16_f32 v154, v130, v131
v_lshlrev_b32 v132, 16, v125
v_lshlrev_b32 v133, 16, v127
v_lshlrev_b32 v134, 16, v251
v_and_b32 v135, 0xffff0000, v251
v_pk_mul_f32 v[134:135], v[134:135], v[132:133]
v_cvt_pk_bf16_f32 v155, v134, v135
s_mov_b32 s65, 8192
buffer_store_dwordx4 v[152:155], v233, s[44:47], s65 offen sc1
v_and_b32 v128, 0xffff0000, v113
v_and_b32 v129, 0xffff0000, v115
v_lshlrev_b32 v130, 16, v252
v_and_b32 v131, 0xffff0000, v252
v_pk_mul_f32 v[130:131], v[130:131], v[128:129]
v_cvt_pk_bf16_f32 v156, v130, v131
v_and_b32 v132, 0xffff0000, v117
v_and_b32 v133, 0xffff0000, v119
v_lshlrev_b32 v134, 16, v253
v_and_b32 v135, 0xffff0000, v253
v_pk_mul_f32 v[134:135], v[134:135], v[132:133]
v_cvt_pk_bf16_f32 v157, v134, v135
v_and_b32 v128, 0xffff0000, v121
v_and_b32 v129, 0xffff0000, v123
v_lshlrev_b32 v130, 16, v254
v_and_b32 v131, 0xffff0000, v254
v_pk_mul_f32 v[130:131], v[130:131], v[128:129]
v_cvt_pk_bf16_f32 v158, v130, v131
v_and_b32 v132, 0xffff0000, v125
v_and_b32 v133, 0xffff0000, v127
v_lshlrev_b32 v134, 16, v255
v_and_b32 v135, 0xffff0000, v255
v_pk_mul_f32 v[134:135], v[134:135], v[132:133]
v_cvt_pk_bf16_f32 v159, v134, v135
s_mov_b32 s65, 12288
buffer_store_dwordx4 v[156:159], v233, s[44:47], s65 offen sc1
s_or_b32 s64, s2, s26
s_cmp_lg_u32 s64, 0
s_cbranch_scc1 Lne_24
v_mov_b32 v8, 0
v_mov_b32 v9, s27
s_mov_b64 exec, 1
buffer_store_dword v9, v8, s[56:59], 0 offen
s_mov_b64 exec, -1
Lne_24:
s_endpgm
Lr_2:
s_mov_b32 s68, 0x100000
Lp_4:
buffer_load_dwordx2 v[14:15], v13, s[56:59], s70 offen sc1
s_waitcnt vmcnt(0)
v_cmp_ne_u32 vcc, s27, v14
s_nop 4
s_cbranch_vccz Lok_5
s_sleep 1
s_sub_u32 s68, s68, 1
s_cmp_lg_u32 s68, 0
s_cbranch_scc1 Lp_4
Lok_5:
s_branch Lrj_3
Lg_6:
s_mov_b32 s65, 0
buffer_store_dwordx2 v[240:241], v225, s[48:51], s65 offen sc1
s_mov_b32 s65, 4096
buffer_store_dwordx2 v[242:243], v225, s[48:51], s65 offen sc1
s_mov_b32 s65, 8192
buffer_store_dwordx2 v[244:245], v225, s[48:51], s65 offen sc1
s_mov_b32 s65, 12288
buffer_store_dwordx2 v[246:247], v225, s[48:51], s65 offen sc1
s_mov_b32 s65, 16384
buffer_store_dwordx2 v[248:249], v225, s[48:51], s65 offen sc1
s_mov_b32 s65, 20480
buffer_store_dwordx2 v[250:251], v225, s[48:51], s65 offen sc1
s_mov_b32 s65, 24576
buffer_store_dwordx2 v[252:253], v225, s[48:51], s65 offen sc1
s_mov_b32 s65, 28672
buffer_store_dwordx2 v[254:255], v225, s[48:51], s65 offen sc1
s_waitcnt vmcnt(0)
s_mov_b64 exec, 1
buffer_store_dword v10, v9, s[56:59], s66 offen sc1
s_mov_b64 exec, -1
s_branch Lj_7
Lr_8:
s_mov_b32 s68, 0x100000
Lp_10:
buffer_load_dword v13, v235, s[56:59], s70 offen sc1
s_waitcnt vmcnt(0)
v_cmp_ne_u32 vcc, s27, v13
s_nop 4
s_cbranch_vccz Lok_11
s_sleep 1
s_sub_u32 s68, s68, 1
s_cmp_lg_u32 s68, 0
s_cbranch_scc1 Lp_10
Lok_11:
s_branch Lrj_9
Lg_13:
buffer_store_dword v80, v4, s[52:55], 0 offen offset:0 sc1
buffer_store_dword v81, v4, s[52:55], 0 offen offset:64 sc1
buffer_store_dword v82, v4, s[52:55], 0 offen offset:512 sc1
buffer_store_dword v83, v4, s[52:55], 0 offen offset:576 sc1
buffer_store_dword v84, v4, s[52:55], 0 offen offset:1024 sc1
buffer_store_dword v85, v4, s[52:55], 0 offen offset:1088 sc1
buffer_store_dword v86, v4, s[52:55], 0 offen offset:1536 sc1
buffer_store_dword v87, v4, s[52:55], 0 offen offset:1600 sc1
buffer_store_dword v88, v4, s[52:55], 0 offen offset:2048 sc1
buffer_store_dword v89, v4, s[52:55], 0 offen offset:2112 sc1
buffer_store_dword v90, v4, s[52:55], 0 offen offset:2560 sc1
buffer_store_dword v91, v4, s[52:55], 0 offen offset:2624 sc1
buffer_store_dword v92, v4, s[52:55], 0 offen offset:3072 sc1
buffer_store_dword v93, v4, s[52:55], 0 offen offset:3136 sc1
buffer_store_dword v94, v4, s[52:55], 0 offen offset:3584 sc1
buffer_store_dword v95, v4, s[52:55], 0 offen offset:3648 sc1
s_branch Lj_14
Lg_15:
s_mov_b64 exec, 1
buffer_store_dword v11, v10, s[56:59], s66 offen sc1
s_mov_b64 exec, -1
s_branch Lj_16
Lr_20:
s_mov_b32 s68, 0x100000
Lp_22:
buffer_load_dword v13, v235, s[56:59], s70 offen sc1
s_waitcnt vmcnt(0)
v_cmp_ne_u32 vcc, s27, v13
s_nop 4
s_cbranch_vccz Lok_23
s_sleep 1
s_sub_u32 s68, s68, 1
s_cmp_lg_u32 s68, 0
s_cbranch_scc1 Lp_22
Lok_23:
s_branch Lrj_21
L_end:
s_endpgm
L_code_end:
.p2align 8
.type L_tables,@object
L_tables:
.long 0x3f803f80,0x3f803f80,0x3f803f80,0x3f803f80,0x3f7b3f80,0x3f553f6d,0xbf7bbf80,0xbf55bf6d
.long 0x3f6d3f80,0x3ec43f35,0x3f6d3f80,0x3ec43f35,0x3f553f80,0xbe483ec4,0xbf55bf80,0x3e48bec4
.long 0x248d3f80,0xa554bf80,0xa6543f80,0xa754bf80,0xbe483f80,0x3f0ebf6d,0x3e48bf80,0xbf0e3f6d
.long 0xbec43f80,0x3f6dbf35,0xbec43f80,0x3f6dbf35,0xbf0e3f80,0x3f7bbec4,0x3f0ebf80,0xbf7b3ec4
.long 0xbf803f80,0xbf803f80,0xbf803f80,0xbf803f80,0xbf7b3f80,0xbf553f6d,0x3f7bbf80,0x3f55bf6d
.long 0xbf6d3f80,0xbec43f35,0xbf6d3f80,0xbec43f35,0xbf553f80,0x3e483ec4,0x3f55bf80,0xbe48bec4
.long 0xa5543f80,0x261fbf80,0x28283f80,0x281fbf80,0x3e483f80,0xbf0ebf6d,0xbe48bf80,0x3f0e3f6d
.long 0x3ec43f80,0xbf6dbf35,0x3ec43f80,0xbf6dbf35,0x3f0e3f80,0xbf7bbec4,0xbf0ebf80,0x3f7b3ec4
.long 0x3f803f80,0x3f803f80,0x3f803f80,0x3f803f80,0x3f0e3f35,0x3e483ec4,0xbf0ebf35,0xbe48bec4
.long 0xbec4248d,0xbf6dbf35,0xbec425b0,0xbf6dbf35,0xbf7bbf35,0xbf0ebf6d,0x3f7b3f35,0x3f0e3f6d
.long 0x25b03f80,0xa5f7bf80,0xa60d3f80,0xa765bf80,0xbf553f35,0x3f7bbec4,0x3f55bf35,0xbf7b3ec4
.long 0xbf6d25b0,0x3ec43f35,0xbf6da58e,0x3ec43f35,0xbe48bf35,0xbf553f6d,0x3e483f35,0x3f55bf6d
.long 0xbf803f80,0xbf803f80,0xbf803f80,0xbf803f80,0xbf0e3f35,0xbe483ec4,0x3f0ebf35,0x3e48bec4
.long 0x3ec4261f,0x3f6dbf35,0x3ec4268d,0x3f6dbf35,0x3f7bbf35,0x3f0ebf6d,0xbf7b3f35,0xbf0e3f6d
.long 0xa7423f80,0xa60dbf80,0x26d43f80,0x2730bf80,0x3f553f35,0xbf7bbec4,0xbf55bf35,0x3f7b3ec4
.long 0x3f6da68d,0xbec43f35,0x3f6d2828,0xbec43f35,0x3e48bf35,0x3f553f6d,0xbe483f35,0xbf55bf6d
.long 0x3f803f80,0x3f803f80,0x3f803f80,0x3f803f80,0xbe48248d,0xbf0ebec4,0x3e48a554,0x3f0e3ec4
.long 0xbf6dbf80,0xbec4bf35,0xbf6dbf80,0xbec4bf35,0x3f0ea554,0x3f7b3f6d,0xbf0e261f,0xbf7bbf6d
.long 0x261f3f80,0xa731bf80,0xa58e3f80,0xa777bf80,0xbf7b261f,0x3f553ec4,0x3f7ba777,0xbf55bec4
.long 0x3ec4bf80,0xbf6d3f35,0x3ec4bf80,0xbf6d3f35,0x3f55a731,0x3e48bf6d,0xbf55258d,0xbe483f6d
.long 0xbf803f80,0xbf803f80,0xbf803f80,0xbf803f80,0x3e48a654,0x3f0ebec4,0xbe48a7b1,0xbf0e3ec4
.long 0x3f6dbf80,0x3ec4bf35,0x3f6dbf80,0x3ec4bf35,0xbf0ea754,0xbf7b3f6d,0x3f0e281f,0x3f7bbf6d
.long 0xa7773f80,0x2804bf80,0xa7e53f80,0x2839bf80,0x3f7ba58e,0xbf553ec4,0xbf7ba7e5,0x3f55bec4
.long 0xbec4bf80,0x3f6d3f35,0xbec4bf80,0x3f6d3f35,0xbf55a777,0xbe48bf6d,0x3f552839,0x3e483f6d
.long 0x3f803f80,0x3f803f80,0x3f803f80,0x3f803f80,0xbf55bf35,0xbf7bbf6d,0x3f553f35,0x3f7b3f6d
.long 0x3ec4a554,0x3f6d3f35,0x3ec4a5f7,0x3f6d3f35,0x3e483f35,0xbf55bec4,0xbe48bf35,0x3f553ec4
.long 0xa68d3f80,0xa742bf80,0xa1373f80,0xa784bf80,0xbf0ebf35,0x3e483f6d,0x3f0e3f35,0xbe48bf6d
.long 0x3f6da742,0xbec4bf35,0x3f6da78d,0xbec4bf35,0xbf7b3f35,0x3f0e3ec4,0x3f7bbf35,0xbf0ebec4
.long 0xbf803f80,0xbf803f80,0xbf803f80,0xbf803f80,0x3f55bf35,0x3f7bbf6d,0xbf553f35,0xbf7b3f6d
.long 0xbec4a777,0xbf6d3f35,0xbec426d4,0xbf6d3f35,0xbe483f35,0x3f55bec4,0x3e48bf35,0xbf553ec4
.long 0x27543f80,0x2889bf80,0xa8803f80,0x28a3bf80,0x3f0ebf35,0xbe483f6d,0xbf0e3f35,0x3e48bf6d
.long 0xbf6da796,0x3ec4bf35,0xbf6da804,0x3ec4bf35,0x3f7b3f35,0xbf0e3ec4,0xbf7bbf35,0x3f0ebec4
.long 0x80008000,0x80008000,0x80008000,0x80008000,0xbe488000,0xbf0ebec4,0x3e48a50d,0x3f0e3ec4
.long 0xbec48000,0xbf6dbf35,0xbec4258d,0xbf6dbf35,0xbf0e8000,0xbf7bbf6d,0x3f0ea5d4,0x3f7b3f6d
.long 0xbf808000,0x3f80a50d,0xbf80268d,0x3f80a69f,0xbf7b8000,0x3f553ec4,0x3f7ba69f,0xbf55bec4
.long 0xbf6d8000,0x3ec43f35,0xbf6d26b0,0x3ec43f35,0xbf558000,0xbe483f6d,0x3f55a7b1,0x3e48bf6d
.long 0xa50d8000,0xa5d4258d,0x26d4270d,0xa7d4271f,0x3e488000,0x3f0ebec4,0xbe4826d4,0xbf0e3ec4
.long 0x3ec48000,0x3f6dbf35,0x3ec4271f,0x3f6dbf35,0x3f0e8000,0x3f7bbf6d,0xbf0ea7d4,0xbf7b3f6d
.long 0x3f808000,0xbf80a5d4,0x3f802754,0xbf80a7f7,0x3f7b8000,0xbf553ec4,0xbf7b260e,0x3f55bec4
.long 0x3f6d8000,0xbec43f35,0x3f6da78d,0xbec43f35,0x3f558000,0x3e483f6d,0xbf55a7f7,0xbe48bf6d
.long 0x80008000,0x80008000,0x80008000,0x80008000,0xbf55bf35,0xbf7bbf6d,0x3f553f35,0x3f7b3f6d
.long 0xbf6dbf80,0xbec4bf35,0xbf6dbf80,0xbec4bf35,0xbe48bf35,0x3f553ec4,0x3e483f35,0xbf55bec4
.long 0xbf80258d,0x3f80a5d4,0xbf8026b0,0x3f80a7b1,0xbf0ebf35,0x3e483f6d,0x3f0e3f35,0xbe48bf6d
.long 0x3ec4bf80,0xbf6d3f35,0x3ec4bf80,0xbf6d3f35,0x3f7bbf35,0xbf0ebec4,0xbf7b3f35,0x3f0e3ec4
.long 0xa630260d,0xa6772654,0x268d2730,0xa7e52831,0x3f55bf35,0x3f7bbf6d,0xbf553f35,0xbf7b3f6d
.long 0x3f6dbf80,0x3ec4bf35,0x3f6dbf80,0x3ec4bf35,0x3e48bf35,0xbf553ec4,0xbe483f35,0x3f55bec4
.long 0x3f802654,0xbf80a69f,0x3f802842,0xbf80a884,0x3f0ebf35,0xbe483f6d,0xbf0e3f35,0x3e48bf6d
.long 0xbec4bf80,0x3f6d3f35,0xbec4bf80,0x3f6d3f35,0xbf7bbf35,0x3f0ebec4,0x3f7b3f35,0xbf0e3ec4
.long 0x80008000,0x80008000,0x80008000,0x80008000,0xbf7bbf80,0xbf55bf6d,0x3f7b3f80,0x3f553f6d
.long 0x3ec4a50d,0x3f6d3f35,0x3ec4a5d4,0x3f6d3f35,0x3f553f80,0xbe483ec4,0xbf55bf80,0x3e48bec4
.long 0xbf80260d,0x3f80a630,0xbf8026d4,0x3f80270d,0x3e48bf80,0xbf0e3f6d,0xbe483f80,0x3f0ebf6d
.long 0x3f6da630,0xbec4bf35,0x3f6da7c2,0xbec4bf35,0xbf0e3f80,0x3f7bbec4,0x3f0ebf80,0xbf7b3ec4
.long 0xa69f268d,0xa7b126b0,0x260e2754,0xa7f7a78d,0x3f7bbf80,0x3f55bf6d,0xbf7b3f80,0xbf553f6d
.long 0xbec4a69f,0xbf6d3f35,0xbec4a7f7,0xbf6d3f35,0xbf553f80,0x3e483ec4,0x3f55bf80,0xbe48bec4
.long 0x3f8026d4,0xbf80a7c2,0x3f80279f,0xbf8027d4,0xbe48bf80,0x3f0e3f6d,0x3e483f80,0xbf0ebf6d
.long 0xbf6d270d,0x3ec4bf35,0xbf6da816,0x3ec4bf35,0x3f0e3f80,0xbf7bbec4,0xbf0ebf80,0x3f7b3ec4
.long 0x80008000,0x80008000,0x80008000,0x80008000,0xbf0ebf35,0xbe48bec4,0x3f0e3f35,0x3e483ec4
.long 0x3f6d3f80,0x3ec43f35,0x3f6d3f80,0x3ec43f35,0xbf7bbf35,0xbf0ebf6d,0x3f7b3f35,0x3f0e3f6d
.long 0xbf802654,0x3f80a677,0xbf8026f7,0x3f80a7c2,0x3f55bf35,0xbf7b3ec4,0xbf553f35,0x3f7bbec4
.long 0xbec43f80,0x3f6dbf35,0xbec43f80,0x3f6dbf35,0xbe48bf35,0xbf553f6d,0x3e483f35,0x3f55bf6d
.long 0x270d26d4,0xa7c226f7,0x21b72777,0xa8042842,0x3f0ebf35,0x3e48bec4,0xbf0e3f35,0xbe483ec4
.long 0xbf6d3f80,0xbec43f35,0xbf6d3f80,0xbec43f35,0x3f7bbf35,0x3f0ebf6d,0xbf7b3f35,0xbf0e3f6d
.long 0x3f80271f,0xbf80268d,0x3f80a70d,0xbf80a909,0xbf55bf35,0x3f7b3ec4,0x3f553f35,0xbf7bbec4
.long 0x3ec43f80,0xbf6dbf35,0x3ec43f80,0xbf6dbf35,0x3e48bf35,0x3f553f6d,0xbe483f35,0xbf55bf6d
.long 0x3f353f80,0xbf35248d,0x3f353f80,0xbf35261f,0x3f0e3f80,0xbf7bbec4,0xbf0ebf80,0x3f7b3ec4
.long 0x3ec43f80,0xbf6dbf35,0x3ec43f80,0xbf6dbf35,0x3e483f80,0xbf0ebf6d,0xbe48bf80,0x3f0e3f6d
.long 0xbf353f80,0x3f35a554,0xbf353f80,0x3f35a777,0xbf553f80,0x3e483ec4,0x3f55bf80,0xbe48bec4
.long 0xbf6d3f80,0xbec43f35,0xbf6d3f80,0xbec43f35,0xbf7b3f80,0xbf553f6d,0x3f7bbf80,0x3f55bf6d
.long 0xbf353f80,0x3f3525b0,0xbf353f80,0x3f35268d,0xbf0e3f80,0x3f7bbec4,0x3f0ebf80,0xbf7b3ec4
.long 0xbec43f80,0x3f6dbf35,0xbec43f80,0x3f6dbf35,0xbe483f80,0x3f0ebf6d,0x3e48bf80,0xbf0e3f6d
.long 0x3f353f80,0xbf35a5f7,0x3f353f80,0xbf3526d4,0x3f553f80,0xbe483ec4,0xbf55bf80,0x3e48bec4
.long 0x3f6d3f80,0x3ec43f35,0x3f6d3f80,0x3ec43f35,0x3f7b3f80,0x3f553f6d,0xbf7bbf80,0xbf55bf6d
.long 0xbf35bf80,0x3f35a554,0xbf35bf80,0x3f35a731,0x3e48bf35,0x3f553f6d,0xbe483f35,0xbf55bf6d
.long 0x3f6da554,0xbec43f35,0x3f6da742,0xbec43f35,0x3f553f35,0xbf7bbec4,0xbf55bf35,0x3f7b3ec4
.long 0x3f35bf80,0xbf35261f,0x3f35bf80,0xbf352804,0x3f7bbf35,0x3f0ebf6d,0xbf7b3f35,0xbf0e3f6d
.long 0x3ec4a5f7,0x3f6dbf35,0x3ec4a78d,0x3f6dbf35,0xbf0e3f35,0xbe483ec4,0x3f0ebf35,0x3e48bec4
.long 0x3f35bf80,0xbf35a742,0x3f35bf80,0xbf35a85d,0xbe48bf35,0xbf553f6d,0x3e483f35,0x3f55bf6d
.long 0xbf6da731,0x3ec43f35,0xbf6d270d,0x3ec43f35,0xbf553f35,0x3f7bbec4,0x3f55bf35,0xbf7b3ec4
.long 0xbf35bf80,0x3f35a60d,0xbf35bf80,0x3f35289a,0xbf7bbf35,0xbf0ebf6d,0x3f7b3f35,0x3f0e3f6d
.long 0xbec4a742,0xbf6dbf35,0xbec4a7e5,0xbf6dbf35,0x3f0e3f35,0x3e483ec4,0xbf0ebf35,0xbe48bec4
.long 0x3f353f80,0xbf3525b0,0x3f353f80,0xbf35a68d,0xbf5525b0,0xbe48bf6d,0x3f55a742,0x3e483f6d
.long 0xbec4bf80,0x3f6d3f35,0xbec4bf80,0x3f6d3f35,0x3f7ba5f7,0xbf553ec4,0xbf7ba60d,0x3f55bec4
.long 0xbf353f80,0x3f35a742,0xbf353f80,0x3f352754,0xbf0ea68d,0xbf7b3f6d,0x3f0ea796,0x3f7bbf6d
.long 0x3f6dbf80,0x3ec4bf35,0x3f6dbf80,0x3ec4bf35,0x3e48a742,0x3f0ebec4,0xbe48268d,0xbf0e3ec4
.long 0xbf353f80,0x3f35a58e,0xbf353f80,0x3f35a7b1,0x3f55a60d,0x3e48bf6d,0xbf5526d4,0xbe483f6d
.long 0x3ec4bf80,0xbf6d3f35,0x3ec4bf80,0xbf6d3f35,0xbf7ba765,0x3f553ec4,0x3f7b2730,0xbf55bec4
.long 0x3f353f80,0xbf35a78d,0x3f353f80,0xbf3528be,0x3f0ea137,0x3f7b3f6d,0xbf0ea880,0xbf7bbf6d
.long 0xbf6dbf80,0xbec4bf35,0xbf6dbf80,0xbec4bf35,0xbe48a784,0xbf0ebec4,0x3e4828a3,0x3f0e3ec4
.long 0xbf35bf80,0x3f35a5f7,0xbf35bf80,0x3f35a742,0x3f7b3f35,0xbf0e3ec4,0xbf7bbf35,0x3f0ebec4
.long 0xbf6d261f,0x3ec4bf35,0xbf6da60d,0x3ec4bf35,0x3f0ebf35,0xbe483f6d,0xbf0e3f35,0x3e48bf6d
.long 0x3f35bf80,0xbf35a60d,0x3f35bf80,0xbf352889,0xbe483f35,0x3f55bec4,0x3e48bf35,0xbf553ec4
.long 0xbec4a60d,0xbf6d3f35,0xbec42816,0xbf6d3f35,0x3f55bf35,0x3f7bbf6d,0xbf553f35,0xbf7b3f6d
.long 0x3f35bf80,0xbf35a78d,0x3f35bf80,0xbf35a7e5,0xbf7b3f35,0x3f0e3ec4,0x3f7bbf35,0xbf0ebec4
.long 0x3f6d258d,0xbec4bf35,0x3f6d2754,0xbec4bf35,0xbf0ebf35,0x3e483f6d,0x3f0e3f35,0xbe48bf6d
.long 0xbf35bf80,0x3f352816,0xbf35bf80,0x3f3528ea,0x3e483f35,0xbf55bec4,0xbe48bf35,0x3f553ec4
.long 0x3ec4268d,0x3f6d3f35,0x3ec4a731,0x3f6d3f35,0xbf55bf35,0xbf7bbf6d,0x3f553f35,0x3f7b3f6d
.long 0xbf358000,0xbf35bf80,0xbf35260d,0xbf35bf80,0xbf558000,0xbe48bf6d,0x3f55a630,0x3e483f6d
.long 0xbf6d8000,0x3ec4bf35,0xbf6d2654,0x3ec4bf35,0xbf7b8000,0x3f55bec4,0x3f7ba677,0xbf553ec4
.long 0xbf358000,0xbf353f80,0xbf3526d4,0xbf353f80,0xbf0e8000,0xbf7b3f6d,0x3f0e270d,0x3f7bbf6d
.long 0xbec48000,0xbf6d3f35,0xbec426f7,0xbf6d3f35,0xbe488000,0xbf0e3ec4,0x3e48a7c2,0x3f0ebec4
.long 0x3f358000,0x3f35bf80,0x3f352730,0x3f35bf80,0x3f558000,0x3e48bf6d,0xbf55268d,0xbe483f6d
.long 0x3f6d8000,0xbec4bf35,0x3f6d2831,0xbec4bf35,0x3f7b8000,0xbf55bec4,0xbf7ba7e5,0x3f553ec4
.long 0x3f358000,0x3f353f80,0x3f352777,0x3f353f80,0x3f0e8000,0x3f7b3f6d,0xbf0e21b7,0xbf7bbf6d
.long 0x3ec48000,0x3f6d3f35,0x3ec42842,0x3f6d3f35,0x3e488000,0x3f0e3ec4,0xbe48a804,0xbf0ebec4
.long 0x3f35a50d,0x3f353f80,0x3f35a630,0x3f353f80,0x3f7b3f35,0xbf0e3ec4,0xbf7bbf35,0x3f0ebec4
.long 0x3ec43f80,0xbf6dbf35,0x3ec43f80,0xbf6dbf35,0xbf0e3f35,0x3e48bf6d,0x3f0ebf35,0xbe483f6d
.long 0x3f35a5d4,0x3f35bf80,0x3f35a7c2,0x3f35bf80,0xbe483f35,0x3f55bec4,0x3e48bf35,0xbf553ec4
.long 0xbf6d3f80,0xbec43f35,0xbf6d3f80,0xbec43f35,0xbf553f35,0xbf7b3f6d,0x3f55bf35,0x3f7bbf6d
.long 0xbf35a630,0xbf353f80,0xbf35260e,0xbf353f80,0xbf7b3f35,0x3f0e3ec4,0x3f7bbf35,0xbf0ebec4
.long 0xbec43f80,0x3f6dbf35,0xbec43f80,0x3f6dbf35,0x3f0e3f35,0xbe48bf6d,0xbf0ebf35,0x3e483f6d
.long 0xbf35a677,0xbf35bf80,0xbf35a80d,0xbf35bf80,0x3e483f35,0xbf55bec4,0xbe48bf35,0x3f553ec4
.long 0x3f6d3f80,0x3ec43f35,0x3f6d3f80,0x3ec43f35,0x3f553f35,0x3f7b3f6d,0xbf55bf35,0xbf7bbf6d
.long 0xbf35258d,0xbf35bf80,0xbf352654,0xbf35bf80,0xbf0ebf80,0x3f7b3ec4,0x3f0e3f80,0xbf7bbec4
.long 0x3f6da5d4,0xbec43f35,0x3f6da69f,0xbec43f35,0x3e483f80,0xbf0ebf6d,0xbe48bf80,0x3f0e3f6d
.long 0xbf352654,0xbf353f80,0xbf35271f,0xbf353f80,0x3f55bf80,0xbe48bec4,0xbf553f80,0x3e483ec4
.long 0x3ec4a677,0x3f6dbf35,0x3ec4268d,0x3f6dbf35,0xbf7b3f80,0xbf553f6d,0x3f7bbf80,0x3f55bf6d
.long 0x3f3526b0,0x3f35bf80,0x3f352842,0x3f35bf80,0x3f0ebf80,0xbf7b3ec4,0xbf0e3f80,0x3f7bbec4
.long 0xbf6da7b1,0x3ec43f35,0xbf6da60d,0x3ec43f35,0xbe483f80,0x3f0ebf6d,0x3e48bf80,0xbf0e3f6d
.long 0x3f3526f7,0x3f353f80,0x3f35a70d,0x3f353f80,0xbf55bf80,0x3e48bec4,0x3f553f80,0xbe483ec4
.long 0xbec4a7c2,0xbf6dbf35,0xbec4a70d,0xbf6dbf35,0x3f7b3f80,0x3f553f6d,0xbf7bbf80,0xbf55bf6d
.long 0x3f35a5d4,0x3f353f80,0x3f35a677,0x3f353f80,0xbe483f35,0xbf55bf6d,0x3e48bf35,0x3f553f6d
.long 0xbec4bf80,0x3f6d3f35,0xbec4bf80,0x3f6d3f35,0x3f553f35,0xbf7bbec4,0xbf55bf35,0x3f7b3ec4
.long 0x3f35a69f,0x3f35bf80,0x3f35268d,0x3f35bf80,0xbf7b3f35,0xbf0e3f6d,0x3f7bbf35,0x3f0ebf6d
.long 0x3f6dbf80,0x3ec4bf35,0x3f6dbf80,0x3ec4bf35,0xbf0e3f35,0xbe483ec4,0x3f0ebf35,0x3e48bec4
.long 0xbf35a7c2,0xbf353f80,0xbf35a80d,0xbf353f80,0x3e483f35,0x3f55bf6d,0xbe48bf35,0xbf553f6d
.long 0x3ec4bf80,0xbf6d3f35,0x3ec4bf80,0xbf6d3f35,0xbf553f35,0x3f7bbec4,0x3f55bf35,0xbf7b3ec4
.long 0xbf35268d,0xbf35bf80,0xbf35a896,0xbf35bf80,0x3f7b3f35,0x3f0e3f6d,0xbf7bbf35,0xbf0ebf6d
.long 0xbf6dbf80,0xbec4bf35,0xbf6dbf80,0xbec4bf35,0x3f0e3f35,0x3e483ec4,0xbf0ebf35,0xbe48bec4
.long 0x3f800000,0x3f800000,0x3f800000,0x3f800000,0x3f800000,0x3f7ffec4,0x3f7ffb11,0x3f7ff4e6
.long 0x3f800000,0x3f7ffb11,0x3f7fec43,0x3f7fd397,0x3f800000,0x3f7ff4e6,0x3f7fd397,0x3f7f9c18
.long 0x3f800000,0x3f7fb10f,0x3f7ec46d,0x3f7d3aac,0x3f800000,0x3f7f9c18,0x3f7e70b0,0x3f7c7eb0
.long 0x3f800000,0x3f7f84ab,0x3f7e1324,0x3f7baccd,0x3f800000,0x3f7f6ac7,0x3f7dabcc,0x3f7ac516
.long 0x3f800000,0x3f7ec46d,0x3f7b14be,0x3f74fa0b,0x3f800000,0x3f7e9bc9,0x3f7a7302,0x3f73913f
.long 0x3f800000,0x3f7e70b0,0x3f79c79d,0x3f721352,0x3f800000,0x3f7e4323,0x3f791298,0x3f708066
.long 0x3f800000,0x3f7d3aac,0x3f74fa0b,0x3f676bd8,0x3f800000,0x3f7cfe73,0x3f740bdd,0x3f655e0b
.long 0x3f800000,0x3f7cbfc9,0x3f731447,0x3f633c5a,0x3f800000,0x3f7c7eb0,0x3f721352,0x3f6106f2
.long 0x3f800000,0x3f800000,0x3f800000,0x3f800000,0x3f7fec43,0x3f7fe129,0x3f7fd397,0x3f7fc38f
.long 0x3f7fb10f,0x3f7f84ab,0x3f7f4e6d,0x3f7f0e58,0x3f7f4e6d,0x3f7eea9d,0x3f7e70b0,0x3f7de0b1
.long 0x3f7b14be,0x3f7853f8,0x3f74fa0b,0x3f710908,0x3f79c79d,0x3f764d97,0x3f721352,0x3f6d1c1d
.long 0x3f7853f8,0x3f740bdd,0x3f6ed89e,0x3f68bf3c,0x3f76ba07,0x3f718f57,0x3f6b4b0c,0x3f63f473
.long 0x3f6c835e,0x3f61c598,0x3f54db31,0x3f45e403,0x3f6a09a7,0x3f5df6be,0x3f4f7a1f,0x3f3ebc1b
.long 0x3f676bd8,0x3f59f26a,0x3f49d112,0x3f373a23,0x3f64aa59,0x3f55b993,0x3f43e200,0x3f2f61a5
.long 0x3f54db31,0x3f3daef9,0x3f226799,0x3f039c3d,0x3f514d3d,0x3f385216,0x3f1b02c6,0x3ef41f07
.long 0x3f4d9f02,0x3f32c8c9,0x3f13682a,0x3ee0924f,0x3f49d112,0x3f2d1469,0x3f0b9a6b,0x3ecc9b8b
.long 0x3f800000,0x3f800000,0x3f800000,0x3f800000,0x3f7fb10f,0x3f7f9c18,0x3f7f84ab,0x3f7f6ac7
.long 0x3f7ec46d,0x3f7e70b0,0x3f7e1324,0x3f7dabcc,0x3f7d3aac,0x3f7c7eb0,0x3f7baccd,0x3f7ac516
.long 0x3f6c835e,0x3f676bd8,0x3f61c598,0x3f5b941a,0x3f676bd8,0x3f6106f2,0x3f59f26a,0x3f5233c6
.long 0x3f61c598,0x3f59f26a,0x3f514d3d,0x3f47de65,0x3f5b941a,0x3f5233c6,0x3f47de65,0x3f3ca003
.long 0x3f3504f3,0x3f226799,0x3f0e39da,0x3ef15aea,0x3f2beb4a,0x3f173c07,0x3f00e7e4,0x3ed25a09
.long 0x3f226799,0x3f0b9a6b,0x3ee63375,0x3eb263ef,0x3f187fc0,0x3eff17b2,0x3ec9b953,0x3e919ddd
.long 0x3ec3ef15,0x3e78cfcc,0x3dc8bd36,0xbd48fb30,0x3eac7cd4,0x3e419b37,0x3d16c32c,0xbdee3876
.long 0x3e94a031,0x3e09cf86,0xbcc90ab0,0xbe3b6ecf,0x3e78cfcc,0x3da3308c,0xbdafb680,0xbe7ee6e1
.long 0x3f800000,0x3f800000,0x3f800000,0x3f800000,0x3f7f4e6d,0x3f7f2f9d,0x3f7f0e58,0x3f7eea9d
.long 0x3f7d3aac,0x3f7cbfc9,0x3f7c3b28,0x3f7baccd,0x3f79c79d,0x3f78b47b,0x3f778bc5,0x3f764d97
.long 0x3f54db31,0x3f4d9f02,0x3f45e403,0x3f3daef9,0x3f49d112,0x3f40d0da,0x3f373a23,0x3f2d1469
.long 0x3f3daef9,0x3f32c8c9,0x3f273656,0x3f1b02c6,0x3f3085bb,0x3f239da9,0x3f15f6d9,0x3f07a136
.long 0x3ec3ef15,0x3e94a031,0x3e47c5c2,0x3dc8bd36,0x3ea09ae5,0x3e5a3997,0x3de1bc2e,0x3bc90f88
.long 0x3e78cfcc,0x3e09cf86,0x3cc90ab0,0xbdafb680,0x3e2f10a2,0x3d621469,0xbd7b2b74,0xbe354098
.long 0xbe47c5c2,0xbeac7cd4,0xbef15aea,0xbf187fc0,0xbe888e93,0xbed25a09,0xbf0b9a6b,0xbf2ac082
.long 0xbeac7cd4,0xbef6e0cb,0xbf1d7fd1,0xbf3b8f3b,0xbecf7bca,0xbf0cead0,0xbf2e3bde,0xbf4ac77f
.long 0x0,0x0,0x0,0x0,0x0,0x3bc90f88,0x3c490e90,0x3c96c9b6
.long 0x0,0x3c490e90,0x3cc90ab0,0x3d16c32c,0x0,0x3c96c9b6,0x3d16c32c,0x3d621469
.long 0x0,0x3d48fb30,0x3dc8bd36,0x3e164083,0x0,0x3d621469,0x3de1bc2e,0x3e28defc
.long 0x0,0x3d7b2b74,0x3dfab273,0x3e3b6ecf,0x0,0x3d8a200a,0x3e09cf86,0x3e4dee60
.long 0x0,0x3dc8bd36,0x3e47c5c2,0x3e94a031,0x0,0x3dd53db9,0x3e541501,0x3e9d9e78
.long 0x0,0x3de1bc2e,0x3e605c13,0x3ea68f12,0x0,0x3dee3876,0x3e6c9a7f,0x3eaf713a
.long 0x0,0x3e164083,0x3e94a031,0x3edae880,0x0,0x3e1c76de,0x3e9aa086,0x3ee363fa
.long 0x0,0x3e22abb6,0x3ea09ae5,0x3eebcbbb,0x0,0x3e28defc,0x3ea68f12,0x3ef41f07
.long 0x0,0x0,0x0,0x0,0x3cc90ab0,0x3cfb49ba,0x3d16c32c,0x3d2fe007
.long 0x3d48fb30,0x3d7b2b74,0x3d96a905,0x3dafb680,0x3d96a905,0x3dbc3ac3,0x3de1bc2e,0x3e039502
.long 0x3e47c5c2,0x3e78cfcc,0x3e94a031,0x3eac7cd4,0x3e605c13,0x3e8b9507,0x3ea68f12,0x3ec1071e
.long 0x3e78cfcc,0x3e9aa086,0x3eb8442a,0x3ed53641,0x3e888e93,0x3ea986c4,0x3ec9b953,0x3ee900b7
.long 0x3ec3ef15,0x3ef15aea,0x3f0e39da,0x3f226799,0x3ecf7bca,0x3eff17b2,0x3f15f6d9,0x3f2ac082
.long 0x3edae880,0x3f064b82,0x3f1d7fd1,0x3f32c8c9,0x3ee63375,0x3f0cead0,0x3f24d225,0x3f3a7ca4
.long 0x3f0e39da,0x3f2beb4a,0x3f45e403,0x3f5b941a,0x3f13682a,0x3f31a81d,0x3f4bbbf8,0x3f6106f2
.long 0x3f187fc0,0x3f373a23,0x3f514d3d,0x3f660f88,0x3f1d7fd1,0x3f3ca003,0x3f5695e5,0x3f6aab7b
.long 0x0,0x0,0x0,0x0,0x3d48fb30,0x3d621469,0x3d7b2b74,0x3d8a200a
.long 0x3dc8bd36,0x3de1bc2e,0x3dfab273,0x3e09cf86,0x3e164083,0x3e28defc,0x3e3b6ecf,0x3e4dee60
.long 0x3ec3ef15,0x3edae880,0x3ef15aea,0x3f039c3d,0x3edae880,0x3ef41f07,0x3f064b82,0x3f121eb0
.long 0x3ef15aea,0x3f064b82,0x3f13682a,0x3f1ff6cb,0x3f039c3d,0x3f121eb0,0x3f1ff6cb,0x3f2d1469
.long 0x3f3504f3,0x3f45e403,0x3f54db31,0x3f61c598,0x3f3daef9,0x3f4e8d90,0x3f5d2d53,0x3f696591
.long 0x3f45e403,0x3f5695e5,0x3f64aa59,0x3f6ff573,0x3f4d9f02,0x3f5df6be,0x3f6b4b0c,0x3f756d97
.long 0x3f6c835e,0x3f7853f8,0x3f7ec46d,0x3f7fb10f,0x3f710908,0x3f7b61fc,0x3f7fd397,0x3f7e4323
.long 0x3f74fa0b,0x3f7dabcc,0x3f7fec43,0x3f7baccd,0x3f7853f8,0x3f7f2f9d,0x3f7f0e58,0x3f77f110
.long 0x0,0x0,0x0,0x0,0x3d96a905,0x3da3308c,0x3dafb680,0x3dbc3ac3
.long 0x3e164083,0x3e22abb6,0x3e2f10a2,0x3e3b6ecf,0x3e605c13,0x3e72b651,0x3e827dc0,0x3e8b9507
.long 0x3f0e39da,0x3f187fc0,0x3f226799,0x3f2beb4a,0x3f1d7fd1,0x3f286605,0x3f32c8c9,0x3f3ca003
.long 0x3f2beb4a,0x3f373a23,0x3f41d870,0x3f4bbbf8,0x3f396842,0x3f44e3f5,0x3f4f7a1f,0x3f591e6a
.long 0x3f6c835e,0x3f74fa0b,0x3f7b14be,0x3f7ec46d,0x3f731447,0x3f7a1e84,0x3f7e70b0,0x3f7ffec4
.long 0x3f7853f8,0x3f7dabcc,0x3f7fec43,0x3f7f0e58,0x3f7c3b28,0x3f7f9c18,0x3f7f84ab,0x3f7bf531
.long 0x3f7b14be,0x3f710908,0x3f61c598,0x3f4d9f02,0x3f76ba07,0x3f696591,0x3f5695e5,0x3f3ebc1b
.long 0x3f710908,0x3f604621,0x3f49d112,0x3f2e3bde,0x3f6a09a7,0x3f55b993,0x3f3b8f3b,0x3f1c420c
.long 0x3f800000,0x3f7fec43,0x3f7fb10f,0x3f7f4e6d,0x3f800000,0x3f7fe129,0x3f7f84ab,0x3f7eea9d
.long 0x3f800000,0x3f7fd397,0x3f7f4e6d,0x3f7e70b0,0x3f800000,0x3f7fc38f,0x3f7f0e58,0x3f7de0b1
.long 0x3f800000,0x3f7f4e6d,0x3f7d3aac,0x3f79c79d,0x3f800000,0x3f7f2f9d,0x3f7cbfc9,0x3f78b47b
.long 0x3f800000,0x3f7f0e58,0x3f7c3b28,0x3f778bc5,0x3f800000,0x3f7eea9d,0x3f7baccd,0x3f764d97
.long 0x3f800000,0x3f7e1324,0x3f7853f8,0x3f6ed89e,0x3f800000,0x3f7de0b1,0x3f778bc5,0x3f6d1c1d
.long 0x3f800000,0x3f7dabcc,0x3f76ba07,0x3f6b4b0c,0x3f800000,0x3f7d7474,0x3f75dec6,0x3f696591
.long 0x3f800000,0x3f7c3b28,0x3f710908,0x3f5ebe05,0x3f800000,0x3f7bf531,0x3f6ff573,0x3f5c61c7
.long 0x3f800000,0x3f7baccd,0x3f6ed89e,0x3f59f26a,0x3f800000,0x3f7b61fc,0x3f6db293,0x3f577026
.long 0x3f7ec46d,0x3f7e1324,0x3f7d3aac,0x3f7c3b28,0x3f7e1324,0x3f7cfe73,0x3f7baccd,0x3f7a1e84
.long 0x3f7d3aac,0x3f7baccd,0x3f79c79d,0x3f778bc5,0x3f7c3b28,0x3f7a1e84,0x3f778bc5,0x3f748422
.long 0x3f74fa0b,0x3f6ed89e,0x3f676bd8,0x3f5ebe05,0x3f731447,0x3f6be858,0x3f633c5a,0x3f591e6a
.long 0x3f710908,0x3f68bf3c,0x3f5ebe05,0x3f531849,0x3f6ed89e,0x3f655e0b,0x3f59f26a,0x3f4cae79
.long 0x3f61c598,0x3f514d3d,0x3f3daef9,0x3f273656,0x3f5ebe05,0x3f4cae79,0x3f373a23,0x3f1ebc12
.long 0x3f5b941a,0x3f47de65,0x3f3085bb,0x3f15f6d9,0x3f584853,0x3f42de29,0x3f299415,0x3f0cead0
.long 0x3f45e403,0x3f273656,0x3f039c3d,0x3eb8442a,0x3f41d870,0x3f212ff9,0x3ef6e0cb,0x3ea395c5
.long 0x3f3daef9,0x3f1b02c6,0x3ee63375,0x3e8e9a22,0x3f396842,0x3f14b039,0x3ed53641,0x3e72b651
.long 0x3f7b14be,0x3f79c79d,0x3f7853f8,0x3f76ba07,0x3f7853f8,0x3f764d97,0x3f740bdd,0x3f718f57
.long 0x3f74fa0b,0x3f721352,0x3f6ed89e,0x3f6b4b0c,0x3f710908,0x3f6d1c1d,0x3f68bf3c,0x3f63f473
.long 0x3f54db31,0x3f49d112,0x3f3daef9,0x3f3085bb,0x3f4d9f02,0x3f40d0da,0x3f32c8c9,0x3f239da9
.long 0x3f45e403,0x3f373a23,0x3f273656,0x3f15f6d9,0x3f3daef9,0x3f2d1469,0x3f1b02c6,0x3f07a136
.long 0x3f0e39da,0x3ee63375,0x3eac7cd4,0x3e605c13,0x3f039c3d,0x3ecc9b8b,0x3e8e9a22,0x3e1c76de
.long 0x3ef15aea,0x3eb263ef,0x3e605c13,0x3dafb680,0x3edae880,0x3e97a117,0x3e22abb6,0x3c96c9b6
.long 0x3e47c5c2,0x3cc90ab0,0xbe164083,0xbea09ae5,0x3e164083,0xbcfb49ba,0xbe541501,0xbec1071e
.long 0x3dc8bd36,0xbdafb680,0xbe888e93,0xbee0924f,0x3d48fb30,0xbe1008b7,0xbea68f12,0xbeff17b2
.long 0x3f74fa0b,0x3f731447,0x3f710908,0x3f6ed89e,0x3f6ed89e,0x3f6be858,0x3f68bf3c,0x3f655e0b
.long 0x3f676bd8,0x3f633c5a,0x3f5ebe05,0x3f59f26a,0x3f5ebe05,0x3f591e6a,0x3f531849,0x3f4cae79
.long 0x3f226799,0x3f13682a,0x3f039c3d,0x3ee63375,0x3f13682a,0x3f0242b1,0x3ee0924f,0x3ebb31a0
.long 0x3f039c3d,0x3ee0924f,0x3eb8442a,0x3e8e9a22,0x3ee63375,0x3ebb31a0,0x3e8e9a22,0x3e419b37
.long 0x3dc8bd36,0xbcc90ab0,0xbe164083,0xbe888e93,0x3cc90ab0,0xbdd53db9,0xbe6c9a7f,0xbeb554ec
.long 0xbd48fb30,0xbe3b6ecf,0xbea09ae5,0xbee0924f,0xbdfab273,0xbe8586ce,0xbec9b953,0xbf04f484
.long 0xbef15aea,0xbf1d7fd1,0xbf3daef9,0xbf584853,0xbf08f59b,0xbf2d1469,0xbf4bbbf8,0xbf63f473
.long 0xbf187fc0,0xbf3b8f3b,0xbf584853,0xbf6db293,0xbf273656,0xbf48d8b3,0xbf633c5a,0xbf756d97
.long 0x0,0x3cc90ab0,0x3d48fb30,0x3d96a905,0x0,0x3cfb49ba,0x3d7b2b74,0x3dbc3ac3
.long 0x0,0x3d16c32c,0x3d96a905,0x3de1bc2e,0x0,0x3d2fe007,0x3dafb680,0x3e039502
.long 0x0,0x3d96a905,0x3e164083,0x3e605c13,0x0,0x3da3308c,0x3e22abb6,0x3e72b651
.long 0x0,0x3dafb680,0x3e2f10a2,0x3e827dc0,0x0,0x3dbc3ac3,0x3e3b6ecf,0x3e8b9507
.long 0x0,0x3dfab273,0x3e78cfcc,0x3eb8442a,0x0,0x3e039502,0x3e827dc0,0x3ec1071e
.long 0x0,0x3e09cf86,0x3e888e93,0x3ec9b953,0x0,0x3e1008b7,0x3e8e9a22,0x3ed25a09
.long 0x0,0x3e2f10a2,0x3eac7cd4,0x3efc5d27,0x0,0x3e354098,0x3eb263ef,0x3f0242b1
.long 0x0,0x3e3b6ecf,0x3eb8442a,0x3f064b82,0x0,0x3e419b37,0x3ebe1d4a,0x3f0a48ad
.long 0x3dc8bd36,0x3dfab273,0x3e164083,0x3e2f10a2,0x3dfab273,0x3e1c76de,0x3e3b6ecf,0x3e5a3997
.long 0x3e164083,0x3e3b6ecf,0x3e605c13,0x3e827dc0,0x3e2f10a2,0x3e5a3997,0x3e827dc0,0x3e97a117
.long 0x3e94a031,0x3eb8442a,0x3edae880,0x3efc5d27,0x3ea09ae5,0x3ec6d529,0x3eebcbbb,0x3f07a136
.long 0x3eac7cd4,0x3ed53641,0x3efc5d27,0x3f10d3cd,0x3eb8442a,0x3ee363fa,0x3f064b82,0x3f19c200
.long 0x3ef15aea,0x3f13682a,0x3f2beb4a,0x3f41d870,0x3efc5d27,0x3f19c200,0x3f32c8c9,0x3f48d8b3
.long 0x3f039c3d,0x3f1ff6cb,0x3f396842,0x3f4f7a1f,0x3f08f59b,0x3f26050a,0x3f3fc767,0x3f55b993
.long 0x3f226799,0x3f41d870,0x3f5b941a,0x3f6ed89e,0x3f273656,0x3f46e22a,0x3f604621,0x3f7294f8
.long 0x3f2beb4a,0x3f4bbbf8,0x3f64aa59,0x3f75dec6,0x3f3085bb,0x3f5064af,0x3f68bf3c,0x3f78b47b
.long 0x3e47c5c2,0x3e605c13,0x3e78cfcc,0x3e888e93,0x3e78cfcc,0x3e8b9507,0x3e9aa086,0x3ea986c4
.long 0x3e94a031,0x3ea68f12,0x3eb8442a,0x3ec9b953,0x3eac7cd4,0x3ec1071e,0x3ed53641,0x3ee900b7
.long 0x3f0e39da,0x3f1d7fd1,0x3f2beb4a,0x3f396842,0x3f187fc0,0x3f286605,0x3f373a23,0x3f44e3f5
.long 0x3f226799,0x3f32c8c9,0x3f41d870,0x3f4f7a1f,0x3f2beb4a,0x3f3ca003,0x3f4bbbf8,0x3f591e6a
.long 0x3f54db31,0x3f64aa59,0x3f710908,0x3f79c79d,0x3f5b941a,0x3f6aab7b,0x3f75dec6,0x3f7cfe73
.long 0x3f61c598,0x3f6ff573,0x3f79c79d,0x3f7f0e58,0x3f676bd8,0x3f748422,0x3f7cbfc9,0x3f7ff4e6
.long 0x3f7b14be,0x3f7fec43,0x3f7d3aac,0x3f731447,0x3f7d3aac,0x3f7fe129,0x3f7a7302,0x3f6d1c1d
.long 0x3f7ec46d,0x3f7f0e58,0x3f76ba07,0x3f660f88,0x3f7fb10f,0x3f7d7474,0x3f721352,0x3f5df6be
.long 0x3e94a031,0x3ea09ae5,0x3eac7cd4,0x3eb8442a,0x3eb8442a,0x3ec6d529,0x3ed53641,0x3ee363fa
.long 0x3edae880,0x3eebcbbb,0x3efc5d27,0x3f064b82,0x3efc5d27,0x3f07a136,0x3f10d3cd,0x3f19c200
.long 0x3f45e403,0x3f514d3d,0x3f5b941a,0x3f64aa59,0x3f514d3d,0x3f5c61c7,0x3f660f88,0x3f6e46be
.long 0x3f5b941a,0x3f660f88,0x3f6ed89e,0x3f75dec6,0x3f64aa59,0x3f6e46be,0x3f75dec6,0x3f7b61fc
.long 0x3f7ec46d,0x3f7fec43,0x3f7d3aac,0x3f76ba07,0x3f7fec43,0x3f7e9bc9,0x3f791298,0x3f6f6830
.long 0x3f7fb10f,0x3f7baccd,0x3f731447,0x3f660f88,0x3f7e1324,0x3f772417,0x3f6b4b0c,0x3f5ac450
.long 0x3f61c598,0x3f49d112,0x3f2beb4a,0x3f08f59b,0x3f584853,0x3f3ca003,0x3f1b02c6,0x3ee900b7
.long 0x3f4d9f02,0x3f2e3bde,0x3f08f59b,0x3ebe1d4a,0x3f41d870,0x3f1ebc12,0x3eebcbbb,0x3e919ddd
.long 0x3f800000,0x3f800000,0x3f800000,0x3f800000,0x3f7ec46d,0x3f7e9bc9,0x3f7e70b0,0x3f7e4323
.long 0x3f7b14be,0x3f7a7302,0x3f79c79d,0x3f791298,0x3f74fa0b,0x3f73913f,0x3f721352,0x3f708066
.long 0x3f3504f3,0x3f2beb4a,0x3f226799,0x3f187fc0,0x3f226799,0x3f173c07,0x3f0b9a6b,0x3eff17b2
.long 0x3f0e39da,0x3f00e7e4,0x3ee63375,0x3ec9b953,0x3ef15aea,0x3ed25a09,0x3eb263ef,0x3e919ddd
.long 0x248d3132,0xbdc8bd36,0xbe47c5c2,0xbe94a031,0xbdc8bd36,0xbe4dee60,0xbe9aa086,0xbecc9b8b
.long 0xbe47c5c2,0xbe9aa086,0xbecf7bca,0xbf00e7e4,0xbe94a031,0xbecc9b8b,0xbf00e7e4,0xbf19c200
.long 0xbf3504f3,0xbf4d9f02,0xbf61c598,0xbf710908,0xbf45e403,0xbf5c61c7,0xbf6db293,0xbf796e4e
.long 0xbf54db31,0xbf68bf3c,0xbf76ba07,0xbf7e70b0,0xbf61c598,0xbf7294f8,0xbf7cbfc9,0xbf7ffec4
.long 0x3f800000,0x3f800000,0x3f800000,0x3f800000,0x3f7e1324,0x3f7de0b1,0x3f7dabcc,0x3f7d7474
.long 0x3f7853f8,0x3f778bc5,0x3f76ba07,0x3f75dec6,0x3f6ed89e,0x3f6d1c1d,0x3f6b4b0c,0x3f696591
.long 0x3f0e39da,0x3f039c3d,0x3ef15aea,0x3edae880,0x3ee63375,0x3ecc9b8b,0x3eb263ef,0x3e97a117
.long 0x3eac7cd4,0x3e8e9a22,0x3e605c13,0x3e22abb6,0x3e605c13,0x3e1c76de,0x3dafb680,0x3c96c9b6
.long 0xbec3ef15,0xbef15aea,0xbf0e39da,0xbf226799,0xbefc5d27,0xbf14b039,0xbf299415,0xbf3ca003
.long 0xbf187fc0,0xbf2e3bde,0xbf41d870,0xbf531849,0xbf3085bb,0xbf44e3f5,0xbf5695e5,0xbf655e0b
.long 0xbf7b14be,0xbf7fb10f,0xbf7ec46d,0xbf7853f8,0xbf7f4e6d,0xbf7f2f9d,0xbf791298,0xbf6d1c1d
.long 0xbf7fb10f,0xbf7a7302,0xbf6ed89e,0xbf5d2d53,0xbf7c3b28,0xbf718f57,0xbf604621,0xbf48d8b3
.long 0x3f800000,0x3f800000,0x3f800000,0x3f800000,0x3f7d3aac,0x3f7cfe73,0x3f7cbfc9,0x3f7c7eb0
.long 0x3f74fa0b,0x3f740bdd,0x3f731447,0x3f721352,0x3f676bd8,0x3f655e0b,0x3f633c5a,0x3f6106f2
.long 0x3ec3ef15,0x3eac7cd4,0x3e94a031,0x3e78cfcc,0x3e78cfcc,0x3e419b37,0x3e09cf86,0x3da3308c
.long 0x3dc8bd36,0x3d16c32c,0xbcc90ab0,0xbdafb680,0xbd48fb30,0xbdee3876,0xbe3b6ecf,0xbe7ee6e1
.long 0xbf3504f3,0xbf45e403,0xbf54db31,0xbf61c598,0xbf4d9f02,0xbf5c61c7,0xbf68bf3c,0xbf7294f8
.long 0xbf61c598,0xbf6db293,0xbf76ba07,0xbf7cbfc9,0xbf710908,0xbf796e4e,0xbf7e70b0,0xbf7ffec4
.long 0xbf6c835e,0xbf5b941a,0xbf45e403,0xbf2beb4a,0xbf5b941a,0xbf44e3f5,0xbf299415,0xbf0a48ad
.long 0xbf45e403,0xbf299415,0xbf08f59b,0xbec9b953,0xbf2beb4a,0xbf0a48ad,0xbec9b953,0xbe72b651
.long 0x3f800000,0x3f800000,0x3f800000,0x3f800000,0x3f7c3b28,0x3f7bf531,0x3f7baccd,0x3f7b61fc
.long 0x3f710908,0x3f6ff573,0x3f6ed89e,0x3f6db293,0x3f5ebe05,0x3f5c61c7,0x3f59f26a,0x3f577026
.long 0x3e47c5c2,0x3e164083,0x3dc8bd36,0x3d48fb30,0x3cc90ab0,0xbcfb49ba,0xbdafb680,0xbe1008b7
.long 0xbe164083,0xbe541501,0xbe888e93,0xbea68f12,0xbea09ae5,0xbec1071e,0xbee0924f,0xbeff17b2
.long 0xbf6c835e,0xbf74fa0b,0xbf7b14be,0xbf7ec46d,0xbf79c79d,0xbf7e4323,0xbf7ffb11,0xbf7eea9d
.long 0xbf7fb10f,0xbf7f84ab,0xbf7c3b28,0xbf75dec6,0xbf7e1324,0xbf78b47b,0xbf6ff573,0xbf63f473
.long 0xbf0e39da,0xbedae880,0xbe94a031,0xbe164083,0xbecf7bca,0xbe8586ce,0xbde1bc2e,0x3d2fe007
.long 0xbe78cfcc,0xbdafb680,0x3d96a905,0x3e6c9a7f,0xbd96a905,0x3dbc3ac3,0x3e827dc0,0x3ed25a09
.long 0x0,0x0,0x0,0x0,0x3dc8bd36,0x3dd53db9,0x3de1bc2e,0x3dee3876
.long 0x3e47c5c2,0x3e541501,0x3e605c13,0x3e6c9a7f,0x3e94a031,0x3e9d9e78,0x3ea68f12,0x3eaf713a
.long 0x3f3504f3,0x3f3daef9,0x3f45e403,0x3f4d9f02,0x3f45e403,0x3f4e8d90,0x3f5695e5,0x3f5df6be
.long 0x3f54db31,0x3f5d2d53,0x3f64aa59,0x3f6b4b0c,0x3f61c598,0x3f696591,0x3f6ff573,0x3f756d97
.long 0x3f800000,0x3f7ec46d,0x3f7b14be,0x3f74fa0b,0x3f7ec46d,0x3f7ac516,0x3f740bdd,0x3f6aab7b
.long 0x3f7b14be,0x3f740bdd,0x3f6a09a7,0x3f5d2d53,0x3f74fa0b,0x3f6aab7b,0x3f5d2d53,0x3f4cae79
.long 0x3f3504f3,0x3f187fc0,0x3ef15aea,0x3eac7cd4,0x3f226799,0x3f0242b1,0x3ebe1d4a,0x3e667c66
.long 0x3f0e39da,0x3ed53641,0x3e888e93,0x3de1bc2e,0x3ef15aea,0x3ea395c5,0x3e22abb6,0xbbc90f88
.long 0x0,0x0,0x0,0x0,0x3dfab273,0x3e039502,0x3e09cf86,0x3e1008b7
.long 0x3e78cfcc,0x3e827dc0,0x3e888e93,0x3e8e9a22,0x3eb8442a,0x3ec1071e,0x3ec9b953,0x3ed25a09
.long 0x3f54db31,0x3f5b941a,0x3f61c598,0x3f676bd8,0x3f64aa59,0x3f6aab7b,0x3f6ff573,0x3f748422
.long 0x3f710908,0x3f75dec6,0x3f79c79d,0x3f7cbfc9,0x3f79c79d,0x3f7cfe73,0x3f7f0e58,0x3f7ff4e6
.long 0x3f6c835e,0x3f61c598,0x3f54db31,0x3f45e403,0x3f5ebe05,0x3f5064af,0x3f3fc767,0x3f2d1469
.long 0x3f4d9f02,0x3f3b8f3b,0x3f273656,0x3f10d3cd,0x3f396842,0x3f239da9,0x3f0b9a6b,0x3ee363fa
.long 0x3e47c5c2,0x3d48fb30,0xbdc8bd36,0xbe78cfcc,0x3d96a905,0xbda3308c,0xbe6c9a7f,0xbec1071e
.long 0xbd48fb30,0xbe541501,0xbeb8442a,0xbf00e7e4,0xbe2f10a2,0xbea986c4,0xbef6e0cb,0xbf1ebc12
.long 0x0,0x0,0x0,0x0,0x3e164083,0x3e1c76de,0x3e22abb6,0x3e28defc
.long 0x3e94a031,0x3e9aa086,0x3ea09ae5,0x3ea68f12,0x3edae880,0x3ee363fa,0x3eebcbbb,0x3ef41f07
.long 0x3f6c835e,0x3f710908,0x3f74fa0b,0x3f7853f8,0x3f7853f8,0x3f7b61fc,0x3f7dabcc,0x3f7f2f9d
.long 0x3f7ec46d,0x3f7fd397,0x3f7fec43,0x3f7f0e58,0x3f7fb10f,0x3f7e4323,0x3f7baccd,0x3f77f110
.long 0x3f3504f3,0x3f226799,0x3f0e39da,0x3ef15aea,0x3f187fc0,0x3f0242b1,0x3ed53641,0x3ea395c5
.long 0x3ef15aea,0x3ebe1d4a,0x3e888e93,0x3e22abb6,0x3eac7cd4,0x3e667c66,0x3de1bc2e,0xbbc90f88
.long 0xbec3ef15,0xbf039c3d,0xbf226799,0xbf3daef9,0xbf039c3d,0xbf239da9,0xbf3fc767,0xbf577026
.long 0xbf226799,0xbf3fc767,0xbf584853,0xbf6b4b0c,0xbf3daef9,0xbf577026,0xbf6b4b0c,0xbf78b47b
.long 0x0,0x0,0x0,0x0,0x3e2f10a2,0x3e354098,0x3e3b6ecf,0x3e419b37
.long 0x3eac7cd4,0x3eb263ef,0x3eb8442a,0x3ebe1d4a,0x3efc5d27,0x3f0242b1,0x3f064b82,0x3f0a48ad
.long 0x3f7b14be,0x3f7d3aac,0x3f7ec46d,0x3f7fb10f,0x3f7fec43,0x3f7fe129,0x3f7f0e58,0x3f7d7474
.long 0x3f7d3aac,0x3f7a7302,0x3f76ba07,0x3f721352,0x3f731447,0x3f6d1c1d,0x3f660f88,0x3f5df6be
.long 0x3ec3ef15,0x3e94a031,0x3e47c5c2,0x3dc8bd36,0x3e605c13,0x3dee3876,0x3c490e90,0xbdbc3ac3
.long 0x3d48fb30,0xbd7b2b74,0xbe2f10a2,0xbe8e9a22,0xbdfab273,0xbe72b651,0xbeb263ef,0xbee900b7
.long 0xbf54db31,0xbf676bd8,0xbf74fa0b,0xbf7d3aac,0xbf6a09a7,0xbf772417,0xbf7e70b0,0xbf7fc38f
.long 0xbf7853f8,0xbf7f0e58,0xbf7f4e6d,0xbf791298,0xbf7f4e6d,0xbf7eea9d,0xbf778bc5,0xbf696591
.long 0x3f6c835e,0x3f6a09a7,0x3f676bd8,0x3f64aa59,0x3f61c598,0x3f5df6be,0x3f59f26a,0x3f55b993
.long 0x3f54db31,0x3f4f7a1f,0x3f49d112,0x3f43e200,0x3f45e403,0x3f3ebc1b,0x3f373a23,0x3f2f61a5
.long 0x3ec3ef15,0x3ea09ae5,0x3e78cfcc,0x3e2f10a2,0x3e94a031,0x3e5a3997,0x3e09cf86,0x3d621469
.long 0x3e47c5c2,0x3de1bc2e,0x3cc90ab0,0xbd7b2b74,0x3dc8bd36,0x3bc90f88,0xbdafb680,0xbe354098
.long 0xbec3ef15,0xbefc5d27,0xbf187fc0,0xbf3085bb,0xbef15aea,0xbf14b039,0xbf2e3bde,0xbf44e3f5
.long 0xbf0e39da,0xbf299415,0xbf41d870,0xbf5695e5,0xbf226799,0xbf3ca003,0xbf531849,0xbf655e0b
.long 0xbf6c835e,0xbf79c79d,0xbf7fb10f,0xbf7e1324,0xbf74fa0b,0xbf7e4323,0xbf7f84ab,0xbf78b47b
.long 0xbf7b14be,0xbf7ffb11,0xbf7c3b28,0xbf6ff573,0xbf7ec46d,0xbf7eea9d,0xbf75dec6,0xbf63f473
.long 0x3f61c598,0x3f5ebe05,0x3f5b941a,0x3f584853,0x3f514d3d,0x3f4cae79,0x3f47de65,0x3f42de29
.long 0x3f3daef9,0x3f373a23,0x3f3085bb,0x3f299415,0x3f273656,0x3f1ebc12,0x3f15f6d9,0x3f0cead0
.long 0x3dc8bd36,0x3cc90ab0,0xbd48fb30,0xbdfab273,0xbcc90ab0,0xbdd53db9,0xbe3b6ecf,0xbe8586ce
.long 0xbe164083,0xbe6c9a7f,0xbea09ae5,0xbec9b953,0xbe888e93,0xbeb554ec,0xbee0924f,0xbf04f484
.long 0xbf45e403,0xbf584853,0xbf676bd8,0xbf731447,0xbf584853,0xbf6816a8,0xbf740bdd,0xbf7bf531
.long 0xbf676bd8,0xbf740bdd,0xbf7c3b28,0xbf7fd397,0xbf731447,0xbf7bf531,0xbf7fd397,0xbf7e9bc9
.long 0xbf74fa0b,0xbf64aa59,0xbf4d9f02,0xbf3085bb,0xbf6a09a7,0xbf53fac3,0xbf373a23,0xbf14b039
.long 0xbf5b941a,0xbf3fc767,0xbf1d7fd1,0xbeebcbbb,0xbf49d112,0xbf286605,0xbf00e7e4,0xbea986c4
.long 0x3f54db31,0x3f514d3d,0x3f4d9f02,0x3f49d112,0x3f3daef9,0x3f385216,0x3f32c8c9,0x3f2d1469
.long 0x3f226799,0x3f1b02c6,0x3f13682a,0x3f0b9a6b,0x3f039c3d,0x3ef41f07,0x3ee0924f,0x3ecc9b8b
.long 0xbe47c5c2,0xbe888e93,0xbeac7cd4,0xbecf7bca,0xbeac7cd4,0xbed25a09,0xbef6e0cb,0xbf0cead0
.long 0xbef15aea,0xbf0b9a6b,0xbf1d7fd1,0xbf2e3bde,0xbf187fc0,0xbf2ac082,0xbf3b8f3b,0xbf4ac77f
.long 0xbf7b14be,0xbf7f4e6d,0xbf7fb10f,0xbf7c3b28,0xbf7fb10f,0xbf7f2f9d,0xbf7a7302,0xbf718f57
.long 0xbf7ec46d,0xbf791298,0xbf6ed89e,0xbf604621,0xbf7853f8,0xbf6d1c1d,0xbf5d2d53,0xbf48d8b3
.long 0xbf0e39da,0xbecf7bca,0xbe78cfcc,0xbd96a905,0xbedae880,0xbe8586ce,0xbdafb680,0x3dbc3ac3
.long 0xbe94a031,0xbde1bc2e,0x3d96a905,0x3e827dc0,0xbe164083,0x3d2fe007,0x3e6c9a7f,0x3ed25a09
.long 0x3f45e403,0x3f41d870,0x3f3daef9,0x3f396842,0x3f273656,0x3f212ff9,0x3f1b02c6,0x3f14b039
.long 0x3f039c3d,0x3ef6e0cb,0x3ee63375,0x3ed53641,0x3eb8442a,0x3ea395c5,0x3e8e9a22,0x3e72b651
.long 0xbef15aea,0xbf08f59b,0xbf187fc0,0xbf273656,0xbf1d7fd1,0xbf2d1469,0xbf3b8f3b,0xbf48d8b3
.long 0xbf3daef9,0xbf4bbbf8,0xbf584853,0xbf633c5a,0xbf584853,0xbf63f473,0xbf6db293,0xbf756d97
.long 0xbf74fa0b,0xbf6a09a7,0xbf5b941a,0xbf49d112,0xbf64aa59,0xbf53fac3,0xbf3fc767,0xbf286605
.long 0xbf4d9f02,0xbf373a23,0xbf1d7fd1,0xbf00e7e4,0xbf3085bb,0xbf14b039,0xbeebcbbb,0xbea986c4
.long 0x3dc8bd36,0x3e888e93,0x3edae880,0x3f13682a,0x3e888e93,0x3eddbe79,0x3f15f6d9,0x3f385216
.long 0x3edae880,0x3f15f6d9,0x3f396842,0x3f5695e5,0x3f13682a,0x3f385216,0x3f5695e5,0x3f6d1c1d
.long 0x3ec3ef15,0x3ecf7bca,0x3edae880,0x3ee63375,0x3ef15aea,0x3eff17b2,0x3f064b82,0x3f0cead0
.long 0x3f0e39da,0x3f15f6d9,0x3f1d7fd1,0x3f24d225,0x3f226799,0x3f2ac082,0x3f32c8c9,0x3f3a7ca4
.long 0x3f6c835e,0x3f731447,0x3f7853f8,0x3f7c3b28,0x3f74fa0b,0x3f7a1e84,0x3f7dabcc,0x3f7f9c18
.long 0x3f7b14be,0x3f7e70b0,0x3f7fec43,0x3f7f84ab,0x3f7ec46d,0x3f7ffec4,0x3f7f0e58,0x3f7bf531
.long 0x3f6c835e,0x3f5ebe05,0x3f4d9f02,0x3f396842,0x3f61c598,0x3f5064af,0x3f3b8f3b,0x3f239da9
.long 0x3f54db31,0x3f3fc767,0x3f273656,0x3f0b9a6b,0x3f45e403,0x3f2d1469,0x3f10d3cd,0x3ee363fa
.long 0x3ec3ef15,0x3e605c13,0x3d48fb30,0xbdfab273,0x3e94a031,0x3dee3876,0xbd7b2b74,0xbe72b651
.long 0x3e47c5c2,0x3c490e90,0xbe2f10a2,0xbeb263ef,0x3dc8bd36,0xbdbc3ac3,0xbe8e9a22,0xbee900b7
.long 0x3ef15aea,0x3efc5d27,0x3f039c3d,0x3f08f59b,0x3f13682a,0x3f19c200,0x3f1ff6cb,0x3f26050a
.long 0x3f2beb4a,0x3f32c8c9,0x3f396842,0x3f3fc767,0x3f41d870,0x3f48d8b3,0x3f4f7a1f,0x3f55b993
.long 0x3f7ec46d,0x3f7fec43,0x3f7fb10f,0x3f7e1324,0x3f7fec43,0x3f7e9bc9,0x3f7baccd,0x3f772417
.long 0x3f7d3aac,0x3f791298,0x3f731447,0x3f6b4b0c,0x3f76ba07,0x3f6f6830,0x3f660f88,0x3f5ac450
.long 0x3f226799,0x3f08f59b,0x3edae880,0x3ea09ae5,0x3f08f59b,0x3ed8106b,0x3e9aa086,0x3e354098
.long 0x3edae880,0x3e9aa086,0x3e2f10a2,0x3d16c32c,0x3ea09ae5,0x3e354098,0x3d16c32c,0xbdd53db9
.long 0xbe94a031,0xbee63375,0xbf187fc0,0xbf396842,0xbecf7bca,0xbf0f8784,0xbf32c8c9,0xbf5064af
.long 0xbf039c3d,0xbf299415,0xbf49d112,0xbf633c5a,0xbf1d7fd1,0xbf40d0da,0xbf5d2d53,0xbf718f57
.long 0x3f0e39da,0x3f13682a,0x3f187fc0,0x3f1d7fd1,0x3f2beb4a,0x3f31a81d,0x3f373a23,0x3f3ca003
.long 0x3f45e403,0x3f4bbbf8,0x3f514d3d,0x3f5695e5,0x3f5b941a,0x3f6106f2,0x3f660f88,0x3f6aab7b
.long 0x3f7b14be,0x3f76ba07,0x3f710908,0x3f6a09a7,0x3f710908,0x3f696591,0x3f604621,0x3f55b993
.long 0x3f61c598,0x3f5695e5,0x3f49d112,0x3f3b8f3b,0x3f4d9f02,0x3f3ebc1b,0x3f2e3bde,0x3f1c420c
.long 0x3e47c5c2,0x3d96a905,0xbd48fb30,0xbe2f10a2,0x3d48fb30,0xbda3308c,0xbe541501,0xbea986c4
.long 0xbdc8bd36,0xbe6c9a7f,0xbeb8442a,0xbef6e0cb,0xbe78cfcc,0xbec1071e,0xbf00e7e4,0xbf1ebc12
.long 0xbf54db31,0xbf6a09a7,0xbf7853f8,0xbf7f4e6d,0xbf676bd8,0xbf772417,0xbf7f0e58,0xbf7eea9d
.long 0xbf74fa0b,0xbf7e70b0,0xbf7f4e6d,0xbf778bc5,0xbf7d3aac,0xbf7fc38f,0xbf791298,0xbf696591
.long 0x3f226799,0x3f273656,0x3f2beb4a,0x3f3085bb,0x3f41d870,0x3f46e22a,0x3f4bbbf8,0x3f5064af
.long 0x3f5b941a,0x3f604621,0x3f64aa59,0x3f68bf3c,0x3f6ed89e,0x3f7294f8,0x3f75dec6,0x3f78b47b
.long 0x3f61c598,0x3f584853,0x3f4d9f02,0x3f41d870,0x3f49d112,0x3f3ca003,0x3f2e3bde,0x3f1ebc12
.long 0x3f2beb4a,0x3f1b02c6,0x3f08f59b,0x3eebcbbb,0x3f08f59b,0x3ee900b7,0x3ebe1d4a,0x3e919ddd
.long 0xbe94a031,0xbecf7bca,0xbf039c3d,0xbf1d7fd1,0xbee63375,0xbf0f8784,0xbf299415,0xbf40d0da
.long 0xbf187fc0,0xbf32c8c9,0xbf49d112,0xbf5d2d53,0xbf396842,0xbf5064af,0xbf633c5a,0xbf718f57
.long 0xbf7ec46d,0xbf76ba07,0xbf676bd8,0xbf514d3d,0xbf76ba07,0xbf66becc,0xbf4f7a1f,0xbf31a81d
.long 0xbf676bd8,0xbf4f7a1f,0xbf3085bb,0xbf0b9a6b,0xbf514d3d,0xbf31a81d,0xbf0b9a6b,0xbec1071e
.long 0x3f803f80,0x3f803f80,0x3f803f80,0x3f803f80,0x3f7b3f80,0x3f553f6d,0xbf7bbf80,0xbf55bf6d
.long 0x3f6d3f80,0x3ec43f35,0x3f6d3f80,0x3ec43f35,0x3f553f80,0xbe483ec4,0xbf55bf80,0x3e48bec4
.long 0x3f353f80,0xbf35248d,0x3f353f80,0xbf35261f,0x3f0e3f80,0xbf7bbec4,0xbf0ebf80,0x3f7b3ec4
.long 0x3ec43f80,0xbf6dbf35,0x3ec43f80,0xbf6dbf35,0x3e483f80,0xbf0ebf6d,0xbe48bf80,0x3f0e3f6d
.long 0x248d3f80,0xa554bf80,0xa6543f80,0xa754bf80,0xbe483f80,0x3f0ebf6d,0x3e48bf80,0xbf0e3f6d
.long 0xbec43f80,0x3f6dbf35,0xbec43f80,0x3f6dbf35,0xbf0e3f80,0x3f7bbec4,0x3f0ebf80,0xbf7b3ec4
.long 0xbf353f80,0x3f35a554,0xbf353f80,0x3f35a777,0xbf553f80,0x3e483ec4,0x3f55bf80,0xbe48bec4
.long 0xbf6d3f80,0xbec43f35,0xbf6d3f80,0xbec43f35,0xbf7b3f80,0xbf553f6d,0x3f7bbf80,0x3f55bf6d
.long 0x3f803f80,0x3f803f80,0x3f803f80,0x3f803f80,0x3f0e3f35,0x3e483ec4,0xbf0ebf35,0xbe48bec4
.long 0xbec4248d,0xbf6dbf35,0xbec425b0,0xbf6dbf35,0xbf7bbf35,0xbf0ebf6d,0x3f7b3f35,0x3f0e3f6d
.long 0xbf35bf80,0x3f35a554,0xbf35bf80,0x3f35a731,0x3e48bf35,0x3f553f6d,0xbe483f35,0xbf55bf6d
.long 0x3f6da554,0xbec43f35,0x3f6da742,0xbec43f35,0x3f553f35,0xbf7bbec4,0xbf55bf35,0x3f7b3ec4
.long 0x25b03f80,0xa5f7bf80,0xa60d3f80,0xa765bf80,0xbf553f35,0x3f7bbec4,0x3f55bf35,0xbf7b3ec4
.long 0xbf6d25b0,0x3ec43f35,0xbf6da58e,0x3ec43f35,0xbe48bf35,0xbf553f6d,0x3e483f35,0x3f55bf6d
.long 0x3f35bf80,0xbf35261f,0x3f35bf80,0xbf352804,0x3f7bbf35,0x3f0ebf6d,0xbf7b3f35,0xbf0e3f6d
.long 0x3ec4a5f7,0x3f6dbf35,0x3ec4a78d,0x3f6dbf35,0xbf0e3f35,0xbe483ec4,0x3f0ebf35,0x3e48bec4
.long 0x3f803f80,0x3f803f80,0x3f803f80,0x3f803f80,0xbe48248d,0xbf0ebec4,0x3e48a554,0x3f0e3ec4
.long 0xbf6dbf80,0xbec4bf35,0xbf6dbf80,0xbec4bf35,0x3f0ea554,0x3f7b3f6d,0xbf0e261f,0xbf7bbf6d
.long 0x3f353f80,0xbf3525b0,0x3f353f80,0xbf35a68d,0xbf5525b0,0xbe48bf6d,0x3f55a742,0x3e483f6d
.long 0xbec4bf80,0x3f6d3f35,0xbec4bf80,0x3f6d3f35,0x3f7ba5f7,0xbf553ec4,0xbf7ba60d,0x3f55bec4
.long 0x261f3f80,0xa731bf80,0xa58e3f80,0xa777bf80,0xbf7b261f,0x3f553ec4,0x3f7ba777,0xbf55bec4
.long 0x3ec4bf80,0xbf6d3f35,0x3ec4bf80,0xbf6d3f35,0x3f55a731,0x3e48bf6d,0xbf55258d,0xbe483f6d
.long 0xbf353f80,0x3f35a742,0xbf353f80,0x3f352754,0xbf0ea68d,0xbf7b3f6d,0x3f0ea796,0x3f7bbf6d
.long 0x3f6dbf80,0x3ec4bf35,0x3f6dbf80,0x3ec4bf35,0x3e48a742,0x3f0ebec4,0xbe48268d,0xbf0e3ec4
.long 0x3f803f80,0x3f803f80,0x3f803f80,0x3f803f80,0xbf55bf35,0xbf7bbf6d,0x3f553f35,0x3f7b3f6d
.long 0x3ec4a554,0x3f6d3f35,0x3ec4a5f7,0x3f6d3f35,0x3e483f35,0xbf55bec4,0xbe48bf35,0x3f553ec4
.long 0xbf35bf80,0x3f35a5f7,0xbf35bf80,0x3f35a742,0x3f7b3f35,0xbf0e3ec4,0xbf7bbf35,0x3f0ebec4
.long 0xbf6d261f,0x3ec4bf35,0xbf6da60d,0x3ec4bf35,0x3f0ebf35,0xbe483f6d,0xbf0e3f35,0x3e48bf6d
.long 0xa68d3f80,0xa742bf80,0xa1373f80,0xa784bf80,0xbf0ebf35,0x3e483f6d,0x3f0e3f35,0xbe48bf6d
.long 0x3f6da742,0xbec4bf35,0x3f6da78d,0xbec4bf35,0xbf7b3f35,0x3f0e3ec4,0x3f7bbf35,0xbf0ebec4
.long 0x3f35bf80,0xbf35a60d,0x3f35bf80,0xbf352889,0xbe483f35,0x3f55bec4,0x3e48bf35,0xbf553ec4
.long 0xbec4a60d,0xbf6d3f35,0xbec42816,0xbf6d3f35,0x3f55bf35,0x3f7bbf6d,0xbf553f35,0xbf7b3f6d
.long 0x0,0x0,0x0,0x0,0x3e480000,0x3f0e3ec4,0xbe48250d,0xbf0ebec4
.long 0x3ec40000,0x3f6d3f35,0x3ec4a58d,0x3f6d3f35,0x3f0e0000,0x3f7b3f6d,0xbf0e25d4,0xbf7bbf6d
.long 0x3f350000,0x3f353f80,0x3f35a60d,0x3f353f80,0x3f550000,0x3e483f6d,0xbf552630,0xbe48bf6d
.long 0x3f6d0000,0xbec43f35,0x3f6da654,0xbec43f35,0x3f7b0000,0xbf553ec4,0xbf7b2677,0x3f55bec4
.long 0x3f800000,0xbf80250d,0x3f80a68d,0xbf80269f,0x3f7b0000,0xbf55bec4,0xbf7b269f,0x3f553ec4
.long 0x3f6d0000,0xbec4bf35,0x3f6da6b0,0xbec4bf35,0x3f550000,0x3e48bf6d,0xbf5527b1,0xbe483f6d
.long 0x3f350000,0x3f35bf80,0x3f35a6d4,0x3f35bf80,0x3f0e0000,0x3f7bbf6d,0xbf0ea70d,0xbf7b3f6d
.long 0x3ec40000,0x3f6dbf35,0x3ec4a6f7,0x3f6dbf35,0x3e480000,0x3f0ebec4,0xbe4827c2,0xbf0e3ec4
.long 0x0,0x0,0x0,0x0,0x3f553f35,0x3f7b3f6d,0xbf55bf35,0xbf7bbf6d
.long 0x3f6d3f80,0x3ec43f35,0x3f6d3f80,0x3ec43f35,0x3e483f35,0xbf55bec4,0xbe48bf35,0x3f553ec4
.long 0xbf35250d,0xbf35bf80,0xbf352630,0xbf35bf80,0xbf7bbf35,0x3f0ebec4,0x3f7b3f35,0xbf0e3ec4
.long 0xbec4bf80,0x3f6d3f35,0xbec4bf80,0x3f6d3f35,0x3f0ebf35,0xbe483f6d,0xbf0e3f35,0x3e48bf6d
.long 0x3f80a58d,0xbf8025d4,0x3f80a6b0,0xbf8027b1,0x3f0e3f35,0xbe48bf6d,0xbf0ebf35,0x3e483f6d
.long 0xbec43f80,0x3f6dbf35,0xbec43f80,0x3f6dbf35,0xbf7b3f35,0x3f0e3ec4,0x3f7bbf35,0xbf0ebec4
.long 0xbf3525d4,0xbf353f80,0xbf3527c2,0xbf353f80,0x3e48bf35,0xbf553ec4,0xbe483f35,0x3f55bec4
.long 0x3f6dbf80,0x3ec4bf35,0x3f6dbf80,0x3ec4bf35,0x3f55bf35,0x3f7bbf6d,0xbf553f35,0xbf7b3f6d
.long 0x0,0x0,0x0,0x0,0x3f7b3f80,0x3f553f6d,0xbf7bbf80,0xbf55bf6d
.long 0xbec4250d,0xbf6dbf35,0xbec425d4,0xbf6dbf35,0xbf55bf80,0x3e48bec4,0x3f553f80,0xbe483ec4
.long 0x3f35a58d,0x3f353f80,0x3f35a654,0x3f353f80,0x3f0e3f80,0xbf7bbec4,0xbf0ebf80,0x3f7b3ec4
.long 0xbf6d25d4,0x3ec4bf35,0xbf6d269f,0x3ec4bf35,0xbe48bf80,0x3f0e3f6d,0x3e483f80,0xbf0ebf6d
.long 0x3f80a60d,0xbf802630,0x3f80a6d4,0xbf80a70d,0xbe483f80,0x3f0ebf6d,0x3e48bf80,0xbf0e3f6d
.long 0xbf6d2630,0x3ec43f35,0xbf6d27c2,0x3ec43f35,0x3f0ebf80,0xbf7b3ec4,0xbf0e3f80,0x3f7bbec4
.long 0x3f35a654,0x3f35bf80,0x3f35a71f,0x3f35bf80,0xbf553f80,0x3e483ec4,0x3f55bf80,0xbe48bec4
.long 0xbec42677,0xbf6d3f35,0xbec4a68d,0xbf6d3f35,0x3f7bbf80,0x3f55bf6d,0xbf7b3f80,0xbf553f6d
.long 0x0,0x0,0x0,0x0,0x3f0e3f35,0x3e483ec4,0xbf0ebf35,0xbe48bec4
.long 0xbf6dbf80,0xbec4bf35,0xbf6dbf80,0xbec4bf35,0x3f7b3f35,0x3f0e3f6d,0xbf7bbf35,0xbf0ebf6d
.long 0xbf3525d4,0xbf35bf80,0xbf352677,0xbf35bf80,0x3e48bf35,0x3f553f6d,0xbe483f35,0xbf55bf6d
.long 0x3ec43f80,0xbf6dbf35,0x3ec43f80,0xbf6dbf35,0xbf55bf35,0x3f7b3ec4,0x3f553f35,0xbf7bbec4
.long 0x3f80a654,0xbf802677,0x3f80a6f7,0xbf8027c2,0xbf553f35,0x3f7bbec4,0x3f55bf35,0xbf7b3ec4
.long 0x3ec4bf80,0xbf6d3f35,0x3ec4bf80,0xbf6d3f35,0x3e483f35,0x3f55bf6d,0xbe48bf35,0xbf553f6d
.long 0xbf35269f,0xbf353f80,0xbf35a68d,0xbf353f80,0x3f7bbf35,0x3f0ebf6d,0xbf7b3f35,0xbf0e3f6d
.long 0xbf6d3f80,0xbec43f35,0xbf6d3f80,0xbec43f35,0x3f0ebf35,0x3e48bec4,0xbf0e3f35,0xbe483ec4
.long 0xbf80bf80,0xbf80bf80,0xbf80bf80,0xbf80bf80,0xbf7bbf80,0xbf55bf6d,0x3f7b3f80,0x3f553f6d
.long 0xbf6dbf80,0xbec4bf35,0xbf6dbf80,0xbec4bf35,0xbf55bf80,0x3e48bec4,0x3f553f80,0xbe483ec4
.long 0xbf35bf80,0x3f35a48d,0xbf35bf80,0x3f35a61f,0xbf0ebf80,0x3f7b3ec4,0x3f0e3f80,0xbf7bbec4
.long 0xbec4bf80,0x3f6d3f35,0xbec4bf80,0x3f6d3f35,0xbe48bf80,0x3f0e3f6d,0x3e483f80,0xbf0ebf6d
.long 0xa48dbf80,0x25543f80,0x2654bf80,0x27543f80,0x3e48bf80,0xbf0e3f6d,0xbe483f80,0x3f0ebf6d
.long 0x3ec4bf80,0xbf6d3f35,0x3ec4bf80,0xbf6d3f35,0x3f0ebf80,0xbf7b3ec4,0xbf0e3f80,0x3f7bbec4
.long 0x3f35bf80,0xbf352554,0x3f35bf80,0xbf352777,0x3f55bf80,0xbe48bec4,0xbf553f80,0x3e483ec4
.long 0x3f6dbf80,0x3ec4bf35,0x3f6dbf80,0x3ec4bf35,0x3f7bbf80,0x3f55bf6d,0xbf7b3f80,0xbf553f6d
.long 0xbf80bf80,0xbf80bf80,0xbf80bf80,0xbf80bf80,0xbf0ebf35,0xbe48bec4,0x3f0e3f35,0x3e483ec4
.long 0x3ec4a48d,0x3f6d3f35,0x3ec4a5b0,0x3f6d3f35,0x3f7b3f35,0x3f0e3f6d,0xbf7bbf35,0xbf0ebf6d
.long 0x3f353f80,0xbf352554,0x3f353f80,0xbf352731,0xbe483f35,0xbf55bf6d,0x3e48bf35,0x3f553f6d
.long 0xbf6d2554,0x3ec4bf35,0xbf6d2742,0x3ec4bf35,0xbf55bf35,0x3f7b3ec4,0x3f553f35,0xbf7bbec4
.long 0xa5b0bf80,0x25f73f80,0x260dbf80,0x27653f80,0x3f55bf35,0xbf7b3ec4,0xbf553f35,0x3f7bbec4
.long 0x3f6da5b0,0xbec4bf35,0x3f6d258e,0xbec4bf35,0x3e483f35,0x3f55bf6d,0xbe48bf35,0xbf553f6d
.long 0xbf353f80,0x3f35a61f,0xbf353f80,0x3f35a804,0xbf7b3f35,0xbf0e3f6d,0x3f7bbf35,0x3f0ebf6d
.long 0xbec425f7,0xbf6d3f35,0xbec4278d,0xbf6d3f35,0x3f0ebf35,0x3e48bec4,0xbf0e3f35,0xbe483ec4
.long 0xbf80bf80,0xbf80bf80,0xbf80bf80,0xbf80bf80,0x3e48a48d,0x3f0e3ec4,0xbe482554,0xbf0ebec4
.long 0x3f6d3f80,0x3ec43f35,0x3f6d3f80,0x3ec43f35,0xbf0e2554,0xbf7bbf6d,0x3f0ea61f,0x3f7b3f6d
.long 0xbf35bf80,0x3f35a5b0,0xbf35bf80,0x3f35268d,0x3f55a5b0,0x3e483f6d,0xbf552742,0xbe48bf6d
.long 0x3ec43f80,0xbf6dbf35,0x3ec43f80,0xbf6dbf35,0xbf7b25f7,0x3f55bec4,0x3f7b260d,0xbf553ec4
.long 0xa61fbf80,0x27313f80,0x258ebf80,0x27773f80,0x3f7ba61f,0xbf55bec4,0xbf7b2777,0x3f553ec4
.long 0xbec43f80,0x3f6dbf35,0xbec43f80,0x3f6dbf35,0xbf552731,0xbe483f6d,0x3f55a58d,0x3e48bf6d
.long 0x3f35bf80,0xbf352742,0x3f35bf80,0xbf35a754,0x3f0e268d,0x3f7bbf6d,0xbf0e2796,0xbf7b3f6d
.long 0xbf6d3f80,0xbec43f35,0xbf6d3f80,0xbec43f35,0xbe482742,0xbf0e3ec4,0x3e48a68d,0x3f0ebec4
.long 0xbf80bf80,0xbf80bf80,0xbf80bf80,0xbf80bf80,0x3f553f35,0x3f7b3f6d,0xbf55bf35,0xbf7bbf6d
.long 0xbec42554,0xbf6dbf35,0xbec425f7,0xbf6dbf35,0xbe48bf35,0x3f553ec4,0x3e483f35,0xbf55bec4
.long 0x3f353f80,0xbf3525f7,0x3f353f80,0xbf352742,0xbf7bbf35,0x3f0ebec4,0x3f7b3f35,0xbf0e3ec4
.long 0x3f6da61f,0xbec43f35,0x3f6d260d,0xbec43f35,0xbf0e3f35,0x3e48bf6d,0x3f0ebf35,0xbe483f6d
.long 0x268dbf80,0x27423f80,0x2137bf80,0x27843f80,0x3f0e3f35,0xbe48bf6d,0xbf0ebf35,0x3e483f6d
.long 0xbf6d2742,0x3ec43f35,0xbf6d278d,0x3ec43f35,0x3f7bbf35,0xbf0ebec4,0xbf7b3f35,0x3f0e3ec4
.long 0xbf353f80,0x3f35260d,0xbf353f80,0x3f35a889,0x3e48bf35,0xbf553ec4,0xbe483f35,0x3f55bec4
.long 0x3ec4260d,0x3f6dbf35,0x3ec4a816,0x3f6dbf35,0xbf553f35,0xbf7b3f6d,0x3f55bf35,0x3f7bbf6d
.long 0x80008000,0x80008000,0x80008000,0x80008000,0xbe488000,0xbf0ebec4,0x3e48a50d,0x3f0e3ec4
.long 0xbec48000,0xbf6dbf35,0xbec4258d,0xbf6dbf35,0xbf0e8000,0xbf7bbf6d,0x3f0ea5d4,0x3f7b3f6d
.long 0xbf358000,0xbf35bf80,0xbf35260d,0xbf35bf80,0xbf558000,0xbe48bf6d,0x3f55a630,0x3e483f6d
.long 0xbf6d8000,0x3ec4bf35,0xbf6d2654,0x3ec4bf35,0xbf7b8000,0x3f55bec4,0x3f7ba677,0xbf553ec4
.long 0xbf808000,0x3f80a50d,0xbf80268d,0x3f80a69f,0xbf7b8000,0x3f553ec4,0x3f7ba69f,0xbf55bec4
.long 0xbf6d8000,0x3ec43f35,0xbf6d26b0,0x3ec43f35,0xbf558000,0xbe483f6d,0x3f55a7b1,0x3e48bf6d
.long 0xbf358000,0xbf353f80,0xbf3526d4,0xbf353f80,0xbf0e8000,0xbf7b3f6d,0x3f0e270d,0x3f7bbf6d
.long 0xbec48000,0xbf6d3f35,0xbec426f7,0xbf6d3f35,0xbe488000,0xbf0e3ec4,0x3e48a7c2,0x3f0ebec4
.long 0x80008000,0x80008000,0x80008000,0x80008000,0xbf55bf35,0xbf7bbf6d,0x3f553f35,0x3f7b3f6d
.long 0xbf6dbf80,0xbec4bf35,0xbf6dbf80,0xbec4bf35,0xbe48bf35,0x3f553ec4,0x3e483f35,0xbf55bec4
.long 0x3f35a50d,0x3f353f80,0x3f35a630,0x3f353f80,0x3f7b3f35,0xbf0e3ec4,0xbf7bbf35,0x3f0ebec4
.long 0x3ec43f80,0xbf6dbf35,0x3ec43f80,0xbf6dbf35,0xbf0e3f35,0x3e48bf6d,0x3f0ebf35,0xbe483f6d
.long 0xbf80258d,0x3f80a5d4,0xbf8026b0,0x3f80a7b1,0xbf0ebf35,0x3e483f6d,0x3f0e3f35,0xbe48bf6d
.long 0x3ec4bf80,0xbf6d3f35,0x3ec4bf80,0xbf6d3f35,0x3f7bbf35,0xbf0ebec4,0xbf7b3f35,0x3f0e3ec4
.long 0x3f35a5d4,0x3f35bf80,0x3f35a7c2,0x3f35bf80,0xbe483f35,0x3f55bec4,0x3e48bf35,0xbf553ec4
.long 0xbf6d3f80,0xbec43f35,0xbf6d3f80,0xbec43f35,0xbf553f35,0xbf7b3f6d,0x3f55bf35,0x3f7bbf6d
.long 0x80008000,0x80008000,0x80008000,0x80008000,0xbf7bbf80,0xbf55bf6d,0x3f7b3f80,0x3f553f6d
.long 0x3ec4a50d,0x3f6d3f35,0x3ec4a5d4,0x3f6d3f35,0x3f553f80,0xbe483ec4,0xbf55bf80,0x3e48bec4
.long 0xbf35258d,0xbf35bf80,0xbf352654,0xbf35bf80,0xbf0ebf80,0x3f7b3ec4,0x3f0e3f80,0xbf7bbec4
.long 0x3f6da5d4,0xbec43f35,0x3f6da69f,0xbec43f35,0x3e483f80,0xbf0ebf6d,0xbe48bf80,0x3f0e3f6d
.long 0xbf80260d,0x3f80a630,0xbf8026d4,0x3f80270d,0x3e48bf80,0xbf0e3f6d,0xbe483f80,0x3f0ebf6d
.long 0x3f6da630,0xbec4bf35,0x3f6da7c2,0xbec4bf35,0xbf0e3f80,0x3f7bbec4,0x3f0ebf80,0xbf7b3ec4
.long 0xbf352654,0xbf353f80,0xbf35271f,0xbf353f80,0x3f55bf80,0xbe48bec4,0xbf553f80,0x3e483ec4
.long 0x3ec4a677,0x3f6dbf35,0x3ec4268d,0x3f6dbf35,0xbf7b3f80,0xbf553f6d,0x3f7bbf80,0x3f55bf6d
.long 0x80008000,0x80008000,0x80008000,0x80008000,0xbf0ebf35,0xbe48bec4,0x3f0e3f35,0x3e483ec4
.long 0x3f6d3f80,0x3ec43f35,0x3f6d3f80,0x3ec43f35,0xbf7bbf35,0xbf0ebf6d,0x3f7b3f35,0x3f0e3f6d
.long 0x3f35a5d4,0x3f353f80,0x3f35a677,0x3f353f80,0xbe483f35,0xbf55bf6d,0x3e48bf35,0x3f553f6d
.long 0xbec4bf80,0x3f6d3f35,0xbec4bf80,0x3f6d3f35,0x3f553f35,0xbf7bbec4,0xbf55bf35,0x3f7b3ec4
.long 0xbf802654,0x3f80a677,0xbf8026f7,0x3f80a7c2,0x3f55bf35,0xbf7b3ec4,0xbf553f35,0x3f7bbec4
.long 0xbec43f80,0x3f6dbf35,0xbec43f80,0x3f6dbf35,0xbe48bf35,0xbf553f6d,0x3e483f35,0x3f55bf6d
.long 0x3f35a69f,0x3f35bf80,0x3f35268d,0x3f35bf80,0xbf7b3f35,0xbf0e3f6d,0x3f7bbf35,0x3f0ebf6d
.long 0x3f6dbf80,0x3ec4bf35,0x3f6dbf80,0x3ec4bf35,0xbf0e3f35,0xbe483ec4,0x3f0ebf35,0x3e48bec4
.long 0xbf803f80,0xbf803f80,0xbf803f80,0xbf803f80,0xbf7b3f80,0xbf553f6d,0x3f7bbf80,0x3f55bf6d
.long 0xbf6d3f80,0xbec43f35,0xbf6d3f80,0xbec43f35,0xbf553f80,0x3e483ec4,0x3f55bf80,0xbe48bec4
.long 0xbf353f80,0x3f3525b0,0xbf353f80,0x3f35268d,0xbf0e3f80,0x3f7bbec4,0x3f0ebf80,0xbf7b3ec4
.long 0xbec43f80,0x3f6dbf35,0xbec43f80,0x3f6dbf35,0xbe483f80,0x3f0ebf6d,0x3e48bf80,0xbf0e3f6d
.long 0xa5543f80,0x261fbf80,0x28283f80,0x281fbf80,0x3e483f80,0xbf0ebf6d,0xbe48bf80,0x3f0e3f6d
.long 0x3ec43f80,0xbf6dbf35,0x3ec43f80,0xbf6dbf35,0x3f0e3f80,0xbf7bbec4,0xbf0ebf80,0x3f7b3ec4
.long 0x3f353f80,0xbf35a5f7,0x3f353f80,0xbf3526d4,0x3f553f80,0xbe483ec4,0xbf55bf80,0x3e48bec4
.long 0x3f6d3f80,0x3ec43f35,0x3f6d3f80,0x3ec43f35,0x3f7b3f80,0x3f553f6d,0xbf7bbf80,0xbf55bf6d
.long 0xbf803f80,0xbf803f80,0xbf803f80,0xbf803f80,0xbf0e3f35,0xbe483ec4,0x3f0ebf35,0x3e48bec4
.long 0x3ec4261f,0x3f6dbf35,0x3ec4268d,0x3f6dbf35,0x3f7bbf35,0x3f0ebf6d,0xbf7b3f35,0xbf0e3f6d
.long 0x3f35bf80,0xbf35a742,0x3f35bf80,0xbf35a85d,0xbe48bf35,0xbf553f6d,0x3e483f35,0x3f55bf6d
.long 0xbf6da731,0x3ec43f35,0xbf6d270d,0x3ec43f35,0xbf553f35,0x3f7bbec4,0x3f55bf35,0xbf7b3ec4
.long 0xa7423f80,0xa60dbf80,0x26d43f80,0x2730bf80,0x3f553f35,0xbf7bbec4,0xbf55bf35,0x3f7b3ec4
.long 0x3f6da68d,0xbec43f35,0x3f6d2828,0xbec43f35,0x3e48bf35,0x3f553f6d,0xbe483f35,0xbf55bf6d
.long 0xbf35bf80,0x3f35a60d,0xbf35bf80,0x3f35289a,0xbf7bbf35,0xbf0ebf6d,0x3f7b3f35,0x3f0e3f6d
.long 0xbec4a742,0xbf6dbf35,0xbec4a7e5,0xbf6dbf35,0x3f0e3f35,0x3e483ec4,0xbf0ebf35,0xbe48bec4
.long 0xbf803f80,0xbf803f80,0xbf803f80,0xbf803f80,0x3e48a654,0x3f0ebec4,0xbe48a7b1,0xbf0e3ec4
.long 0x3f6dbf80,0x3ec4bf35,0x3f6dbf80,0x3ec4bf35,0xbf0ea754,0xbf7b3f6d,0x3f0e281f,0x3f7bbf6d
.long 0xbf353f80,0x3f35a58e,0xbf353f80,0x3f35a7b1,0x3f55a60d,0x3e48bf6d,0xbf5526d4,0xbe483f6d
.long 0x3ec4bf80,0xbf6d3f35,0x3ec4bf80,0xbf6d3f35,0xbf7ba765,0x3f553ec4,0x3f7b2730,0xbf55bec4
.long 0xa7773f80,0x2804bf80,0xa7e53f80,0x2839bf80,0x3f7ba58e,0xbf553ec4,0xbf7ba7e5,0x3f55bec4
.long 0xbec4bf80,0x3f6d3f35,0xbec4bf80,0x3f6d3f35,0xbf55a777,0xbe48bf6d,0x3f552839,0x3e483f6d
.long 0x3f353f80,0xbf35a78d,0x3f353f80,0xbf3528be,0x3f0ea137,0x3f7b3f6d,0xbf0ea880,0xbf7bbf6d
.long 0xbf6dbf80,0xbec4bf35,0xbf6dbf80,0xbec4bf35,0xbe48a784,0xbf0ebec4,0x3e4828a3,0x3f0e3ec4
.long 0xbf803f80,0xbf803f80,0xbf803f80,0xbf803f80,0x3f55bf35,0x3f7bbf6d,0xbf553f35,0xbf7b3f6d
.long 0xbec4a777,0xbf6d3f35,0xbec426d4,0xbf6d3f35,0xbe483f35,0x3f55bec4,0x3e48bf35,0xbf553ec4
.long 0x3f35bf80,0xbf35a78d,0x3f35bf80,0xbf35a7e5,0xbf7b3f35,0x3f0e3ec4,0x3f7bbf35,0xbf0ebec4
.long 0x3f6d258d,0xbec4bf35,0x3f6d2754,0xbec4bf35,0xbf0ebf35,0x3e483f6d,0x3f0e3f35,0xbe48bf6d
.long 0x27543f80,0x2889bf80,0xa8803f80,0x28a3bf80,0x3f0ebf35,0xbe483f6d,0xbf0e3f35,0x3e48bf6d
.long 0xbf6da796,0x3ec4bf35,0xbf6da804,0x3ec4bf35,0x3f7b3f35,0xbf0e3ec4,0xbf7bbf35,0x3f0ebec4
.long 0xbf35bf80,0x3f352816,0xbf35bf80,0x3f3528ea,0x3e483f35,0xbf55bec4,0xbe48bf35,0x3f553ec4
.long 0x3ec4268d,0x3f6d3f35,0x3ec4a731,0x3f6d3f35,0xbf55bf35,0xbf7bbf6d,0x3f553f35,0x3f7b3f6d
.long 0x250d0000,0x25d4a58d,0xa6d4a70d,0x27d4a71f,0xbe480000,0xbf0e3ec4,0x3e48a6d4,0x3f0ebec4
.long 0xbec40000,0xbf6d3f35,0xbec4a71f,0xbf6d3f35,0xbf0e0000,0xbf7b3f6d,0x3f0e27d4,0x3f7bbf6d
.long 0xbf350000,0xbf353f80,0xbf35a730,0xbf353f80,0xbf550000,0xbe483f6d,0x3f55a68d,0x3e48bf6d
.long 0xbf6d0000,0x3ec43f35,0xbf6da831,0x3ec43f35,0xbf7b0000,0x3f553ec4,0x3f7b27e5,0xbf55bec4
.long 0xbf800000,0x3f8025d4,0xbf80a754,0x3f8027f7,0xbf7b0000,0x3f55bec4,0x3f7ba60e,0xbf553ec4
.long 0xbf6d0000,0x3ec4bf35,0xbf6d278d,0x3ec4bf35,0xbf550000,0xbe48bf6d,0x3f5527f7,0x3e483f6d
.long 0xbf350000,0xbf35bf80,0xbf35a777,0xbf35bf80,0xbf0e0000,0xbf7bbf6d,0x3f0ea1b7,0x3f7b3f6d
.long 0xbec40000,0xbf6dbf35,0xbec4a842,0xbf6dbf35,0xbe480000,0xbf0ebec4,0x3e482804,0x3f0e3ec4
.long 0x2630a60d,0x2677a654,0xa68da730,0x27e5a831,0xbf553f35,0xbf7b3f6d,0x3f55bf35,0x3f7bbf6d
.long 0xbf6d3f80,0xbec43f35,0xbf6d3f80,0xbec43f35,0xbe483f35,0x3f55bec4,0x3e48bf35,0xbf553ec4
.long 0x3f352630,0x3f35bf80,0x3f35a60e,0x3f35bf80,0x3f7bbf35,0xbf0ebec4,0xbf7b3f35,0x3f0e3ec4
.long 0x3ec4bf80,0xbf6d3f35,0x3ec4bf80,0xbf6d3f35,0xbf0ebf35,0x3e483f6d,0x3f0e3f35,0xbe48bf6d
.long 0xbf80a654,0x3f80269f,0xbf80a842,0x3f802884,0xbf0e3f35,0x3e48bf6d,0x3f0ebf35,0xbe483f6d
.long 0x3ec43f80,0xbf6dbf35,0x3ec43f80,0xbf6dbf35,0x3f7b3f35,0xbf0e3ec4,0xbf7bbf35,0x3f0ebec4
.long 0x3f352677,0x3f353f80,0x3f35280d,0x3f353f80,0xbe48bf35,0x3f553ec4,0x3e483f35,0xbf55bec4
.long 0xbf6dbf80,0xbec4bf35,0xbf6dbf80,0xbec4bf35,0xbf55bf35,0xbf7bbf6d,0x3f553f35,0x3f7b3f6d
.long 0x269fa68d,0x27b1a6b0,0xa60ea754,0x27f7278d,0xbf7b3f80,0xbf553f6d,0x3f7bbf80,0x3f55bf6d
.long 0x3ec4269f,0x3f6dbf35,0x3ec427f7,0x3f6dbf35,0x3f55bf80,0xbe48bec4,0xbf553f80,0x3e483ec4
.long 0xbf35a6b0,0xbf353f80,0xbf35a842,0xbf353f80,0xbf0e3f80,0x3f7bbec4,0x3f0ebf80,0xbf7b3ec4
.long 0x3f6d27b1,0xbec4bf35,0x3f6d260d,0xbec4bf35,0x3e48bf80,0xbf0e3f6d,0xbe483f80,0x3f0ebf6d
.long 0xbf80a6d4,0x3f8027c2,0xbf80a79f,0x3f80a7d4,0x3e483f80,0xbf0ebf6d,0xbe48bf80,0x3f0e3f6d
.long 0x3f6da70d,0xbec43f35,0x3f6d2816,0xbec43f35,0xbf0ebf80,0x3f7b3ec4,0x3f0e3f80,0xbf7bbec4
.long 0xbf35a6f7,0xbf35bf80,0xbf35270d,0xbf35bf80,0x3f553f80,0xbe483ec4,0xbf55bf80,0x3e48bec4
.long 0x3ec427c2,0x3f6d3f35,0x3ec4270d,0x3f6d3f35,0xbf7bbf80,0xbf55bf6d,0x3f7b3f80,0x3f553f6d
.long 0xa70da6d4,0x27c2a6f7,0xa1b7a777,0x2804a842,0xbf0e3f35,0xbe483ec4,0x3f0ebf35,0x3e48bec4
.long 0x3f6dbf80,0x3ec4bf35,0x3f6dbf80,0x3ec4bf35,0xbf7b3f35,0xbf0e3f6d,0x3f7bbf35,0x3f0ebf6d
.long 0x3f3527c2,0x3f35bf80,0x3f35280d,0x3f35bf80,0xbe48bf35,0xbf553f6d,0x3e483f35,0x3f55bf6d
.long 0xbec43f80,0x3f6dbf35,0xbec43f80,0x3f6dbf35,0x3f55bf35,0xbf7b3ec4,0xbf553f35,0x3f7bbec4
.long 0xbf80a71f,0x3f80a68d,0xbf80270d,0x3f802909,0x3f553f35,0xbf7bbec4,0xbf55bf35,0x3f7b3ec4
.long 0xbec4bf80,0x3f6d3f35,0xbec4bf80,0x3f6d3f35,0xbe483f35,0xbf55bf6d,0x3e48bf35,0x3f553f6d
.long 0x3f35a68d,0x3f353f80,0x3f352896,0x3f353f80,0xbf7bbf35,0xbf0ebf6d,0x3f7b3f35,0x3f0e3f6d
.long 0x3f6d3f80,0x3ec43f35,0x3f6d3f80,0x3ec43f35,0xbf0ebf35,0xbe48bec4,0x3f0e3f35,0x3e483ec4
.long 0x3f80bf80,0x3f80bf80,0x3f80bf80,0x3f80bf80,0x3f7bbf80,0x3f55bf6d,0xbf7b3f80,0xbf553f6d
.long 0x3f6dbf80,0x3ec4bf35,0x3f6dbf80,0x3ec4bf35,0x3f55bf80,0xbe48bec4,0xbf553f80,0x3e483ec4
.long 0x3f35bf80,0xbf35a5b0,0x3f35bf80,0xbf35a68d,0x3f0ebf80,0xbf7b3ec4,0xbf0e3f80,0x3f7bbec4
.long 0x3ec4bf80,0xbf6d3f35,0x3ec4bf80,0xbf6d3f35,0x3e48bf80,0xbf0e3f6d,0xbe483f80,0x3f0ebf6d
.long 0x2554bf80,0xa61f3f80,0xa828bf80,0xa81f3f80,0xbe48bf80,0x3f0e3f6d,0x3e483f80,0xbf0ebf6d
.long 0xbec4bf80,0x3f6d3f35,0xbec4bf80,0x3f6d3f35,0xbf0ebf80,0x3f7b3ec4,0x3f0e3f80,0xbf7bbec4
.long 0xbf35bf80,0x3f3525f7,0xbf35bf80,0x3f35a6d4,0xbf55bf80,0x3e48bec4,0x3f553f80,0xbe483ec4
.long 0xbf6dbf80,0xbec4bf35,0xbf6dbf80,0xbec4bf35,0xbf7bbf80,0xbf55bf6d,0x3f7b3f80,0x3f553f6d
.long 0x3f80bf80,0x3f80bf80,0x3f80bf80,0x3f80bf80,0x3f0ebf35,0x3e48bec4,0xbf0e3f35,0xbe483ec4
.long 0xbec4a61f,0xbf6d3f35,0xbec4a68d,0xbf6d3f35,0xbf7b3f35,0xbf0e3f6d,0x3f7bbf35,0x3f0ebf6d
.long 0xbf353f80,0x3f352742,0xbf353f80,0x3f35285d,0x3e483f35,0x3f55bf6d,0xbe48bf35,0xbf553f6d
.long 0x3f6d2731,0xbec4bf35,0x3f6da70d,0xbec4bf35,0x3f55bf35,0xbf7b3ec4,0xbf553f35,0x3f7bbec4
.long 0x2742bf80,0x260d3f80,0xa6d4bf80,0xa7303f80,0xbf55bf35,0x3f7b3ec4,0x3f553f35,0xbf7bbec4
.long 0xbf6d268d,0x3ec4bf35,0xbf6da828,0x3ec4bf35,0xbe483f35,0xbf55bf6d,0x3e48bf35,0x3f553f6d
.long 0x3f353f80,0xbf35260d,0x3f353f80,0xbf35a89a,0x3f7b3f35,0x3f0e3f6d,0xbf7bbf35,0xbf0ebf6d
.long 0x3ec42742,0x3f6d3f35,0x3ec427e5,0x3f6d3f35,0xbf0ebf35,0xbe48bec4,0x3f0e3f35,0x3e483ec4
.long 0x3f80bf80,0x3f80bf80,0x3f80bf80,0x3f80bf80,0xbe482654,0xbf0e3ec4,0x3e4827b1,0x3f0ebec4
.long 0xbf6d3f80,0xbec43f35,0xbf6d3f80,0xbec43f35,0x3f0e2754,0x3f7bbf6d,0xbf0ea81f,0xbf7b3f6d
.long 0x3f35bf80,0xbf35258e,0x3f35bf80,0xbf3527b1,0xbf55260d,0xbe483f6d,0x3f55a6d4,0x3e48bf6d
.long 0xbec43f80,0x3f6dbf35,0xbec43f80,0x3f6dbf35,0x3f7b2765,0xbf55bec4,0xbf7ba730,0x3f553ec4
.long 0x2777bf80,0xa8043f80,0x27e5bf80,0xa8393f80,0xbf7b258e,0x3f55bec4,0x3f7b27e5,0xbf553ec4
.long 0x3ec43f80,0xbf6dbf35,0x3ec43f80,0xbf6dbf35,0x3f552777,0x3e483f6d,0xbf55a839,0xbe48bf6d
.long 0xbf35bf80,0x3f35278d,0xbf35bf80,0x3f35a8be,0xbf0e2137,0xbf7bbf6d,0x3f0e2880,0x3f7b3f6d
.long 0x3f6d3f80,0x3ec43f35,0x3f6d3f80,0x3ec43f35,0x3e482784,0x3f0e3ec4,0xbe48a8a3,0xbf0ebec4
.long 0x3f80bf80,0x3f80bf80,0x3f80bf80,0x3f80bf80,0xbf553f35,0xbf7b3f6d,0x3f55bf35,0x3f7bbf6d
.long 0x3ec42777,0x3f6dbf35,0x3ec4a6d4,0x3f6dbf35,0x3e48bf35,0xbf553ec4,0xbe483f35,0x3f55bec4
.long 0xbf353f80,0x3f35278d,0xbf353f80,0x3f3527e5,0x3f7bbf35,0xbf0ebec4,0xbf7b3f35,0x3f0e3ec4
.long 0xbf6da58d,0x3ec43f35,0xbf6da754,0x3ec43f35,0x3f0e3f35,0xbe48bf6d,0xbf0ebf35,0x3e483f6d
.long 0xa754bf80,0xa8893f80,0x2880bf80,0xa8a33f80,0xbf0e3f35,0x3e48bf6d,0x3f0ebf35,0xbe483f6d
.long 0x3f6d2796,0xbec43f35,0x3f6d2804,0xbec43f35,0xbf7bbf35,0x3f0ebec4,0x3f7b3f35,0xbf0e3ec4
.long 0x3f353f80,0xbf35a816,0x3f353f80,0xbf35a8ea,0xbe48bf35,0x3f553ec4,0x3e483f35,0xbf55bec4
.long 0xbec4a68d,0xbf6dbf35,0xbec42731,0xbf6dbf35,0x3f553f35,0x3f7b3f6d,0xbf55bf35,0xbf7bbf6d
.long 0xa50d8000,0xa5d4258d,0x26d4270d,0xa7d4271f,0x3e488000,0x3f0ebec4,0xbe4826d4,0xbf0e3ec4
.long 0x3ec48000,0x3f6dbf35,0x3ec4271f,0x3f6dbf35,0x3f0e8000,0x3f7bbf6d,0xbf0ea7d4,0xbf7b3f6d
.long 0x3f358000,0x3f35bf80,0x3f352730,0x3f35bf80,0x3f558000,0x3e48bf6d,0xbf55268d,0xbe483f6d
.long 0x3f6d8000,0xbec4bf35,0x3f6d2831,0xbec4bf35,0x3f7b8000,0xbf55bec4,0xbf7ba7e5,0x3f553ec4
.long 0x3f808000,0xbf80a5d4,0x3f802754,0xbf80a7f7,0x3f7b8000,0xbf553ec4,0xbf7b260e,0x3f55bec4
.long 0x3f6d8000,0xbec43f35,0x3f6da78d,0xbec43f35,0x3f558000,0x3e483f6d,0xbf55a7f7,0xbe48bf6d
.long 0x3f358000,0x3f353f80,0x3f352777,0x3f353f80,0x3f0e8000,0x3f7b3f6d,0xbf0e21b7,0xbf7bbf6d
.long 0x3ec48000,0x3f6d3f35,0x3ec42842,0x3f6d3f35,0x3e488000,0x3f0e3ec4,0xbe48a804,0xbf0ebec4
.long 0xa630260d,0xa6772654,0x268d2730,0xa7e52831,0x3f55bf35,0x3f7bbf6d,0xbf553f35,0xbf7b3f6d
.long 0x3f6dbf80,0x3ec4bf35,0x3f6dbf80,0x3ec4bf35,0x3e48bf35,0xbf553ec4,0xbe483f35,0x3f55bec4
.long 0xbf35a630,0xbf353f80,0xbf35260e,0xbf353f80,0xbf7b3f35,0x3f0e3ec4,0x3f7bbf35,0xbf0ebec4
.long 0xbec43f80,0x3f6dbf35,0xbec43f80,0x3f6dbf35,0x3f0e3f35,0xbe48bf6d,0xbf0ebf35,0x3e483f6d
.long 0x3f802654,0xbf80a69f,0x3f802842,0xbf80a884,0x3f0ebf35,0xbe483f6d,0xbf0e3f35,0x3e48bf6d
.long 0xbec4bf80,0x3f6d3f35,0xbec4bf80,0x3f6d3f35,0xbf7bbf35,0x3f0ebec4,0x3f7b3f35,0xbf0e3ec4
.long 0xbf35a677,0xbf35bf80,0xbf35a80d,0xbf35bf80,0x3e483f35,0xbf55bec4,0xbe48bf35,0x3f553ec4
.long 0x3f6d3f80,0x3ec43f35,0x3f6d3f80,0x3ec43f35,0x3f553f35,0x3f7b3f6d,0xbf55bf35,0xbf7bbf6d
.long 0xa69f268d,0xa7b126b0,0x260e2754,0xa7f7a78d,0x3f7bbf80,0x3f55bf6d,0xbf7b3f80,0xbf553f6d
.long 0xbec4a69f,0xbf6d3f35,0xbec4a7f7,0xbf6d3f35,0xbf553f80,0x3e483ec4,0x3f55bf80,0xbe48bec4
.long 0x3f3526b0,0x3f35bf80,0x3f352842,0x3f35bf80,0x3f0ebf80,0xbf7b3ec4,0xbf0e3f80,0x3f7bbec4
.long 0xbf6da7b1,0x3ec43f35,0xbf6da60d,0x3ec43f35,0xbe483f80,0x3f0ebf6d,0x3e48bf80,0xbf0e3f6d
.long 0x3f8026d4,0xbf80a7c2,0x3f80279f,0xbf8027d4,0xbe48bf80,0x3f0e3f6d,0x3e483f80,0xbf0ebf6d
.long 0xbf6d270d,0x3ec4bf35,0xbf6da816,0x3ec4bf35,0x3f0e3f80,0xbf7bbec4,0xbf0ebf80,0x3f7b3ec4
.long 0x3f3526f7,0x3f353f80,0x3f35a70d,0x3f353f80,0xbf55bf80,0x3e48bec4,0x3f553f80,0xbe483ec4
.long 0xbec4a7c2,0xbf6dbf35,0xbec4a70d,0xbf6dbf35,0x3f7b3f80,0x3f553f6d,0xbf7bbf80,0xbf55bf6d
.long 0x270d26d4,0xa7c226f7,0x21b72777,0xa8042842,0x3f0ebf35,0x3e48bec4,0xbf0e3f35,0xbe483ec4
.long 0xbf6d3f80,0xbec43f35,0xbf6d3f80,0xbec43f35,0x3f7bbf35,0x3f0ebf6d,0xbf7b3f35,0xbf0e3f6d
.long 0xbf35a7c2,0xbf353f80,0xbf35a80d,0xbf353f80,0x3e483f35,0x3f55bf6d,0xbe48bf35,0xbf553f6d
.long 0x3ec4bf80,0xbf6d3f35,0x3ec4bf80,0xbf6d3f35,0xbf553f35,0x3f7bbec4,0x3f55bf35,0xbf7b3ec4
.long 0x3f80271f,0xbf80268d,0x3f80a70d,0xbf80a909,0xbf55bf35,0x3f7b3ec4,0x3f553f35,0xbf7bbec4
.long 0x3ec43f80,0xbf6dbf35,0x3ec43f80,0xbf6dbf35,0x3e48bf35,0x3f553f6d,0xbe483f35,0xbf55bf6d
.long 0xbf35268d,0xbf35bf80,0xbf35a896,0xbf35bf80,0x3f7b3f35,0x3f0e3f6d,0xbf7bbf35,0xbf0ebf6d
.long 0xbf6dbf80,0xbec4bf35,0xbf6dbf80,0xbec4bf35,0x3f0e3f35,0x3e483ec4,0xbf0ebf35,0xbe48bec4
.long 0x3f003f00,0x3f003f00,0x3f003f00,0x3f003f00,0x3eff3f00,0x3ef53efb,0xbd49240d,0xbe15bdc8
.long 0x3efb3f00,0x3ed53eed,0xbefbbf00,0xbed5beed,0x3ef53f00,0x3ea23ed5,0x3e15a4d4,0x3ec63e8e
.long 0x3eed3f00,0x3e443eb5,0x3eed3f00,0x3e443eb5,0x3ee23f00,0x3d493e8e,0xbe712530,0xbeffbed5
.long 0x3ed53f00,0xbdc83e44,0xbed5bf00,0x3dc8be44,0x3ec63f00,0xbe713dc8,0x3ea2a577,0x3ee23efb
.long 0x3eb53f00,0xbeb5240d,0x3eb53f00,0xbeb5259f,0x3ea23f00,0xbee2bdc8,0xbec6259f,0xbe71befb
.long 0x3e8e3f00,0xbefbbe44,0xbe8ebf00,0x3efb3e44,0x3e713f00,0xbeffbe8e,0x3ee2a6b1,0xbd493ed5
.long 0x3e443f00,0xbeedbeb5,0x3e443f00,0xbeedbeb5,0x3e153f00,0xbec6bed5,0xbef5a60d,0x3ea2be8e
.long 0x3dc83f00,0xbe8ebeed,0xbdc8bf00,0x3e8e3eed,0x3d493f00,0xbe15befb,0x3effa6c2,0xbef53dc8
.long 0x3f003f00,0x3f003f00,0x3f003f00,0x3f003f00,0x3ee23eed,0x3ec63ed5,0xbe71be44,0xbea2be8e
.long 0x3e8e3eb5,0x3dc83e44,0xbe8ebeb5,0xbdc8be44,0x3d493e44,0xbe71bdc8,0x3eff3eed,0x3ee23efb
.long 0xbe44240d,0xbeedbeb5,0xbe442530,0xbeedbeb5,0xbec6be44,0xbef5befb,0xbea2beed,0x3e15bdc8
.long 0xbefbbeb5,0xbe8ebeed,0x3efb3eb5,0x3e8e3eed,0xbef5beed,0x3d49be8e,0xbe153e44,0xbeffbed5
.long 0xbeb5bf00,0x3eb5a4d4,0xbeb5bf00,0x3eb5a6b1,0xbe15beed,0x3eff3e8e,0x3ef53e44,0x3d493ed5
.long 0x3dc8beb5,0x3ed53eed,0xbdc83eb5,0xbed5beed,0x3ea2be44,0x3e153efb,0xbec6beed,0x3ef53dc8
.long 0x3eeda4d4,0xbe443eb5,0x3eeda6c2,0xbe443eb5,0x3eff3e44,0xbee23dc8,0xbd493eed,0xbe71befb
.long 0x3ed53eb5,0xbefbbe44,0xbed5beb5,0x3efb3e44,0x3e713eed,0xbea2bed5,0x3ee2be44,0xbec63e8e
.long 0x3f003f00,0x3f003f00,0x3f003f00,0x3f003f00,0x3ea23eb5,0x3e713e8e,0xbec6beb5,0xbee2bed5
.long 0xbdc8240d,0xbe8ebe44,0x3dc8a4d4,0x3e8e3e44,0xbee2beb5,0xbeffbefb,0x3e713eb5,0xbd493dc8
.long 0xbeedbf00,0xbe44beb5,0xbeedbf00,0xbe44beb5,0xbe15beb5,0x3ea23dc8,0x3ef53eb5,0x3ec63efb
.long 0x3e8ea4d4,0x3efb3eed,0xbe8e259f,0xbefbbeed,0x3eff3eb5,0x3e153ed5,0xbd49beb5,0x3ef53e8e
.long 0x3eb53f00,0xbeb52530,0x3eb53f00,0xbeb5a60d,0xbd493eb5,0xbef5bed5,0xbeffbeb5,0x3e15be8e
.long 0xbed52530,0xbdc8beed,0x3ed5a6c2,0x3dc83eed,0xbef5beb5,0x3ec6bdc8,0xbe153eb5,0xbea2befb
.long 0xbe44bf00,0x3eed3eb5,0xbe44bf00,0x3eed3eb5,0x3e71beb5,0x3d493efb,0x3ee23eb5,0xbeffbdc8
.long 0x3efba577,0xbed53e44,0xbefba58d,0x3ed5be44,0x3ec63eb5,0xbee2be8e,0x3ea2beb5,0xbe713ed5
.long 0x3f003f00,0x3f003f00,0x3f003f00,0x3f003f00,0x3e153e44,0x3d493dc8,0xbef5beed,0xbeffbefb
.long 0xbed5beb5,0xbefbbeed,0x3ed53eb5,0x3efb3eed,0xbec6beed,0xbe15be8e,0xbea2be44,0xbef5bed5
.long 0x3e44a4d4,0x3eed3eb5,0x3e44a577,0x3eed3eb5,0x3eff3eed,0x3e713ed5,0xbd493e44,0xbee2be8e
.long 0x3dc83eb5,0xbed5be44,0xbdc8beb5,0x3ed53e44,0xbee2be44,0xbea2befb,0x3e713eed,0xbec6bdc8
.long 0xbeb5bf00,0x3eb5a577,0xbeb5bf00,0x3eb5a6c2,0x3e71be44,0x3ec63efb,0x3ee23eed,0xbea23dc8
.long 0x3efb3eb5,0xbe8e3e44,0xbefbbeb5,0x3e8ebe44,0x3d493eed,0xbee2bed5,0x3eff3e44,0xbe713e8e
.long 0xbeed259f,0x3e44beb5,0xbeeda58d,0x3e44beb5,0xbea2beed,0x3ef53e8e,0x3ec6be44,0xbe153ed5
.long 0x3e8ebeb5,0xbdc83eed,0xbe8e3eb5,0x3dc8beed,0x3ef53e44,0xbeffbdc8,0x3e15beed,0xbd493efb
.long 0x80008000,0x80008000,0x80008000,0x80008000,0xbd498000,0xbe15bdc8,0xbeffbf00,0xbef5befb
.long 0xbdc88000,0xbe8ebe44,0x3dc8a48d,0x3e8e3e44,0xbe158000,0xbec6be8e,0x3ef53f00,0x3ea23ed5
.long 0xbe448000,0xbeedbeb5,0xbe44250d,0xbeedbeb5,0xbe718000,0xbeffbed5,0xbee2bf00,0xbd49be8e
.long 0xbe8e8000,0xbefbbeed,0x3e8ea554,0x3efb3eed,0xbea28000,0xbee2befb,0x3ec63f00,0xbe713dc8
.long 0xbeb58000,0xbeb5bf00,0xbeb5258d,0xbeb5bf00,0xbec68000,0xbe71befb,0xbea2bf00,0x3ee23dc8
.long 0xbed58000,0xbdc8beed,0x3ed5a5b0,0x3dc83eed,0xbee28000,0x3d49bed5,0x3e713f00,0xbeffbe8e
.long 0xbeed8000,0x3e44beb5,0xbeed25d4,0x3e44beb5,0xbef58000,0x3ea2be8e,0xbe15bf00,0x3ec63ed5
.long 0xbefb8000,0x3ed5be44,0x3efba5f7,0xbed53e44,0xbeff8000,0x3ef5bdc8,0x3d493f00,0xbe15befb
.long 0x80008000,0x80008000,0x80008000,0x80008000,0xbe71be44,0xbea2be8e,0xbee2beed,0xbec6bed5
.long 0xbed5beb5,0xbefbbeed,0x3ed53eb5,0x3efb3eed,0xbeffbeed,0xbee2befb,0x3d493e44,0xbe71bdc8
.long 0xbeedbf00,0xbe44beb5,0xbeedbf00,0xbe44beb5,0xbea2beed,0x3e15bdc8,0x3ec63e44,0x3ef53efb
.long 0xbdc8beb5,0x3ed53e44,0x3dc83eb5,0xbed5be44,0x3e15be44,0x3eff3ed5,0xbef5beed,0x3d49be8e
.long 0x3eb5a48d,0x3eb53f00,0x3eb5a5b0,0x3eb53f00,0x3ef53e44,0x3d493ed5,0x3e153eed,0xbeffbe8e
.long 0x3efb3eb5,0xbe8e3e44,0xbefbbeb5,0x3e8ebe44,0x3ec63eed,0xbef5bdc8,0x3ea2be44,0x3e153efb
.long 0x3e443f00,0xbeedbeb5,0x3e443f00,0xbeedbeb5,0xbd493eed,0xbe71befb,0xbeffbe44,0x3ee2bdc8
.long 0xbe8e3eb5,0x3dc8beed,0x3e8ebeb5,0xbdc83eed,0xbee23e44,0x3ec6be8e,0x3e713eed,0xbea2bed5
.long 0x80008000,0x80008000,0x80008000,0x80008000,0xbec6beb5,0xbee2bed5,0xbea2beb5,0xbe71be8e
.long 0xbefbbf00,0xbed5beed,0x3efb3f00,0x3ed53eed,0xbe71beb5,0x3d49bdc8,0xbee2beb5,0xbeffbefb
.long 0x3e44a48d,0x3eed3eb5,0x3e44a554,0x3eed3eb5,0x3ef53eb5,0x3ec63efb,0x3e153eb5,0xbea2bdc8
.long 0x3ed53f00,0xbdc83e44,0xbed5bf00,0x3dc8be44,0x3d493eb5,0xbef5be8e,0x3eff3eb5,0x3e153ed5
.long 0xbeb5250d,0xbeb5bf00,0xbeb525d4,0xbeb5bf00,0xbeffbeb5,0x3e15be8e,0x3d49beb5,0x3ef53ed5
.long 0xbe8ebf00,0x3efb3e44,0x3e8e3f00,0xbefbbe44,0x3e15beb5,0x3ea23efb,0xbef5beb5,0x3ec6bdc8
.long 0x3eeda554,0xbe443eb5,0x3eeda61f,0xbe443eb5,0x3ee23eb5,0xbeffbdc8,0xbe713eb5,0xbd49befb
.long 0x3dc83f00,0xbe8ebeed,0xbdc8bf00,0x3e8e3eed,0xbea23eb5,0x3e71bed5,0x3ec63eb5,0xbee2be8e
.long 0x80008000,0x80008000,0x80008000,0x80008000,0xbef5beed,0xbeffbefb,0xbe15be44,0xbd49bdc8
.long 0xbe8ebeb5,0xbdc8be44,0x3e8e3eb5,0x3dc83e44,0x3ea23e44,0x3ef53ed5,0xbec6beed,0xbe15be8e
.long 0x3eed3f00,0x3e443eb5,0x3eed3f00,0x3e443eb5,0xbd493e44,0xbee2be8e,0xbeffbeed,0xbe71bed5
.long 0xbefbbeb5,0xbe8ebeed,0x3efb3eb5,0x3e8e3eed,0xbe71beed,0x3ec63dc8,0xbee2be44,0xbea2befb
.long 0x3eb5a554,0x3eb53f00,0x3eb5a5f7,0x3eb53f00,0x3ee23eed,0xbea23dc8,0xbe713e44,0xbec6befb
.long 0xbdc83eb5,0xbed5beed,0x3dc8beb5,0x3ed53eed,0xbeffbe44,0x3e71be8e,0x3d493eed,0xbee2bed5
.long 0xbe44bf00,0x3eed3eb5,0xbe44bf00,0x3eed3eb5,0x3ec6be44,0xbe153ed5,0x3ea23eed,0xbef5be8e
.long 0x3ed53eb5,0xbefbbe44,0xbed5beb5,0x3efb3e44,0xbe153eed,0x3d49befb,0x3ef53e44,0xbeffbdc8
.long 0x3f003f00,0x3f003f00,0x3f003f00,0x3f003f00,0xbeffbf00,0xbef5befb,0x3d49a4d4,0x3e153dc8
.long 0x3efb3f00,0x3ed53eed,0xbefbbf00,0xbed5beed,0xbef5bf00,0xbea2bed5,0xbe15259f,0xbec6be8e
.long 0x3eed3f00,0x3e443eb5,0x3eed3f00,0x3e443eb5,0xbee2bf00,0xbd49be8e,0x3e71a6c2,0x3eff3ed5
.long 0x3ed53f00,0xbdc83e44,0xbed5bf00,0x3dc8be44,0xbec6bf00,0x3e71bdc8,0xbea2a58d,0xbee2befb
.long 0x3eb53f00,0xbeb5a5d4,0x3eb53f00,0xbeb5a50e,0xbea2bf00,0x3ee23dc8,0x3ec6a6f7,0x3e713efb
.long 0x3e8e3f00,0xbefbbe44,0xbe8ebf00,0x3efb3e44,0xbe71bf00,0x3eff3e8e,0xbee22784,0x3d49bed5
.long 0x3e443f00,0xbeedbeb5,0x3e443f00,0xbeedbeb5,0xbe15bf00,0x3ec63ed5,0x3ef526d4,0xbea23e8e
.long 0x3dc83f00,0xbe8ebeed,0xbdc8bf00,0x3e8e3eed,0xbd49bf00,0x3e153efb,0xbeff2809,0x3ef5bdc8
.long 0x3f003f00,0x3f003f00,0x3f003f00,0x3f003f00,0xbee2beed,0xbec6bed5,0x3e713e44,0x3ea23e8e
.long 0x3e8e3eb5,0x3dc83e44,0xbe8ebeb5,0xbdc8be44,0xbd49be44,0x3e713dc8,0xbeffbeed,0xbee2befb
.long 0xbe44259f,0xbeedbeb5,0xbe44a60d,0xbeedbeb5,0x3ec63e44,0x3ef53efb,0x3ea23eed,0xbe153dc8
.long 0xbefbbeb5,0xbe8ebeed,0x3efb3eb5,0x3e8e3eed,0x3ef53eed,0xbd493e8e,0x3e15be44,0x3eff3ed5
.long 0xbeb5bf00,0x3eb5a6d4,0xbeb5bf00,0x3eb5a6f7,0x3e153eed,0xbeffbe8e,0xbef5be44,0xbd49bed5
.long 0x3dc8beb5,0x3ed53eed,0xbdc83eb5,0xbed5beed,0xbea23e44,0xbe15befb,0x3ec63eed,0xbef5bdc8
.long 0x3eeda6f7,0xbe443eb5,0x3eeda716,0xbe443eb5,0xbeffbe44,0x3ee2bdc8,0x3d49beed,0x3e713efb
.long 0x3ed53eb5,0xbefbbe44,0xbed5beb5,0x3efb3e44,0xbe71beed,0x3ea23ed5,0xbee23e44,0x3ec6be8e
.long 0x3f003f00,0x3f003f00,0x3f003f00,0x3f003f00,0xbea2beb5,0xbe71be8e,0x3ec63eb5,0x3ee23ed5
.long 0xbdc82530,0xbe8ebe44,0x3dc8a577,0x3e8e3e44,0x3ee23eb5,0x3eff3efb,0xbe71beb5,0x3d49bdc8
.long 0xbeedbf00,0xbe44beb5,0xbeedbf00,0xbe44beb5,0x3e153eb5,0xbea2bdc8,0xbef5beb5,0xbec6befb
.long 0x3e8ea6c2,0x3efb3eed,0xbe8ea58d,0xbefbbeed,0xbeffbeb5,0xbe15bed5,0x3d493eb5,0xbef5be8e
.long 0x3eb53f00,0xbeb5a58d,0x3eb53f00,0xbeb5a0b7,0x3d49beb5,0x3ef53ed5,0x3eff3eb5,0xbe153e8e
.long 0xbed5a50e,0xbdc8beed,0x3ed5a70d,0x3dc83eed,0x3ef53eb5,0xbec63dc8,0x3e15beb5,0x3ea23efb
.long 0xbe44bf00,0x3eed3eb5,0xbe44bf00,0x3eed3eb5,0xbe713eb5,0xbd49befb,0xbee2beb5,0x3eff3dc8
.long 0x3efba70d,0xbed53e44,0xbefb2796,0x3ed5be44,0xbec6beb5,0x3ee23e8e,0xbea23eb5,0x3e71bed5
.long 0x3f003f00,0x3f003f00,0x3f003f00,0x3f003f00,0xbe15be44,0xbd49bdc8,0x3ef53eed,0x3eff3efb
.long 0xbed5beb5,0xbefbbeed,0x3ed53eb5,0x3efb3eed,0x3ec63eed,0x3e153e8e,0x3ea23e44,0x3ef53ed5
.long 0x3e44a6b1,0x3eed3eb5,0x3e44a6c2,0x3eed3eb5,0xbeffbeed,0xbe71bed5,0x3d49be44,0x3ee23e8e
.long 0x3dc83eb5,0xbed5be44,0xbdc8beb5,0x3ed53e44,0x3ee23e44,0x3ea23efb,0xbe71beed,0x3ec63dc8
.long 0xbeb5bf00,0x3eb5a6e5,0xbeb5bf00,0x3eb5a704,0xbe713e44,0xbec6befb,0xbee2beed,0x3ea2bdc8
.long 0x3efb3eb5,0xbe8e3e44,0xbefbbeb5,0x3e8ebe44,0xbd49beed,0x3ee23ed5,0xbeffbe44,0x3e71be8e
.long 0xbeed250d,0x3e44beb5,0xbeed260d,0x3e44beb5,0x3ea23eed,0xbef5be8e,0xbec63e44,0x3e15bed5
.long 0x3e8ebeb5,0xbdc83eed,0xbe8e3eb5,0x3dc8beed,0xbef5be44,0x3eff3dc8,0xbe153eed,0x3d49befb
.long 0x80008000,0x80008000,0x80008000,0x80008000,0x3d49a48d,0x3e153dc8,0x3eff3f00,0x3ef53efb
.long 0xbdc8250d,0xbe8ebe44,0x3dc8a554,0x3e8e3e44,0x3e15a554,0x3ec63e8e,0xbef5bf00,0xbea2bed5
.long 0xbe44258d,0xbeedbeb5,0xbe4425d4,0xbeedbeb5,0x3e71a5b0,0x3eff3ed5,0x3ee23f00,0x3d493e8e
.long 0xbe8e25d4,0xbefbbeed,0x3e8ea61f,0x3efb3eed,0x3ea2a5f7,0x3ee23efb,0xbec6bf00,0x3e71bdc8
.long 0xbeb5260d,0xbeb5bf00,0xbeb52654,0xbeb5bf00,0x3ec6a61f,0x3e713efb,0x3ea23f00,0xbee2bdc8
.long 0xbed52630,0xbdc8beed,0x3ed5a742,0x3dc83eed,0x3ee2a731,0xbd493ed5,0xbe71bf00,0x3eff3e8e
.long 0xbeed2654,0x3e44beb5,0xbeed269f,0x3e44beb5,0x3ef5268d,0xbea23e8e,0x3e153f00,0xbec6bed5
.long 0xbefb2677,0x3ed5be44,0x3efb260d,0xbed53e44,0x3effa742,0xbef53dc8,0xbd49bf00,0x3e153efb
.long 0x80008000,0x80008000,0x80008000,0x80008000,0x3e713e44,0x3ea23e8e,0x3ee23eed,0x3ec63ed5
.long 0xbed5beb5,0xbefbbeed,0x3ed53eb5,0x3efb3eed,0x3eff3eed,0x3ee23efb,0xbd49be44,0x3e713dc8
.long 0xbeedbf00,0xbe44beb5,0xbeedbf00,0xbe44beb5,0x3ea23eed,0xbe153dc8,0xbec6be44,0xbef5befb
.long 0xbdc8beb5,0x3ed53e44,0x3dc83eb5,0xbed5be44,0xbe153e44,0xbeffbed5,0x3ef53eed,0xbd493e8e
.long 0x3eb5a61f,0x3eb53f00,0x3eb5268d,0x3eb53f00,0xbef5be44,0xbd49bed5,0xbe15beed,0x3eff3e8e
.long 0x3efb3eb5,0xbe8e3e44,0xbefbbeb5,0x3e8ebe44,0xbec6beed,0x3ef53dc8,0xbea23e44,0xbe15befb
.long 0x3e443f00,0xbeedbeb5,0x3e443f00,0xbeedbeb5,0x3d49beed,0x3e713efb,0x3eff3e44,0xbee23dc8
.long 0xbe8e3eb5,0x3dc8beed,0x3e8ebeb5,0xbdc83eed,0x3ee2be44,0xbec63e8e,0xbe71beed,0x3ea23ed5
.long 0x80008000,0x80008000,0x80008000,0x80008000,0x3ec63eb5,0x3ee23ed5,0x3ea23eb5,0x3e713e8e
.long 0xbefbbf00,0xbed5beed,0x3efb3f00,0x3ed53eed,0x3e713eb5,0xbd493dc8,0x3ee23eb5,0x3eff3efb
.long 0x3e44a5b0,0x3eed3eb5,0x3e44a5f7,0x3eed3eb5,0xbef5beb5,0xbec6befb,0xbe15beb5,0x3ea23dc8
.long 0x3ed53f00,0xbdc83e44,0xbed5bf00,0x3dc8be44,0xbd49beb5,0x3ef53e8e,0xbeffbeb5,0xbe15bed5
.long 0xbeb52630,0xbeb5bf00,0xbeb52677,0xbeb5bf00,0x3eff3eb5,0xbe153e8e,0xbd493eb5,0xbef5bed5
.long 0xbe8ebf00,0x3efb3e44,0x3e8e3f00,0xbefbbe44,0xbe153eb5,0xbea2befb,0x3ef53eb5,0xbec63dc8
.long 0x3eeda742,0xbe443eb5,0x3eed260d,0xbe443eb5,0xbee2beb5,0x3eff3dc8,0x3e71beb5,0x3d493efb
.long 0x3dc83f00,0xbe8ebeed,0xbdc8bf00,0x3e8e3eed,0x3ea2beb5,0xbe713ed5,0xbec6beb5,0x3ee23e8e
.long 0x80008000,0x80008000,0x80008000,0x80008000,0x3ef53eed,0x3eff3efb,0x3e153e44,0x3d493dc8
.long 0xbe8ebeb5,0xbdc8be44,0x3e8e3eb5,0x3dc83e44,0xbea2be44,0xbef5bed5,0x3ec63eed,0x3e153e8e
.long 0x3eed3f00,0x3e443eb5,0x3eed3f00,0x3e443eb5,0x3d49be44,0x3ee23e8e,0x3eff3eed,0x3e713ed5
.long 0xbefbbeb5,0xbe8ebeed,0x3efb3eb5,0x3e8e3eed,0x3e713eed,0xbec6bdc8,0x3ee23e44,0x3ea23efb
.long 0x3eb5a731,0x3eb53f00,0x3eb5a742,0x3eb53f00,0xbee2beed,0x3ea2bdc8,0x3e71be44,0x3ec63efb
.long 0xbdc83eb5,0xbed5beed,0x3dc8beb5,0x3ed53eed,0x3eff3e44,0xbe713e8e,0xbd49beed,0x3ee23ed5
.long 0xbe44bf00,0x3eed3eb5,0xbe44bf00,0x3eed3eb5,0xbec63e44,0x3e15bed5,0xbea2beed,0x3ef53e8e
.long 0x3ed53eb5,0xbefbbe44,0xbed5beb5,0x3efb3e44,0x3e15beed,0xbd493efb,0xbef5be44,0x3eff3dc8
.long 0x240d3f00,0xa4d4bf00,0xa5d43f00,0xa6d4bf00,0xbd493f00,0x3e15befb,0xbeffa5d4,0x3ef53dc8
.long 0xbdc83f00,0x3e8ebeed,0x3dc8bf00,0xbe8e3eed,0xbe153f00,0x3ec6bed5,0x3ef5a6d4,0xbea2be8e
.long 0xbe443f00,0x3eedbeb5,0xbe443f00,0x3eedbeb5,0xbe713f00,0x3effbe8e,0xbee2a58d,0x3d493ed5
.long 0xbe8e3f00,0x3efbbe44,0x3e8ebf00,0xbefb3e44,0xbea23f00,0x3ee2bdc8,0x3ec6a6e5,0x3e71befb
.long 0xbeb53f00,0x3eb5a4d4,0xbeb53f00,0x3eb5a6f7,0xbec63f00,0x3e713dc8,0xbea2a50e,0xbee23efb
.long 0xbed53f00,0x3dc83e44,0x3ed5bf00,0xbdc8be44,0xbee23f00,0xbd493e8e,0x3e71a6f7,0x3effbed5
.long 0xbeed3f00,0xbe443eb5,0xbeed3f00,0xbe443eb5,0xbef53f00,0xbea23ed5,0xbe15a0b7,0xbec63e8e
.long 0xbefb3f00,0xbed53eed,0x3efbbf00,0x3ed5beed,0xbeff3f00,0xbef53efb,0x3d49a704,0x3e15bdc8
.long 0x25303f00,0xa577bf00,0xa58d3f00,0xa6e5bf00,0xbe713eed,0x3ea2bed5,0xbee2be44,0x3ec63e8e
.long 0xbed53eb5,0x3efbbe44,0x3ed5beb5,0xbefb3e44,0xbeff3e44,0x3ee23dc8,0x3d493eed,0x3e71befb
.long 0xbeed2530,0x3e443eb5,0xbeeda50e,0x3e443eb5,0xbea2be44,0xbe153efb,0x3ec6beed,0xbef53dc8
.long 0xbdc8beb5,0xbed53eed,0x3dc83eb5,0x3ed5beed,0x3e15beed,0xbeff3e8e,0xbef53e44,0xbd493ed5
.long 0x3eb5bf00,0xbeb5259f,0x3eb5bf00,0xbeb5250d,0x3ef5beed,0xbd49be8e,0x3e153e44,0x3effbed5
.long 0x3efbbeb5,0x3e8ebeed,0xbefb3eb5,0xbe8e3eed,0x3ec6be44,0x3ef5befb,0x3ea2beed,0xbe15bdc8
.long 0x3e44a577,0x3eedbeb5,0x3e44a70d,0x3eedbeb5,0xbd493e44,0x3e71bdc8,0xbeff3eed,0xbee23efb
.long 0xbe8e3eb5,0xbdc83e44,0x3e8ebeb5,0x3dc8be44,0xbee23eed,0xbec63ed5,0x3e71be44,0x3ea2be8e
.long 0x259f3f00,0xa6b1bf00,0xa50e3f00,0xa6f7bf00,0xbec63eb5,0x3ee2be8e,0xbea2beb5,0x3e713ed5
.long 0xbefb259f,0x3ed53e44,0x3efba6f7,0xbed5be44,0xbe71beb5,0xbd493efb,0xbee23eb5,0x3effbdc8
.long 0x3e44bf00,0xbeed3eb5,0x3e44bf00,0xbeed3eb5,0x3ef5beb5,0xbec6bdc8,0x3e153eb5,0x3ea2befb
.long 0x3ed5a6b1,0x3dc8beed,0xbed52784,0xbdc83eed,0x3d493eb5,0x3ef5bed5,0x3effbeb5,0xbe15be8e
.long 0xbeb53f00,0x3eb5a6c2,0xbeb53f00,0x3eb5a716,0xbeff3eb5,0xbe153ed5,0x3d49beb5,0xbef53e8e
.long 0xbe8ea60d,0xbefb3eed,0x3e8e26d4,0x3efbbeed,0x3e15beb5,0xbea23dc8,0xbef53eb5,0xbec63efb
.long 0x3eedbf00,0x3e44beb5,0x3eedbf00,0x3e44beb5,0x3ee2beb5,0x3effbefb,0xbe713eb5,0x3d493dc8
.long 0x3dc8a6c2,0x3e8ebe44,0xbdc82809,0xbe8e3e44,0xbea23eb5,0xbe713e8e,0x3ec6beb5,0x3ee2bed5
.long 0xa60d3f00,0xa6c2bf00,0xa0b73f00,0xa704bf00,0xbef53e44,0x3effbdc8,0xbe15beed,0x3d493efb
.long 0xbe8ebeb5,0x3dc83eed,0x3e8e3eb5,0xbdc8beed,0x3ea2beed,0xbef53e8e,0xbec6be44,0x3e153ed5
.long 0x3eeda6c2,0xbe44beb5,0x3eeda70d,0xbe44beb5,0xbd493eed,0x3ee2bed5,0xbeff3e44,0x3e713e8e
.long 0xbefb3eb5,0x3e8e3e44,0x3efbbeb5,0xbe8ebe44,0xbe71be44,0xbec63efb,0xbee23eed,0x3ea23dc8
.long 0x3eb5bf00,0xbeb5a58d,0x3eb5bf00,0xbeb5260d,0x3ee2be44,0x3ea2befb,0xbe713eed,0x3ec6bdc8
.long 0xbdc83eb5,0x3ed5be44,0x3dc8beb5,0xbed53e44,0xbeff3eed,0xbe713ed5,0x3d493e44,0x3ee2be8e
.long 0xbe44a58d,0xbeed3eb5,0xbe442796,0xbeed3eb5,0x3ec6beed,0x3e15be8e,0x3ea2be44,0x3ef5bed5
.long 0x3ed5beb5,0x3efbbeed,0xbed53eb5,0xbefb3eed,0xbe153e44,0xbd493dc8,0x3ef5beed,0x3effbefb
.long 0xbf008000,0x3f00a48d,0xbf00260d,0x3f00a61f,0xbeff8000,0x3ef53dc8,0x3d49bf00,0xbe153efb
.long 0xbefb8000,0x3ed53e44,0x3efba61f,0xbed5be44,0xbef58000,0x3ea23e8e,0xbe153f00,0x3ec6bed5
.long 0xbeed8000,0x3e443eb5,0xbeed2630,0x3e443eb5,0xbee28000,0x3d493ed5,0x3e71bf00,0xbeff3e8e
.long 0xbed58000,0xbdc83eed,0x3ed5a731,0x3dc8beed,0xbec68000,0xbe713efb,0xbea23f00,0x3ee2bdc8
.long 0xbeb58000,0xbeb53f00,0xbeb52654,0xbeb53f00,0xbea28000,0xbee23efb,0x3ec6bf00,0xbe71bdc8
.long 0xbe8e8000,0xbefb3eed,0x3e8e268d,0x3efbbeed,0xbe718000,0xbeff3ed5,0xbee23f00,0xbd493e8e
.long 0xbe448000,0xbeed3eb5,0xbe442677,0xbeed3eb5,0xbe158000,0xbec63e8e,0x3ef5bf00,0x3ea2bed5
.long 0xbdc88000,0xbe8e3e44,0x3dc8a742,0x3e8ebe44,0xbd498000,0xbe153dc8,0xbeff3f00,0xbef53efb
.long 0xbf00250d,0x3f00a554,0xbf002630,0x3f00a731,0xbee2be44,0x3ec63e8e,0x3e71beed,0xbea23ed5
.long 0xbe8ebeb5,0x3dc83eed,0x3e8e3eb5,0xbdc8beed,0xbd49beed,0xbe713efb,0xbeff3e44,0x3ee23dc8
.long 0x3e44bf00,0xbeed3eb5,0x3e44bf00,0xbeed3eb5,0x3ec6beed,0xbef53dc8,0x3ea23e44,0x3e15befb
.long 0x3efbbeb5,0xbe8ebe44,0xbefb3eb5,0x3e8e3e44,0x3ef5be44,0x3d49bed5,0x3e15beed,0xbeff3e8e
.long 0x3eb5a554,0x3eb5bf00,0x3eb5a742,0x3eb5bf00,0x3e153e44,0x3effbed5,0xbef53eed,0x3d493e8e
.long 0xbdc83eb5,0x3ed5be44,0x3dc8beb5,0xbed53e44,0xbea23eed,0x3e153dc8,0x3ec6be44,0x3ef5befb
.long 0xbeed3f00,0xbe443eb5,0xbeed3f00,0xbe443eb5,0xbeff3eed,0xbee23efb,0x3d49be44,0xbe713dc8
.long 0xbed53eb5,0xbefb3eed,0x3ed5beb5,0x3efbbeed,0xbe713e44,0xbea23e8e,0xbee23eed,0xbec63ed5
.long 0xbf00258d,0x3f00a5b0,0xbf002654,0x3f00268d,0xbea2beb5,0x3e713ed5,0x3ec6beb5,0xbee23e8e
.long 0x3dc8bf00,0xbe8e3eed,0xbdc83f00,0x3e8ebeed,0x3ee2beb5,0xbeff3dc8,0xbe71beb5,0xbd493efb
.long 0x3eeda5b0,0xbe44beb5,0x3eeda742,0xbe44beb5,0x3e153eb5,0x3ea2befb,0xbef53eb5,0x3ec63dc8
.long 0xbe8e3f00,0x3efbbe44,0x3e8ebf00,0xbefb3e44,0xbeff3eb5,0x3e153e8e,0x3d493eb5,0x3ef5bed5
.long 0xbeb525d4,0xbeb53f00,0xbeb5269f,0xbeb53f00,0x3d49beb5,0xbef53e8e,0x3effbeb5,0x3e15bed5
.long 0x3ed5bf00,0xbdc8be44,0xbed53f00,0x3dc83e44,0x3ef5beb5,0x3ec6befb,0x3e15beb5,0xbea23dc8
.long 0x3e44a5f7,0x3eedbeb5,0x3e44260d,0x3eedbeb5,0xbe713eb5,0x3d493dc8,0xbee23eb5,0xbeff3efb
.long 0xbefb3f00,0xbed53eed,0x3efbbf00,0x3ed5beed,0xbec63eb5,0xbee23ed5,0xbea23eb5,0xbe713e8e
.long 0xbf0025d4,0x3f00a5f7,0xbf002677,0x3f00a742,0xbe15beed,0x3d493efb,0x3ef5be44,0xbeff3dc8
.long 0x3ed5beb5,0xbefb3e44,0xbed53eb5,0x3efbbe44,0x3ec63e44,0xbe15bed5,0x3ea2beed,0xbef53e8e
.long 0xbe443f00,0x3eedbeb5,0xbe443f00,0x3eedbeb5,0xbeff3e44,0x3e713e8e,0x3d49beed,0xbee23ed5
.long 0xbdc8beb5,0xbed53eed,0x3dc83eb5,0x3ed5beed,0x3ee2beed,0xbea2bdc8,0xbe71be44,0xbec63efb
.long 0x3eb5a61f,0x3eb5bf00,0x3eb5260d,0x3eb5bf00,0xbe713eed,0x3ec6bdc8,0xbee23e44,0xbea23efb
.long 0xbefb3eb5,0xbe8e3eed,0x3efbbeb5,0x3e8ebeed,0xbd49be44,0xbee23e8e,0xbeff3eed,0xbe713ed5
.long 0x3eedbf00,0x3e44beb5,0x3eedbf00,0x3e44beb5,0x3ea2be44,0x3ef5bed5,0xbec63eed,0xbe153e8e
.long 0xbe8e3eb5,0xbdc83e44,0x3e8ebeb5,0x3dc8be44,0xbef53eed,0xbeff3efb,0xbe153e44,0xbd493dc8
.long 0x250d3f00,0xa70dbf00,0x27963f00,0xa731bf00,0x3d49bf00,0xbe153efb,0x3eff27a8,0xbef5bdc8
.long 0xbdc83f00,0x3e8ebeed,0x3dc8bf00,0xbe8e3eed,0x3e15bf00,0xbec63ed5,0xbef5279f,0x3ea23e8e
.long 0xbe443f00,0x3eedbeb5,0xbe443f00,0x3eedbeb5,0x3e71bf00,0xbeff3e8e,0x3ee22654,0xbd49bed5
.long 0xbe8e3f00,0x3efbbe44,0x3e8ebf00,0xbefb3e44,0x3ea2bf00,0xbee23dc8,0xbec626b0,0xbe713efb
.long 0xbeb53f00,0x3eb5a731,0xbeb53f00,0x3eb5a765,0x3ec6bf00,0xbe71bdc8,0x3ea2a765,0x3ee2befb
.long 0xbed53f00,0x3dc83e44,0x3ed5bf00,0xbdc8be44,0x3ee2bf00,0x3d49be8e,0xbe7127b9,0xbeff3ed5
.long 0xbeed3f00,0xbe443eb5,0xbeed3f00,0xbe443eb5,0x3ef5bf00,0x3ea2bed5,0x3e15a800,0x3ec6be8e
.long 0xbefb3f00,0xbed53eed,0x3efbbf00,0x3ed5beed,0x3effbf00,0x3ef5befb,0xbd492823,0xbe153dc8
.long 0x258d3f00,0xa716bf00,0x26543f00,0x268dbf00,0x3e71beed,0xbea23ed5,0x3ee23e44,0xbec6be8e
.long 0xbed53eb5,0x3efbbe44,0x3ed5beb5,0xbefb3e44,0x3effbe44,0xbee2bdc8,0xbd49beed,0xbe713efb
.long 0xbeed260d,0x3e443eb5,0xbeed27a8,0x3e443eb5,0x3ea23e44,0x3e15befb,0xbec63eed,0x3ef5bdc8
.long 0xbdc8beb5,0xbed53eed,0x3dc83eb5,0x3ed5beed,0xbe153eed,0x3effbe8e,0x3ef5be44,0x3d49bed5
.long 0x3eb5bf00,0xbeb5279f,0x3eb5bf00,0xbeb527b9,0xbef53eed,0x3d493e8e,0xbe15be44,0xbeff3ed5
.long 0x3efbbeb5,0x3e8ebeed,0xbefb3eb5,0xbe8e3eed,0xbec63e44,0xbef53efb,0xbea23eed,0x3e153dc8
.long 0x3e442654,0x3eedbeb5,0x3e44a784,0x3eedbeb5,0x3d49be44,0xbe713dc8,0x3effbeed,0x3ee2befb
.long 0xbe8e3eb5,0xbdc83e44,0x3e8ebeb5,0x3dc8be44,0x3ee2beed,0x3ec6bed5,0xbe713e44,0xbea23e8e
.long 0x278d3f00,0xa71fbf00,0x279f3f00,0xa742bf00,0x3ec6beb5,0xbee23e8e,0x3ea23eb5,0xbe71bed5
.long 0xbefb260d,0x3ed53e44,0x3efb2654,0xbed5be44,0x3e713eb5,0x3d49befb,0x3ee2beb5,0xbeff3dc8
.long 0x3e44bf00,0xbeed3eb5,0x3e44bf00,0xbeed3eb5,0xbef53eb5,0x3ec63dc8,0xbe15beb5,0xbea23efb
.long 0x3ed5a7dd,0x3dc8beed,0xbed5281a,0xbdc83eed,0xbd49beb5,0xbef53ed5,0xbeff3eb5,0x3e153e8e
.long 0xbeb53f00,0x3eb52654,0xbeb53f00,0x3eb5a800,0x3effbeb5,0x3e15bed5,0xbd493eb5,0x3ef5be8e
.long 0xbe8ea731,0xbefb3eed,0x3e8e283e,0x3efbbeed,0xbe153eb5,0x3ea2bdc8,0x3ef5beb5,0x3ec6befb
.long 0x3eedbf00,0x3e44beb5,0x3eedbf00,0x3e44beb5,0xbee23eb5,0xbeff3efb,0x3e71beb5,0xbd49bdc8
.long 0x3dc8a765,0x3e8ebe44,0xbdc8286a,0xbe8e3e44,0x3ea2beb5,0x3e71be8e,0xbec63eb5,0xbee23ed5
.long 0x260d3f00,0x26b1bf00,0x268d3f00,0x2654bf00,0x3ef5be44,0xbeff3dc8,0x3e153eed,0xbd49befb
.long 0xbe8ebeb5,0x3dc83eed,0x3e8e3eb5,0xbdc8beed,0xbea23eed,0x3ef5be8e,0x3ec63e44,0xbe15bed5
.long 0x3eed268d,0xbe44beb5,0x3eeda765,0xbe44beb5,0x3d49beed,0xbee23ed5,0x3effbe44,0xbe71be8e
.long 0xbefb3eb5,0x3e8e3e44,0x3efbbeb5,0xbe8ebe44,0x3e713e44,0x3ec6befb,0x3ee2beed,0xbea2bdc8
.long 0x3eb5bf00,0xbeb526b0,0x3eb5bf00,0xbeb52823,0xbee23e44,0xbea23efb,0x3e71beed,0xbec63dc8
.long 0xbdc83eb5,0x3ed5be44,0x3dc8beb5,0xbed53e44,0x3effbeed,0x3e71bed5,0xbd49be44,0xbee23e8e
.long 0xbe4426d4,0xbeed3eb5,0xbe44a6b1,0xbeed3eb5,0xbec63eed,0xbe153e8e,0xbea23e44,0xbef53ed5
.long 0x3ed5beb5,0x3efbbeed,0xbed53eb5,0xbefb3eed,0x3e15be44,0x3d49bdc8,0xbef53eed,0xbeff3efb
.long 0xbf00268d,0x3f002654,0xbf0026d4,0x3f00258e,0x3eff2654,0xbef5bdc8,0xbd493f00,0x3e15befb
.long 0xbefb269f,0x3ed53e44,0x3efba777,0xbed5be44,0x3ef5a754,0xbea2be8e,0x3e15bf00,0xbec63ed5
.long 0xbeed26b0,0x3e443eb5,0xbeed27c2,0x3e443eb5,0x3ee2260d,0xbd49bed5,0xbe713f00,0x3effbe8e
.long 0xbed527b1,0xbdc83eed,0x3ed5a804,0x3dc8beed,0x3ec6a765,0x3e71befb,0x3ea2bf00,0xbee23dc8
.long 0xbeb526d4,0xbeb53f00,0xbeb5271f,0xbeb53f00,0x3ea2258e,0x3ee2befb,0xbec63f00,0x3e713dc8
.long 0xbe8ea70d,0xbefb3eed,0x3e8e2754,0x3efbbeed,0x3e71a777,0x3effbed5,0x3ee2bf00,0x3d49be8e
.long 0xbe4426f7,0xbeed3eb5,0xbe44a68d,0xbeed3eb5,0x3e152137,0x3ec6be8e,0xbef53f00,0xbea23ed5
.long 0xbdc827c2,0xbe8e3e44,0x3dc8a889,0x3e8ebe44,0x3d49a784,0x3e15bdc8,0x3effbf00,0x3ef5befb
.long 0xbf00269f,0x3f00a754,0xbf00a70d,0x3f00a777,0x3ee23e44,0xbec6be8e,0xbe713eed,0x3ea2bed5
.long 0xbe8ebeb5,0x3dc83eed,0x3e8e3eb5,0xbdc8beed,0x3d493eed,0x3e71befb,0x3effbe44,0xbee2bdc8
.long 0x3e44bf00,0xbeed3eb5,0x3e44bf00,0xbeed3eb5,0xbec63eed,0x3ef5bdc8,0xbea2be44,0xbe153efb
.long 0x3efbbeb5,0xbe8ebe44,0xbefb3eb5,0x3e8e3e44,0xbef53e44,0xbd493ed5,0xbe153eed,0x3effbe8e
.long 0x3eb5a777,0x3eb5bf00,0x3eb5a796,0x3eb5bf00,0xbe15be44,0xbeff3ed5,0x3ef5beed,0xbd49be8e
.long 0xbdc83eb5,0x3ed5be44,0x3dc8beb5,0xbed53e44,0x3ea2beed,0xbe15bdc8,0xbec63e44,0xbef53efb
.long 0xbeed3f00,0xbe443eb5,0xbeed3f00,0xbe443eb5,0x3effbeed,0x3ee2befb,0xbd493e44,0x3e71bdc8
.long 0xbed53eb5,0xbefb3eed,0x3ed5beb5,0x3efbbeed,0x3e71be44,0x3ea2be8e,0x3ee2beed,0x3ec6bed5
.long 0xbf0026b0,0x3f00260d,0xbf0026f7,0x3f002137,0x3ea23eb5,0xbe71bed5,0xbec63eb5,0x3ee2be8e
.long 0x3dc8bf00,0xbe8e3eed,0xbdc83f00,0x3e8ebeed,0xbee23eb5,0x3effbdc8,0x3e713eb5,0x3d49befb
.long 0x3eed258e,0xbe44beb5,0x3eeda78d,0xbe44beb5,0xbe15beb5,0xbea23efb,0x3ef5beb5,0xbec6bdc8
.long 0xbe8e3f00,0x3efbbe44,0x3e8ebf00,0xbefb3e44,0x3effbeb5,0xbe15be8e,0xbd49beb5,0xbef53ed5
.long 0xbeb527c2,0xbeb53f00,0xbeb5a68d,0xbeb53f00,0xbd493eb5,0x3ef5be8e,0xbeff3eb5,0xbe153ed5
.long 0x3ed5bf00,0xbdc8be44,0xbed53f00,0x3dc83e44,0xbef53eb5,0xbec63efb,0xbe153eb5,0x3ea2bdc8
.long 0x3e44a78d,0x3eedbeb5,0x3e44a816,0x3eedbeb5,0x3e71beb5,0xbd49bdc8,0x3ee2beb5,0x3effbefb
.long 0xbefb3f00,0xbed53eed,0x3efbbf00,0x3ed5beed,0x3ec6beb5,0x3ee2bed5,0x3ea2beb5,0x3e71be8e
.long 0xbf0027b1,0x3f00a765,0xbf0027c2,0x3f00a784,0x3e153eed,0xbd49befb,0xbef53e44,0x3effbdc8
.long 0x3ed5beb5,0xbefb3e44,0xbed53eb5,0x3efbbe44,0xbec6be44,0x3e153ed5,0xbea23eed,0x3ef5be8e
.long 0xbe443f00,0x3eedbeb5,0xbe443f00,0x3eedbeb5,0x3effbe44,0xbe71be8e,0xbd493eed,0x3ee2bed5
.long 0xbdc8beb5,0xbed53eed,0x3dc83eb5,0x3ed5beed,0xbee23eed,0x3ea23dc8,0x3e713e44,0x3ec6befb
.long 0x3eb5a58d,0x3eb5bf00,0x3eb5a68d,0x3eb5bf00,0x3e71beed,0xbec63dc8,0x3ee2be44,0x3ea2befb
.long 0xbefb3eb5,0xbe8e3eed,0x3efbbeb5,0x3e8ebeed,0x3d493e44,0x3ee2be8e,0x3effbeed,0x3e71bed5
.long 0x3eedbf00,0x3e44beb5,0x3eedbf00,0x3e44beb5,0xbea23e44,0xbef53ed5,0x3ec6beed,0x3e15be8e
.long 0xbe8e3eb5,0xbdc83e44,0x3e8ebeb5,0x3dc8be44,0x3ef5beed,0x3effbefb,0x3e15be44,0x3d49bdc8
.long 0xbf003f00,0xbf003f00,0xbf003f00,0xbf003f00,0xbeff3f00,0xbef53efb,0x3d49250d,0x3e15bdc8
.long 0xbefb3f00,0xbed53eed,0x3efbbf00,0x3ed5beed,0xbef53f00,0xbea23ed5,0xbe15a70d,0xbec63e8e
.long 0xbeed3f00,0xbe443eb5,0xbeed3f00,0xbe443eb5,0xbee23f00,0xbd493e8e,0x3e71258d,0x3effbed5
.long 0xbed53f00,0x3dc83e44,0x3ed5bf00,0xbdc8be44,0xbec63f00,0x3e713dc8,0xbea2a716,0xbee23efb
.long 0xbeb53f00,0x3eb52530,0xbeb53f00,0x3eb5260d,0xbea23f00,0x3ee2bdc8,0x3ec6278d,0x3e71befb
.long 0xbe8e3f00,0x3efbbe44,0x3e8ebf00,0xbefb3e44,0xbe713f00,0x3effbe8e,0xbee2a71f,0x3d493ed5
.long 0xbe443f00,0x3eedbeb5,0xbe443f00,0x3eedbeb5,0xbe153f00,0x3ec6bed5,0x3ef5260d,0xbea2be8e
.long 0xbdc83f00,0x3e8ebeed,0x3dc8bf00,0xbe8e3eed,0xbd493f00,0x3e15befb,0xbeff26b1,0x3ef53dc8
.long 0xbf003f00,0xbf003f00,0xbf003f00,0xbf003f00,0xbee23eed,0xbec63ed5,0x3e71be44,0x3ea2be8e
.long 0xbe8e3eb5,0xbdc83e44,0x3e8ebeb5,0x3dc8be44,0xbd493e44,0x3e71bdc8,0xbeff3eed,0xbee23efb
.long 0x3e44259f,0x3eedbeb5,0x3e44260d,0x3eedbeb5,0x3ec6be44,0x3ef5befb,0x3ea2beed,0xbe15bdc8
.long 0x3efbbeb5,0x3e8ebeed,0xbefb3eb5,0xbe8e3eed,0x3ef5beed,0xbd49be8e,0x3e153e44,0x3effbed5
.long 0x3eb5bf00,0xbeb5a6c2,0x3eb5bf00,0xbeb5268d,0x3e15beed,0xbeff3e8e,0xbef53e44,0xbd493ed5
.long 0xbdc8beb5,0xbed53eed,0x3dc83eb5,0x3ed5beed,0xbea2be44,0xbe153efb,0x3ec6beed,0xbef53dc8
.long 0xbeeda6b1,0x3e443eb5,0xbeeda7dd,0x3e443eb5,0xbeff3e44,0x3ee23dc8,0x3d493eed,0x3e71befb
.long 0xbed53eb5,0x3efbbe44,0x3ed5beb5,0xbefb3e44,0xbe713eed,0x3ea2bed5,0xbee2be44,0x3ec63e8e
.long 0xbf003f00,0xbf003f00,0xbf003f00,0xbf003f00,0xbea23eb5,0xbe713e8e,0x3ec6beb5,0x3ee2bed5
.long 0x3dc8a5d4,0x3e8ebe44,0xbdc827a8,0xbe8e3e44,0x3ee2beb5,0x3effbefb,0xbe713eb5,0x3d493dc8
.long 0x3eedbf00,0x3e44beb5,0x3eedbf00,0x3e44beb5,0x3e15beb5,0xbea23dc8,0xbef53eb5,0xbec63efb
.long 0xbe8ea6d4,0xbefb3eed,0x3e8e279f,0x3efbbeed,0xbeff3eb5,0xbe153ed5,0x3d49beb5,0xbef53e8e
.long 0xbeb53f00,0x3eb5a50e,0xbeb53f00,0x3eb527a8,0x3d493eb5,0x3ef5bed5,0x3effbeb5,0xbe15be8e
.long 0x3ed5a58d,0x3dc8beed,0xbed52654,0xbdc83eed,0x3ef5beb5,0xbec6bdc8,0x3e153eb5,0x3ea2befb
.long 0x3e44bf00,0xbeed3eb5,0x3e44bf00,0xbeed3eb5,0xbe71beb5,0xbd493efb,0xbee23eb5,0x3effbdc8
.long 0xbefba6e5,0x3ed53e44,0x3efb26b0,0xbed5be44,0xbec63eb5,0x3ee2be8e,0xbea2beb5,0x3e713ed5
.long 0xbf003f00,0xbf003f00,0xbf003f00,0xbf003f00,0xbe153e44,0xbd493dc8,0x3ef5beed,0x3effbefb
.long 0x3ed5beb5,0x3efbbeed,0xbed53eb5,0xbefb3eed,0x3ec6beed,0x3e15be8e,0x3ea2be44,0x3ef5bed5
.long 0xbe44a6f7,0xbeed3eb5,0xbe442654,0xbeed3eb5,0xbeff3eed,0xbe713ed5,0x3d493e44,0x3ee2be8e
.long 0xbdc83eb5,0x3ed5be44,0x3dc8beb5,0xbed53e44,0x3ee2be44,0x3ea2befb,0xbe713eed,0x3ec6bdc8
.long 0x3eb5bf00,0xbeb5a70d,0x3eb5bf00,0xbeb5a765,0xbe71be44,0xbec63efb,0xbee23eed,0x3ea23dc8
.long 0xbefb3eb5,0x3e8e3e44,0x3efbbeb5,0xbe8ebe44,0xbd493eed,0x3ee2bed5,0xbeff3e44,0x3e713e8e
.long 0x3eed2784,0xbe44beb5,0x3eed281a,0xbe44beb5,0x3ea2beed,0xbef53e8e,0xbec6be44,0x3e153ed5
.long 0xbe8ebeb5,0x3dc83eed,0x3e8e3eb5,0xbdc8beed,0xbef53e44,0x3effbdc8,0xbe15beed,0x3d493efb
.long 0xa48d8000,0xa554250d,0x2654268d,0xa754269f,0x3d498000,0x3e15bdc8,0x3effbf00,0x3ef5befb
.long 0x3dc88000,0x3e8ebe44,0xbdc82654,0xbe8e3e44,0x3e158000,0x3ec6be8e,0xbef53f00,0xbea23ed5
.long 0x3e448000,0x3eedbeb5,0x3e44269f,0x3eedbeb5,0x3e718000,0x3effbed5,0x3ee2bf00,0x3d49be8e
.long 0x3e8e8000,0x3efbbeed,0xbe8ea754,0xbefb3eed,0x3ea28000,0x3ee2befb,0xbec63f00,0x3e713dc8
.long 0x3eb58000,0x3eb5bf00,0x3eb526b0,0x3eb5bf00,0x3ec68000,0x3e71befb,0x3ea2bf00,0xbee23dc8
.long 0x3ed58000,0x3dc8beed,0xbed5260d,0xbdc83eed,0x3ee28000,0xbd49bed5,0xbe713f00,0x3effbe8e
.long 0x3eed8000,0xbe44beb5,0x3eed27b1,0xbe44beb5,0x3ef58000,0xbea2be8e,0x3e15bf00,0xbec63ed5
.long 0x3efb8000,0xbed5be44,0xbefba765,0x3ed53e44,0x3eff8000,0xbef5bdc8,0xbd493f00,0x3e15befb
.long 0xa5b0258d,0xa5f725d4,0x260d26b0,0xa76527b1,0x3e71be44,0x3ea2be8e,0x3ee2beed,0x3ec6bed5
.long 0x3ed5beb5,0x3efbbeed,0xbed53eb5,0xbefb3eed,0x3effbeed,0x3ee2befb,0xbd493e44,0x3e71bdc8
.long 0x3eedbf00,0x3e44beb5,0x3eedbf00,0x3e44beb5,0x3ea2beed,0xbe15bdc8,0xbec63e44,0xbef53efb
.long 0x3dc8beb5,0xbed53e44,0xbdc83eb5,0x3ed5be44,0xbe15be44,0xbeff3ed5,0x3ef5beed,0xbd49be8e
.long 0xbeb5a5b0,0xbeb53f00,0xbeb5258e,0xbeb53f00,0xbef53e44,0xbd493ed5,0xbe153eed,0x3effbe8e
.long 0xbefb3eb5,0x3e8e3e44,0x3efbbeb5,0xbe8ebe44,0xbec63eed,0x3ef5bdc8,0xbea2be44,0xbe153efb
.long 0xbe443f00,0x3eedbeb5,0xbe443f00,0x3eedbeb5,0x3d493eed,0x3e71befb,0x3effbe44,0xbee2bdc8
.long 0x3e8e3eb5,0xbdc8beed,0xbe8ebeb5,0x3dc83eed,0x3ee23e44,0xbec6be8e,0xbe713eed,0x3ea2bed5
.long 0xa61f260d,0xa7312630,0x258e26d4,0xa777a70d,0x3ec6beb5,0x3ee2bed5,0x3ea2beb5,0x3e71be8e
.long 0x3efbbf00,0x3ed5beed,0xbefb3f00,0xbed53eed,0x3e71beb5,0xbd49bdc8,0x3ee2beb5,0x3effbefb
.long 0xbe44a61f,0xbeed3eb5,0xbe44a777,0xbeed3eb5,0xbef53eb5,0xbec63efb,0xbe153eb5,0x3ea2bdc8
.long 0xbed53f00,0x3dc83e44,0x3ed5bf00,0xbdc8be44,0xbd493eb5,0x3ef5be8e,0xbeff3eb5,0xbe153ed5
.long 0x3eb52630,0x3eb5bf00,0x3eb527c2,0x3eb5bf00,0x3effbeb5,0xbe15be8e,0xbd49beb5,0xbef53ed5
.long 0x3e8ebf00,0xbefb3e44,0xbe8e3f00,0x3efbbe44,0xbe15beb5,0xbea23efb,0x3ef5beb5,0xbec6bdc8
.long 0xbeeda731,0x3e443eb5,0xbeeda804,0x3e443eb5,0xbee23eb5,0x3effbdc8,0x3e713eb5,0x3d49befb
.long 0xbdc83f00,0x3e8ebeed,0x3dc8bf00,0xbe8e3eed,0x3ea23eb5,0xbe71bed5,0xbec63eb5,0x3ee2be8e
.long 0x268d2654,0xa7422677,0x213726f7,0xa78427c2,0x3ef5beed,0x3effbefb,0x3e15be44,0x3d49bdc8
.long 0x3e8ebeb5,0x3dc8be44,0xbe8e3eb5,0xbdc83e44,0xbea23e44,0xbef53ed5,0x3ec6beed,0x3e15be8e
.long 0xbeed3f00,0xbe443eb5,0xbeed3f00,0xbe443eb5,0x3d493e44,0x3ee2be8e,0x3effbeed,0x3e71bed5
.long 0x3efbbeb5,0x3e8ebeed,0xbefb3eb5,0xbe8e3eed,0x3e71beed,0xbec63dc8,0x3ee2be44,0x3ea2befb
.long 0xbeb5a742,0xbeb53f00,0xbeb5a78d,0xbeb53f00,0xbee23eed,0x3ea23dc8,0x3e713e44,0x3ec6befb
.long 0x3dc83eb5,0x3ed5beed,0xbdc8beb5,0xbed53eed,0x3effbe44,0xbe71be8e,0xbd493eed,0x3ee2bed5
.long 0x3e44bf00,0xbeed3eb5,0x3e44bf00,0xbeed3eb5,0xbec6be44,0x3e153ed5,0xbea23eed,0x3ef5be8e
.long 0xbed53eb5,0x3efbbe44,0x3ed5beb5,0xbefb3e44,0x3e153eed,0xbd49befb,0xbef53e44,0x3effbdc8
.long 0xbf003f00,0xbf003f00,0xbf003f00,0xbf003f00,0x3effbf00,0x3ef5befb,0xbd492766,0xbe153dc8
.long 0xbefb3f00,0xbed53eed,0x3efbbf00,0x3ed5beed,0x3ef5bf00,0x3ea2bed5,0x3e15a6b1,0x3ec6be8e
.long 0xbeed3f00,0xbe443eb5,0xbeed3f00,0xbe443eb5,0x3ee2bf00,0x3d49be8e,0xbe71a654,0xbeff3ed5
.long 0xbed53f00,0x3dc83e44,0x3ed5bf00,0xbdc8be44,0x3ec6bf00,0xbe71bdc8,0x3ea22742,0x3ee2befb
.long 0xbeb53f00,0x3eb526f7,0xbeb53f00,0x3eb52835,0x3ea2bf00,0xbee23dc8,0xbec6a8aa,0xbe713efb
.long 0xbe8e3f00,0x3efbbe44,0x3e8ebf00,0xbefb3e44,0x3e71bf00,0xbeff3e8e,0x3ee227ee,0xbd49bed5
.long 0xbe443f00,0x3eedbeb5,0xbe443f00,0x3eedbeb5,0x3e15bf00,0xbec63ed5,0xbef527cb,0x3ea23e8e
.long 0xbdc83f00,0x3e8ebeed,0x3dc8bf00,0xbe8e3eed,0x3d49bf00,0xbe153efb,0x3effa784,0xbef5bdc8
.long 0xbf003f00,0xbf003f00,0xbf003f00,0xbf003f00,0x3ee2beed,0x3ec6bed5,0xbe713e44,0xbea23e8e
.long 0xbe8e3eb5,0xbdc83e44,0x3e8ebeb5,0x3dc8be44,0x3d49be44,0xbe713dc8,0x3effbeed,0x3ee2befb
.long 0x3e4427b9,0x3eedbeb5,0x3e442742,0x3eedbeb5,0xbec63e44,0xbef53efb,0xbea23eed,0x3e153dc8
.long 0x3efbbeb5,0x3e8ebeed,0xbefb3eb5,0xbe8e3eed,0xbef53eed,0x3d493e8e,0xbe15be44,0xbeff3ed5
.long 0x3eb5bf00,0xbeb5a58d,0x3eb5bf00,0xbeb5a81a,0xbe153eed,0x3effbe8e,0x3ef5be44,0x3d49bed5
.long 0xbdc8beb5,0xbed53eed,0x3dc83eb5,0x3ed5beed,0x3ea23e44,0x3e15befb,0xbec63eed,0x3ef5bdc8
.long 0xbeeda847,0x3e443eb5,0xbeeda88f,0x3e443eb5,0x3effbe44,0xbee2bdc8,0xbd49beed,0xbe713efb
.long 0xbed53eb5,0x3efbbe44,0x3ed5beb5,0xbefb3e44,0x3e71beed,0xbea23ed5,0x3ee23e44,0xbec6be8e
.long 0xbf003f00,0xbf003f00,0xbf003f00,0xbf003f00,0x3ea2beb5,0x3e71be8e,0xbec63eb5,0xbee23ed5
.long 0x3dc826f7,0x3e8ebe44,0xbdc827dd,0xbe8e3e44,0xbee23eb5,0xbeff3efb,0x3e71beb5,0xbd49bdc8
.long 0x3eedbf00,0x3e44beb5,0x3eedbf00,0x3e44beb5,0xbe153eb5,0x3ea2bdc8,0x3ef5beb5,0x3ec6befb
.long 0xbe8ea58d,0xbefb3eed,0x3e8e289d,0x3efbbeed,0x3effbeb5,0x3e15bed5,0xbd493eb5,0x3ef5be8e
.long 0xbeb53f00,0x3eb5a6b1,0xbeb53f00,0x3eb52800,0xbd49beb5,0xbef53ed5,0xbeff3eb5,0x3e153e8e
.long 0x3ed5a6b1,0x3dc8beed,0xbed526f7,0xbdc83eed,0xbef53eb5,0x3ec63dc8,0xbe15beb5,0xbea23efb
.long 0x3e44bf00,0xbeed3eb5,0x3e44bf00,0xbeed3eb5,0x3e713eb5,0x3d49befb,0x3ee2beb5,0xbeff3dc8
.long 0xbefba84f,0x3ed53e44,0x3efb2809,0xbed5be44,0x3ec6beb5,0xbee23e8e,0x3ea23eb5,0xbe71bed5
.long 0xbf003f00,0xbf003f00,0xbf003f00,0xbf003f00,0x3e15be44,0x3d49bdc8,0xbef53eed,0xbeff3efb
.long 0x3ed5beb5,0x3efbbeed,0xbed53eb5,0xbefb3eed,0xbec63eed,0xbe153e8e,0xbea23e44,0xbef53ed5
.long 0xbe442766,0xbeed3eb5,0xbe44a81a,0xbeed3eb5,0x3effbeed,0x3e71bed5,0xbd49be44,0xbee23e8e
.long 0xbdc83eb5,0x3ed5be44,0x3dc8beb5,0xbed53e44,0xbee23e44,0xbea23efb,0x3e71beed,0xbec63dc8
.long 0x3eb5bf00,0xbeb52742,0x3eb5bf00,0xbeb5a7cb,0x3e713e44,0x3ec6befb,0x3ee2beed,0xbea2bdc8
.long 0xbefb3eb5,0x3e8e3e44,0x3efbbeb5,0xbe8ebe44,0x3d49beed,0xbee23ed5,0x3effbe44,0xbe71be8e
.long 0x3eed2873,0xbe44beb5,0x3eed28a6,0xbe44beb5,0xbea23eed,0x3ef5be8e,0x3ec63e44,0xbe15bed5
.long 0xbe8ebeb5,0x3dc83eed,0x3e8e3eb5,0xbdc8beed,0x3ef5be44,0xbeff3dc8,0x3e153eed,0xbd49befb
.long 0xa58d270d,0xa78da6d4,0xa8162754,0xa7b1a60e,0xbd49a58d,0xbe153dc8,0xbeff3f00,0xbef53efb
.long 0x3dc8a6d4,0x3e8ebe44,0xbdc82828,0xbe8e3e44,0xbe15a78d,0xbec63e8e,0x3ef5bf00,0x3ea2bed5
.long 0x3e44271f,0x3eedbeb5,0x3e4427f7,0x3eedbeb5,0xbe71a60d,0xbeff3ed5,0xbee23f00,0xbd493e8e
.long 0x3e8e27d4,0x3efbbeed,0xbe8ea81f,0xbefb3eed,0xbea2a796,0xbee23efb,0x3ec6bf00,0xbe71bdc8
.long 0x3eb52730,0x3eb5bf00,0x3eb52842,0x3eb5bf00,0xbec6a80d,0xbe713efb,0xbea23f00,0x3ee2bdc8
.long 0x3ed5a68d,0x3dc8beed,0xbed526d4,0xbdc83eed,0xbee2a79f,0x3d493ed5,0x3e71bf00,0xbeff3e8e
.long 0x3eed2831,0xbe44beb5,0x3eed2884,0xbe44beb5,0xbef5a68d,0x3ea23e8e,0xbe153f00,0x3ec6bed5
.long 0x3efb27e5,0xbed5be44,0xbefba730,0x3ed53e44,0xbeff2731,0x3ef53dc8,0x3d49bf00,0xbe153efb
.long 0xa60d271f,0xa79627d4,0xa6d4a78d,0x270d27f7,0xbe713e44,0xbea23e8e,0xbee23eed,0xbec63ed5
.long 0x3ed5beb5,0x3efbbeed,0xbed53eb5,0xbefb3eed,0xbeff3eed,0xbee23efb,0x3d49be44,0xbe713dc8
.long 0x3eedbf00,0x3e44beb5,0x3eedbf00,0x3e44beb5,0xbea23eed,0x3e153dc8,0x3ec6be44,0x3ef5befb
.long 0x3dc8beb5,0xbed53e44,0xbdc83eb5,0x3ed5be44,0x3e153e44,0x3effbed5,0xbef53eed,0x3d493e8e
.long 0xbeb5a68d,0xbeb53f00,0xbeb5a828,0xbeb53f00,0x3ef5be44,0x3d49bed5,0x3e15beed,0xbeff3e8e
.long 0xbefb3eb5,0x3e8e3e44,0x3efbbeb5,0xbe8ebe44,0x3ec6beed,0xbef53dc8,0x3ea23e44,0x3e15befb
.long 0xbe443f00,0x3eedbeb5,0xbe443f00,0x3eedbeb5,0xbd49beed,0xbe713efb,0xbeff3e44,0x3ee23dc8
.long 0x3e8e3eb5,0xbdc8beed,0xbe8ebeb5,0x3dc83eed,0xbee2be44,0x3ec63e8e,0x3e71beed,0xbea23ed5
.long 0xa80d2730,0xa79fa68d,0xa81f2777,0xa7c2a1b7,0xbec63eb5,0xbee23ed5,0xbea23eb5,0xbe713e8e
.long 0x3efbbf00,0x3ed5beed,0xbefb3f00,0xbed53eed,0xbe713eb5,0x3d493dc8,0xbee23eb5,0xbeff3efb
.long 0xbe44a68d,0xbeed3eb5,0xbe4426d4,0xbeed3eb5,0x3ef5beb5,0x3ec6befb,0x3e15beb5,0xbea23dc8
.long 0xbed53f00,0x3dc83e44,0x3ed5bf00,0xbdc8be44,0x3d49beb5,0xbef53e8e,0x3effbeb5,0x3e15bed5
.long 0x3eb5a60e,0x3eb5bf00,0x3eb5280d,0x3eb5bf00,0xbeff3eb5,0x3e153e8e,0x3d493eb5,0x3ef5bed5
.long 0x3e8ebf00,0xbefb3e44,0xbe8e3f00,0x3efbbe44,0x3e153eb5,0x3ea2befb,0xbef53eb5,0x3ec63dc8
.long 0xbeeda85d,0x3e443eb5,0xbeeda89a,0x3e443eb5,0x3ee2beb5,0xbeff3dc8,0xbe71beb5,0xbd493efb
.long 0xbdc83f00,0x3e8ebeed,0x3dc8bf00,0xbe8e3eed,0xbea2beb5,0x3e713ed5,0x3ec6beb5,0xbee23e8e
.long 0xa68d2831,0x273127e5,0xa70d2842,0x26d42804,0xbef53eed,0xbeff3efb,0xbe153e44,0xbd493dc8
.long 0x3e8ebeb5,0x3dc8be44,0xbe8e3eb5,0xbdc83e44,0x3ea2be44,0x3ef5bed5,0xbec63eed,0xbe153e8e
.long 0xbeed3f00,0xbe443eb5,0xbeed3f00,0xbe443eb5,0xbd49be44,0xbee23e8e,0xbeff3eed,0xbe713ed5
.long 0x3efbbeb5,0x3e8ebeed,0xbefb3eb5,0xbe8e3eed,0xbe713eed,0x3ec6bdc8,0xbee23e44,0xbea23efb
.long 0xbeb5270d,0xbeb53f00,0xbeb5a7e5,0xbeb53f00,0x3ee2beed,0xbea2bdc8,0xbe71be44,0xbec63efb
.long 0x3dc83eb5,0x3ed5beed,0xbdc8beb5,0xbed53eed,0xbeff3e44,0x3e713e8e,0x3d49beed,0xbee23ed5
.long 0x3e44bf00,0xbeed3eb5,0x3e44bf00,0xbeed3eb5,0x3ec63e44,0xbe15bed5,0x3ea2beed,0xbef53e8e
.long 0xbed53eb5,0x3efbbe44,0x3ed5beb5,0xbefb3e44,0xbe15beed,0x3d493efb,0x3ef5be44,0xbeff3dc8
.long 0xa4d43f00,0x259fbf00,0xa7313f00,0x279fbf00,0x3d493f00,0xbe15befb,0x3eff2796,0xbef53dc8
.long 0x3dc83f00,0xbe8ebeed,0xbdc8bf00,0x3e8e3eed,0x3e153f00,0xbec6bed5,0xbef5a731,0x3ea2be8e
.long 0x3e443f00,0xbeedbeb5,0x3e443f00,0xbeedbeb5,0x3e713f00,0xbeffbe8e,0x3ee22654,0xbd493ed5
.long 0x3e8e3f00,0xbefbbe44,0xbe8ebf00,0x3efb3e44,0x3ea23f00,0xbee2bdc8,0xbec6268d,0xbe71befb
.long 0x3eb53f00,0xbeb5a577,0x3eb53f00,0xbeb52654,0x3ec63f00,0xbe713dc8,0x3ea2279f,0x3ee23efb
.long 0x3ed53f00,0xbdc83e44,0xbed5bf00,0x3dc8be44,0x3ee23f00,0x3d493e8e,0xbe71a742,0xbeffbed5
.long 0x3eed3f00,0x3e443eb5,0x3eed3f00,0x3e443eb5,0x3ef53f00,0x3ea23ed5,0x3e15268d,0x3ec63e8e
.long 0x3efb3f00,0x3ed53eed,0xbefbbf00,0xbed5beed,0x3eff3f00,0x3ef53efb,0xbd492654,0xbe15bdc8
.long 0xa6c23f00,0xa58dbf00,0x26543f00,0x26b0bf00,0x3e713eed,0xbea2bed5,0x3ee2be44,0xbec63e8e
.long 0x3ed53eb5,0xbefbbe44,0xbed5beb5,0x3efb3e44,0x3eff3e44,0xbee23dc8,0xbd493eed,0xbe71befb
.long 0x3eeda60d,0xbe443eb5,0x3eeda731,0xbe443eb5,0x3ea2be44,0x3e153efb,0xbec6beed,0x3ef53dc8
.long 0x3dc8beb5,0x3ed53eed,0xbdc83eb5,0xbed5beed,0xbe15beed,0x3eff3e8e,0x3ef53e44,0x3d493ed5
.long 0xbeb5bf00,0x3eb5a58d,0xbeb5bf00,0x3eb526d4,0xbef5beed,0x3d49be8e,0xbe153e44,0xbeffbed5
.long 0xbefbbeb5,0xbe8ebeed,0x3efb3eb5,0x3e8e3eed,0xbec6be44,0xbef5befb,0xbea2beed,0x3e15bdc8
.long 0xbe44a6c2,0xbeedbeb5,0xbe44a765,0xbeedbeb5,0x3d493e44,0xbe71bdc8,0x3eff3eed,0x3ee23efb
.long 0x3e8e3eb5,0x3dc83e44,0xbe8ebeb5,0xbdc8be44,0x3ee23eed,0x3ec63ed5,0xbe71be44,0xbea2be8e
.long 0xa6f73f00,0x250dbf00,0xa7653f00,0x27b9bf00,0x3ec63eb5,0xbee2be8e,0x3ea2beb5,0xbe713ed5
.long 0x3efba50e,0xbed53e44,0xbefba765,0x3ed5be44,0x3e71beb5,0x3d493efb,0x3ee23eb5,0xbeffbdc8
.long 0xbe44bf00,0x3eed3eb5,0xbe44bf00,0x3eed3eb5,0xbef5beb5,0x3ec6bdc8,0xbe153eb5,0xbea2befb
.long 0xbed5a6f7,0xbdc8beed,0x3ed527b9,0x3dc83eed,0xbd493eb5,0xbef5bed5,0xbeffbeb5,0x3e15be8e
.long 0x3eb53f00,0xbeb5a70d,0x3eb53f00,0xbeb5a784,0x3eff3eb5,0x3e153ed5,0xbd49beb5,0x3ef53e8e
.long 0x3e8ea0b7,0x3efb3eed,0xbe8ea800,0xbefbbeed,0xbe15beb5,0x3ea23dc8,0x3ef53eb5,0x3ec63efb
.long 0xbeedbf00,0xbe44beb5,0xbeedbf00,0xbe44beb5,0xbee2beb5,0xbeffbefb,0x3e713eb5,0xbd493dc8
.long 0xbdc8a704,0xbe8ebe44,0x3dc82823,0x3e8e3e44,0x3ea23eb5,0x3e713e8e,0xbec6beb5,0xbee2bed5
.long 0xa7163f00,0x260dbf00,0xa8003f00,0x2823bf00,0x3ef53e44,0xbeffbdc8,0x3e15beed,0xbd493efb
.long 0x3e8ebeb5,0xbdc83eed,0xbe8e3eb5,0x3dc8beed,0xbea2beed,0x3ef53e8e,0x3ec6be44,0xbe153ed5
.long 0xbeed26d4,0x3e44beb5,0xbeed283e,0x3e44beb5,0x3d493eed,0xbee2bed5,0x3eff3e44,0xbe713e8e
.long 0x3efb3eb5,0xbe8e3e44,0xbefbbeb5,0x3e8ebe44,0x3e71be44,0x3ec63efb,0x3ee23eed,0xbea23dc8
.long 0xbeb5bf00,0x3eb52796,0xbeb5bf00,0x3eb5a6b1,0xbee2be44,0xbea2befb,0x3e713eed,0xbec6bdc8
.long 0x3dc83eb5,0xbed5be44,0xbdc8beb5,0x3ed53e44,0x3eff3eed,0x3e713ed5,0xbd493e44,0xbee2be8e
.long 0x3e442809,0x3eed3eb5,0x3e44286a,0x3eed3eb5,0xbec6beed,0xbe15be8e,0xbea2be44,0xbef5bed5
.long 0xbed5beb5,0xbefbbeed,0x3ed53eb5,0x3efb3eed,0x3e153e44,0x3d493dc8,0xbef5beed,0xbeffbefb
.long 0x3f008000,0xbf00a554,0x3f0026d4,0xbf00a777,0x3eff8000,0xbef53dc8,0xbd49bf00,0x3e153efb
.long 0x3efb8000,0xbed53e44,0xbefb258e,0x3ed5be44,0x3ef58000,0xbea23e8e,0x3e153f00,0xbec6bed5
.long 0x3eed8000,0xbe443eb5,0x3eeda70d,0xbe443eb5,0x3ee28000,0xbd493ed5,0xbe71bf00,0x3eff3e8e
.long 0x3ed58000,0x3dc83eed,0xbed5a777,0xbdc8beed,0x3ec68000,0x3e713efb,0x3ea23f00,0xbee2bdc8
.long 0x3eb58000,0x3eb53f00,0x3eb526f7,0x3eb53f00,0x3ea28000,0x3ee23efb,0xbec6bf00,0x3e71bdc8
.long 0x3e8e8000,0x3efb3eed,0xbe8e2137,0xbefbbeed,0x3e718000,0x3eff3ed5,0x3ee23f00,0x3d493e8e
.long 0x3e448000,0x3eed3eb5,0x3e4427c2,0x3eed3eb5,0x3e158000,0x3ec63e8e,0xbef5bf00,0xbea2bed5
.long 0x3dc88000,0x3e8e3e44,0xbdc8a784,0xbe8ebe44,0x3d498000,0x3e153dc8,0x3eff3f00,0x3ef53efb
.long 0x3f0025d4,0xbf00a61f,0x3f0027c2,0xbf00a58d,0x3ee2be44,0xbec63e8e,0xbe71beed,0x3ea23ed5
.long 0x3e8ebeb5,0xbdc83eed,0xbe8e3eb5,0x3dc8beed,0x3d49beed,0x3e713efb,0x3eff3e44,0xbee23dc8
.long 0xbe44bf00,0x3eed3eb5,0xbe44bf00,0x3eed3eb5,0xbec6beed,0x3ef53dc8,0xbea23e44,0xbe15befb
.long 0xbefbbeb5,0x3e8ebe44,0x3efb3eb5,0xbe8e3e44,0xbef5be44,0xbd49bed5,0xbe15beed,0x3eff3e8e
.long 0xbeb5a5f7,0xbeb5bf00,0xbeb5a78d,0xbeb5bf00,0xbe153e44,0xbeffbed5,0x3ef53eed,0xbd493e8e
.long 0x3dc83eb5,0xbed5be44,0xbdc8beb5,0x3ed53e44,0x3ea23eed,0xbe153dc8,0xbec6be44,0xbef5befb
.long 0x3eed3f00,0x3e443eb5,0x3eed3f00,0x3e443eb5,0x3eff3eed,0x3ee23efb,0xbd49be44,0x3e713dc8
.long 0x3ed53eb5,0x3efb3eed,0xbed5beb5,0xbefbbeed,0x3e713e44,0x3ea23e8e,0x3ee23eed,0x3ec63ed5
.long 0x3f002654,0xbf00a742,0x3f00271f,0xbf00a796,0x3ea2beb5,0xbe713ed5,0xbec6beb5,0x3ee23e8e
.long 0xbdc8bf00,0x3e8e3eed,0x3dc83f00,0xbe8ebeed,0xbee2beb5,0x3eff3dc8,0x3e71beb5,0x3d493efb
.long 0xbeed268d,0x3e44beb5,0xbeed2754,0x3e44beb5,0xbe153eb5,0xbea2befb,0x3ef53eb5,0xbec63dc8
.long 0x3e8e3f00,0xbefbbe44,0xbe8ebf00,0x3efb3e44,0x3eff3eb5,0xbe153e8e,0xbd493eb5,0xbef5bed5
.long 0x3eb52677,0x3eb53f00,0x3eb5a68d,0x3eb53f00,0xbd49beb5,0x3ef53e8e,0xbeffbeb5,0xbe15bed5
.long 0xbed5bf00,0x3dc8be44,0x3ed53f00,0xbdc83e44,0xbef5beb5,0xbec6befb,0xbe15beb5,0x3ea23dc8
.long 0xbe44a742,0xbeedbeb5,0xbe44a889,0xbeedbeb5,0x3e713eb5,0xbd493dc8,0x3ee23eb5,0x3eff3efb
.long 0x3efb3f00,0x3ed53eed,0xbefbbf00,0xbed5beed,0x3ec63eb5,0x3ee23ed5,0x3ea23eb5,0x3e713e8e
.long 0x3f00269f,0xbf00260d,0x3f00a68d,0xbf00a68d,0x3e15beed,0xbd493efb,0xbef5be44,0x3eff3dc8
.long 0xbed5beb5,0x3efb3e44,0x3ed53eb5,0xbefbbe44,0xbec63e44,0x3e15bed5,0xbea2beed,0x3ef53e8e
.long 0x3e443f00,0xbeedbeb5,0x3e443f00,0xbeedbeb5,0x3eff3e44,0xbe713e8e,0xbd49beed,0x3ee23ed5
.long 0x3dc8beb5,0x3ed53eed,0xbdc83eb5,0xbed5beed,0xbee2beed,0x3ea2bdc8,0x3e71be44,0x3ec63efb
.long 0xbeb5260d,0xbeb5bf00,0xbeb5a816,0xbeb5bf00,0x3e713eed,0xbec6bdc8,0x3ee23e44,0x3ea23efb
.long 0x3efb3eb5,0x3e8e3eed,0xbefbbeb5,0xbe8ebeed,0x3d49be44,0x3ee23e8e,0x3eff3eed,0x3e713ed5
.long 0xbeedbf00,0xbe44beb5,0xbeedbf00,0xbe44beb5,0xbea2be44,0xbef5bed5,0x3ec63eed,0x3e153e8e
.long 0x3e8e3eb5,0x3dc83e44,0xbe8ebeb5,0xbdc8be44,0x3ef53eed,0x3eff3efb,0x3e153e44,0x3d493dc8
.long 0x27663f00,0xa6b1bf00,0x26f73f00,0x258cbf00,0xbd49bf00,0x3e153efb,0xbeffa861,0x3ef5bdc8
.long 0x3dc83f00,0xbe8ebeed,0xbdc8bf00,0x3e8e3eed,0xbe15bf00,0x3ec63ed5,0x3ef52882,0xbea23e8e
.long 0x3e443f00,0xbeedbeb5,0x3e443f00,0xbeedbeb5,0xbe71bf00,0x3eff3e8e,0xbee2a71f,0x3d49bed5
.long 0x3e8e3f00,0xbefbbe44,0xbe8ebf00,0x3efb3e44,0xbea2bf00,0x3ee23dc8,0x3ec6a835,0x3e713efb
.long 0x3eb53f00,0xbeb5a812,0x3eb53f00,0xbeb5a898,0xbec6bf00,0x3e71bdc8,0xbea2a7dd,0xbee2befb
.long 0x3ed53f00,0xbdc83e44,0xbed5bf00,0x3dc8be44,0xbee2bf00,0xbd49be8e,0x3e71a7dd,0x3eff3ed5
.long 0x3eed3f00,0x3e443eb5,0x3eed3f00,0x3e443eb5,0xbef5bf00,0xbea2bed5,0xbe15a835,0xbec6be8e
.long 0x3efb3f00,0x3ed53eed,0xbefbbf00,0xbed5beed,0xbeffbf00,0xbef5befb,0x3d49a71f,0x3e153dc8
.long 0xa6543f00,0x2742bf00,0xa71f3f00,0x28a6bf00,0xbe71beed,0x3ea23ed5,0xbee23e44,0x3ec6be8e
.long 0x3ed53eb5,0xbefbbe44,0xbed5beb5,0x3efb3e44,0xbeffbe44,0x3ee2bdc8,0x3d49beed,0x3e713efb
.long 0x3eed2742,0xbe443eb5,0x3eed2653,0xbe443eb5,0xbea23e44,0xbe15befb,0x3ec63eed,0xbef5bdc8
.long 0x3dc8beb5,0x3ed53eed,0xbdc83eb5,0xbed5beed,0x3e153eed,0xbeffbe8e,0xbef5be44,0xbd49bed5
.long 0xbeb5bf00,0x3eb52765,0xbeb5bf00,0x3eb5a71f,0x3ef53eed,0xbd493e8e,0x3e15be44,0x3eff3ed5
.long 0xbefbbeb5,0xbe8ebeed,0x3efb3eb5,0x3e8e3eed,0x3ec63e44,0x3ef53efb,0x3ea23eed,0xbe153dc8
.long 0xbe44a81a,0xbeedbeb5,0xbe44a87c,0xbeedbeb5,0xbd49be44,0x3e713dc8,0xbeffbeed,0xbee2befb
.long 0x3e8e3eb5,0x3dc83e44,0xbe8ebeb5,0xbdc8be44,0xbee2beed,0xbec6bed5,0x3e713e44,0x3ea23e8e
.long 0xa7a83f00,0x27eebf00,0xa7dd3f00,0xa7ddbf00,0xbec6beb5,0x3ee23e8e,0xbea23eb5,0x3e71bed5
.long 0x3efba796,0xbed53e44,0xbefb284f,0x3ed5be44,0xbe713eb5,0xbd49befb,0xbee2beb5,0x3eff3dc8
.long 0xbe44bf00,0x3eed3eb5,0xbe44bf00,0x3eed3eb5,0x3ef53eb5,0xbec63dc8,0x3e15beb5,0x3ea23efb
.long 0xbed5a81a,0xbdc8beed,0x3ed528ec,0x3dc83eed,0x3d49beb5,0x3ef53ed5,0x3eff3eb5,0xbe153e8e
.long 0x3eb53f00,0xbeb526f7,0x3eb53f00,0xbeb5a800,0xbeffbeb5,0xbe15bed5,0x3d493eb5,0xbef5be8e
.long 0x3e8ea800,0x3efb3eed,0xbe8ea800,0xbefbbeed,0x3e153eb5,0xbea2bdc8,0xbef5beb5,0xbec6befb
.long 0xbeedbf00,0xbe44beb5,0xbeedbf00,0xbe44beb5,0x3ee23eb5,0x3eff3efb,0xbe71beb5,0x3d49bdc8
.long 0xbdc8a7cb,0xbe8ebe44,0x3dc82894,0x3e8e3e44,0xbea2beb5,0xbe71be8e,0x3ec63eb5,0x3ee23ed5
.long 0xa81a3f00,0x283ebf00,0xa8353f00,0xa71fbf00,0xbef5be44,0x3eff3dc8,0xbe153eed,0x3d49befb
.long 0x3e8ebeb5,0xbdc83eed,0xbe8e3eb5,0x3dc8beed,0x3ea23eed,0xbef5be8e,0xbec63e44,0x3e15bed5
.long 0xbeed2861,0x3e44beb5,0xbeed2882,0x3e44beb5,0xbd49beed,0x3ee23ed5,0xbeffbe44,0x3e71be8e
.long 0x3efb3eb5,0xbe8e3e44,0xbefbbeb5,0x3e8ebe44,0xbe713e44,0xbec6befb,0xbee2beed,0x3ea2bdc8
.long 0xbeb5bf00,0x3eb52809,0xbeb5bf00,0x3eb52894,0x3ee23e44,0x3ea23efb,0xbe71beed,0x3ec63dc8
.long 0x3dc83eb5,0xbed5be44,0xbdc8beb5,0x3ed53e44,0xbeffbeed,0xbe71bed5,0x3d49be44,0x3ee23e8e
.long 0x3e4428a6,0x3eed3eb5,0x3e44282c,0x3eed3eb5,0x3ec63eed,0x3e153e8e,0x3ea23e44,0x3ef53ed5
.long 0xbed5beb5,0xbefbbeed,0x3ed53eb5,0x3efb3eed,0xbe15be44,0xbd49bdc8,0x3ef53eed,0x3eff3efb
.long 0x3f002754,0xbf00a7b1,0x3f00279f,0xbf00a7e5,0xbeffa816,0x3ef5bdc8,0x3d493f00,0xbe15befb
.long 0x3efba60e,0xbed53e44,0xbefba7e5,0x3ed5be44,0xbef5a7b1,0x3ea2be8e,0xbe15bf00,0x3ec63ed5
.long 0x3eeda78d,0xbe443eb5,0x3eeda7d4,0xbe443eb5,0xbee2a6d4,0x3d49bed5,0x3e713f00,0xbeffbe8e
.long 0x3ed527f7,0x3dc83eed,0xbed5a839,0xbdc8beed,0xbec6270d,0xbe71befb,0xbea2bf00,0x3ee23dc8
.long 0x3eb52777,0x3eb53f00,0x3eb5a70d,0x3eb53f00,0xbea2a81f,0xbee2befb,0x3ec63f00,0xbe713dc8
.long 0x3e8ea1b7,0x3efb3eed,0xbe8ea880,0xbefbbeed,0xbe71a7c2,0xbeffbed5,0xbee2bf00,0xbd49be8e
.long 0x3e442842,0x3eed3eb5,0x3e442909,0x3eed3eb5,0xbe15a70d,0xbec6be8e,0x3ef53f00,0x3ea23ed5
.long 0x3dc82804,0x3e8e3e44,0xbdc8a8a3,0xbe8ebe44,0xbd4926d4,0xbe15bdc8,0xbeffbf00,0xbef5befb
.long 0x3f0027f7,0xbf00a81f,0x3f002816,0xbf00a839,0xbee23e44,0x3ec6be8e,0x3e713eed,0xbea2bed5
.long 0x3e8ebeb5,0xbdc83eed,0xbe8e3eb5,0x3dc8beed,0xbd493eed,0xbe71befb,0xbeffbe44,0x3ee2bdc8
.long 0xbe44bf00,0x3eed3eb5,0xbe44bf00,0x3eed3eb5,0x3ec63eed,0xbef5bdc8,0x3ea2be44,0x3e153efb
.long 0xbefbbeb5,0x3e8ebe44,0x3efb3eb5,0xbe8e3e44,0x3ef53e44,0x3d493ed5,0x3e153eed,0xbeffbe8e
.long 0xbeb526d4,0xbeb5bf00,0xbeb5a804,0xbeb5bf00,0x3e15be44,0x3eff3ed5,0xbef5beed,0x3d49be8e
.long 0x3dc83eb5,0xbed5be44,0xbdc8beb5,0x3ed53e44,0xbea2beed,0x3e15bdc8,0x3ec63e44,0x3ef53efb
.long 0x3eed3f00,0x3e443eb5,0x3eed3f00,0x3e443eb5,0xbeffbeed,0xbee2befb,0x3d493e44,0xbe71bdc8
.long 0x3ed53eb5,0x3efb3eed,0xbed5beb5,0xbefbbeed,0xbe71be44,0xbea2be8e,0xbee2beed,0xbec6bed5
.long 0x3f002842,0xbf0026d4,0x3f00a70d,0xbf00a880,0xbea23eb5,0x3e71bed5,0x3ec63eb5,0xbee2be8e
.long 0xbdc8bf00,0x3e8e3eed,0x3dc83f00,0xbe8ebeed,0x3ee23eb5,0xbeffbdc8,0xbe713eb5,0xbd49befb
.long 0xbeed27b1,0x3e44beb5,0xbeed28be,0x3e44beb5,0x3e15beb5,0x3ea23efb,0xbef5beb5,0x3ec6bdc8
.long 0x3e8e3f00,0xbefbbe44,0xbe8ebf00,0x3efb3e44,0xbeffbeb5,0x3e15be8e,0x3d49beb5,0x3ef53ed5
.long 0x3eb5280d,0x3eb53f00,0x3eb52896,0x3eb53f00,0x3d493eb5,0xbef5be8e,0x3eff3eb5,0x3e153ed5
.long 0xbed5bf00,0x3dc8be44,0x3ed53f00,0xbdc83e44,0x3ef53eb5,0x3ec63efb,0x3e153eb5,0xbea2bdc8
.long 0xbe44a7e5,0xbeedbeb5,0xbe44a8ea,0xbeedbeb5,0xbe71beb5,0x3d49bdc8,0xbee2beb5,0xbeffbefb
.long 0x3efb3f00,0x3ed53eed,0xbefbbf00,0xbed5beed,0xbec6beb5,0xbee2bed5,0xbea2beb5,0xbe71be8e
.long 0x3f00260d,0xbf00a730,0x3f00270d,0xbf00a8a3,0xbe153eed,0x3d49befb,0x3ef53e44,0xbeffbdc8
.long 0xbed5beb5,0x3efb3e44,0x3ed53eb5,0xbefbbe44,0x3ec6be44,0xbe153ed5,0x3ea23eed,0xbef5be8e
.long 0x3e443f00,0xbeedbeb5,0x3e443f00,0xbeedbeb5,0xbeffbe44,0x3e71be8e,0x3d493eed,0xbee2bed5
.long 0x3dc8beb5,0x3ed53eed,0xbdc83eb5,0xbed5beed,0x3ee23eed,0xbea23dc8,0xbe713e44,0xbec6befb
.long 0xbeb5a754,0xbeb5bf00,0xbeb52731,0xbeb5bf00,0xbe71beed,0x3ec63dc8,0xbee2be44,0xbea2befb
.long 0x3efb3eb5,0x3e8e3eed,0xbefbbeb5,0xbe8ebeed,0xbd493e44,0xbee2be8e,0xbeffbeed,0xbe71bed5
.long 0xbeedbf00,0xbe44beb5,0xbeedbf00,0xbe44beb5,0x3ea23e44,0x3ef53ed5,0xbec6beed,0xbe15be8e
.long 0x3e8e3eb5,0x3dc83e44,0xbe8ebeb5,0xbdc8be44,0xbef5beed,0xbeffbefb,0xbe15be44,0xbd49bdc8
.long 0x3f800000,0x3f800000,0x3f800000,0x3f800000,0x3f800000,0x3f800000,0x3f800000,0x3f800000
.long 0x3f800000,0x3f800000,0x3f800000,0x3f800000,0x3f800000,0x3f800000,0x3f800000,0x3f800000
.long 0x0,0x0,0x0,0x0,0x0,0x0,0x0,0x0
.long 0x0,0x0,0x0,0x0,0x0,0x0,0x0,0x0
.long 0x3f800000,0x3f7fffb1,0x3f7ffec4,0x3f7ffd39,0x3f7ffb11,0x3f7ff84a,0x3f7ff4e6,0x3f7ff0e3
.long 0x3f7fec43,0x3f7fe705,0x3f7fe129,0x3f7fdaaf,0x3f7fd397,0x3f7fcbe2,0x3f7fc38f,0x3f7fba9e
.long 0x0,0x3b490fc6,0x3bc90f88,0x3c16cb58,0x3c490e90,0x3c7b514b,0x3c96c9b6,0x3cafea69
.long 0x3cc90ab0,0x3ce22a7a,0x3cfb49ba,0x3d0a342f,0x3d16c32c,0x3d2351cb,0x3d2fe007,0x3d3c6dd5
.long 0x3f800000,0x3f7ffec4,0x3f7ffb11,0x3f7ff4e6,0x3f7fec43,0x3f7fe129,0x3f7fd397,0x3f7fc38f
.long 0x3f7fb10f,0x3f7f9c18,0x3f7f84ab,0x3f7f6ac7,0x3f7f4e6d,0x3f7f2f9d,0x3f7f0e58,0x3f7eea9d
.long 0x0,0x3bc90f88,0x3c490e90,0x3c96c9b6,0x3cc90ab0,0x3cfb49ba,0x3d16c32c,0x3d2fe007
.long 0x3d48fb30,0x3d621469,0x3d7b2b74,0x3d8a200a,0x3d96a905,0x3da3308c,0x3dafb680,0x3dbc3ac3
.long 0x3f800000,0x3f7ffd39,0x3f7ff4e6,0x3f7fe705,0x3f7fd397,0x3f7fba9e,0x3f7f9c18,0x3f7f7808
.long 0x3f7f4e6d,0x3f7f1f49,0x3f7eea9d,0x3f7eb069,0x3f7e70b0,0x3f7e2b72,0x3f7de0b1,0x3f7d906e
.long 0x0,0x3c16cb58,0x3c96c9b6,0x3ce22a7a,0x3d16c32c,0x3d3c6dd5,0x3d621469,0x3d83db0a
.long 0x3d96a905,0x3da973ba,0x3dbc3ac3,0x3dcefdb7,0x3de1bc2e,0x3df475c0,0x3e039502,0x3e0cec4a
.long 0x3f800000,0x3f7ffb11,0x3f7fec43,0x3f7fd397,0x3f7fb10f,0x3f7f84ab,0x3f7f4e6d,0x3f7f0e58
.long 0x3f7ec46d,0x3f7e70b0,0x3f7e1324,0x3f7dabcc,0x3f7d3aac,0x3f7cbfc9,0x3f7c3b28,0x3f7baccd
.long 0x0,0x3c490e90,0x3cc90ab0,0x3d16c32c,0x3d48fb30,0x3d7b2b74,0x3d96a905,0x3dafb680
.long 0x3dc8bd36,0x3de1bc2e,0x3dfab273,0x3e09cf86,0x3e164083,0x3e22abb6,0x3e2f10a2,0x3e3b6ecf
.long 0x3f800000,0x3f7ff84a,0x3f7fe129,0x3f7fba9e,0x3f7f84ab,0x3f7f3f54,0x3f7eea9d,0x3f7e868b
.long 0x3f7e1324,0x3f7d906e,0x3f7cfe73,0x3f7c5d3a,0x3f7baccd,0x3f7aed37,0x3f7a1e84,0x3f7940c0
.long 0x0,0x3c7b514b,0x3cfb49ba,0x3d3c6dd5,0x3d7b2b74,0x3d9cecf9,0x3dbc3ac3,0x3ddb7d37
.long 0x3dfab273,0x3e0cec4a,0x3e1c76de,0x3e2bf804,0x3e3b6ecf,0x3e4ada4f,0x3e5a3997,0x3e698bba
.long 0x3f800000,0x3f7ff4e6,0x3f7fd397,0x3f7f9c18,0x3f7f4e6d,0x3f7eea9d,0x3f7e70b0,0x3f7de0b1
.long 0x3f7d3aac,0x3f7c7eb0,0x3f7baccd,0x3f7ac516,0x3f79c79d,0x3f78b47b,0x3f778bc5,0x3f764d97
.long 0x0,0x3c96c9b6,0x3d16c32c,0x3d621469,0x3d96a905,0x3dbc3ac3,0x3de1bc2e,0x3e039502
.long 0x3e164083,0x3e28defc,0x3e3b6ecf,0x3e4dee60,0x3e605c13,0x3e72b651,0x3e827dc0,0x3e8b9507
.long 0x3f800000,0x3f7ff0e3,0x3f7fc38f,0x3f7f7808,0x3f7f0e58,0x3f7e868b,0x3f7de0b1,0x3f7d1cdd
.long 0x3f7c3b28,0x3f7b3bab,0x3f7a1e84,0x3f78e3d6,0x3f778bc5,0x3f76167a,0x3f748422,0x3f72d4eb
.long 0x0,0x3cafea69,0x3d2fe007,0x3d83db0a,0x3dafb680,0x3ddb7d37,0x3e039502,0x3e195be0
.long 0x3e2f10a2,0x3e44b0b9,0x3e5a3997,0x3e6fa8b2,0x3e827dc0,0x3e8d17c0,0x3e97a117,0x3ea21887
.long 0x3f800000,0x3f7fec43,0x3f7fb10f,0x3f7f4e6d,0x3f7ec46d,0x3f7e1324,0x3f7d3aac,0x3f7c3b28
.long 0x3f7b14be,0x3f79c79d,0x3f7853f8,0x3f76ba07,0x3f74fa0b,0x3f731447,0x3f710908,0x3f6ed89e
.long 0x0,0x3cc90ab0,0x3d48fb30,0x3d96a905,0x3dc8bd36,0x3dfab273,0x3e164083,0x3e2f10a2
.long 0x3e47c5c2,0x3e605c13,0x3e78cfcc,0x3e888e93,0x3e94a031,0x3ea09ae5,0x3eac7cd4,0x3eb8442a
.long 0x3f800000,0x3f7fe705,0x3f7f9c18,0x3f7f1f49,0x3f7e70b0,0x3f7d906e,0x3f7c7eb0,0x3f7b3bab
.long 0x3f79c79d,0x3f7822d1,0x3f764d97,0x3f74484b,0x3f721352,0x3f6faf1b,0x3f6d1c1d,0x3f6a5ad9
.long 0x0,0x3ce22a7a,0x3d621469,0x3da973ba,0x3de1bc2e,0x3e0cec4a,0x3e28defc,0x3e44b0b9
.long 0x3e605c13,0x3e7bdba4,0x3e8b9507,0x3e9920fe,0x3ea68f12,0x3eb3dca5,0x3ec1071e,0x3ece0bea
.long 0x3f800000,0x3f7fe129,0x3f7f84ab,0x3f7eea9d,0x3f7e1324,0x3f7cfe73,0x3f7baccd,0x3f7a1e84
.long 0x3f7853f8,0x3f764d97,0x3f740bdd,0x3f718f57,0x3f6ed89e,0x3f6be858,0x3f68bf3c,0x3f655e0b
.long 0x0,0x3cfb49ba,0x3d7b2b74,0x3dbc3ac3,0x3dfab273,0x3e1c76de,0x3e3b6ecf,0x3e5a3997
.long 0x3e78cfcc,0x3e8b9507,0x3e9aa086,0x3ea986c4,0x3eb8442a,0x3ec6d529,0x3ed53641,0x3ee363fa
.long 0x3f800000,0x3f7fdaaf,0x3f7f6ac7,0x3f7eb069,0x3f7dabcc,0x3f7c5d3a,0x3f7ac516,0x3f78e3d6
.long 0x3f76ba07,0x3f74484b,0x3f718f57,0x3f6e8ff8,0x3f6b4b0c,0x3f67c187,0x3f63f473,0x3f5fe4e9
.long 0x0,0x3d0a342f,0x3d8a200a,0x3dcefdb7,0x3e09cf86,0x3e2bf804,0x3e4dee60,0x3e6fa8b2
.long 0x3e888e93,0x3e9920fe,0x3ea986c4,0x3eb9bb1e,0x3ec9b953,0x3ed97cb9,0x3ee900b7,0x3ef840c8
.long 0x3f800000,0x3f7fd397,0x3f7f4e6d,0x3f7e70b0,0x3f7d3aac,0x3f7baccd,0x3f79c79d,0x3f778bc5
.long 0x3f74fa0b,0x3f721352,0x3f6ed89e,0x3f6b4b0c,0x3f676bd8,0x3f633c5a,0x3f5ebe05,0x3f59f26a
.long 0x0,0x3d16c32c,0x3d96a905,0x3de1bc2e,0x3e164083,0x3e3b6ecf,0x3e605c13,0x3e827dc0
.long 0x3e94a031,0x3ea68f12,0x3eb8442a,0x3ec9b953,0x3edae880,0x3eebcbbb,0x3efc5d27,0x3f064b82
.long 0x3f800000,0x3f7fcbe2,0x3f7f2f9d,0x3f7e2b72,0x3f7cbfc9,0x3f7aed37,0x3f78b47b,0x3f76167a
.long 0x3f731447,0x3f6faf1b,0x3f6be858,0x3f67c187,0x3f633c5a,0x3f5e5aa6,0x3f591e6a,0x3f5389c7
.long 0x0,0x3d2351cb,0x3da3308c,0x3df475c0,0x3e22abb6,0x3e4ada4f,0x3e72b651,0x3e8d17c0
.long 0x3ea09ae5,0x3eb3dca5,0x3ec6d529,0x3ed97cb9,0x3eebcbbb,0x3efdbabb,0x3f07a136,0x3f102dd5
.long 0x3f800000,0x3f7fc38f,0x3f7f0e58,0x3f7de0b1,0x3f7c3b28,0x3f7a1e84,0x3f778bc5,0x3f748422
.long 0x3f710908,0x3f6d1c1d,0x3f68bf3c,0x3f63f473,0x3f5ebe05,0x3f591e6a,0x3f531849,0x3f4cae79
.long 0x0,0x3d2fe007,0x3dafb680,0x3e039502,0x3e2f10a2,0x3e5a3997,0x3e827dc0,0x3e97a117
.long 0x3eac7cd4,0x3ec1071e,0x3ed53641,0x3ee900b7,0x3efc5d27,0x3f07a136,0x3f10d3cd,0x3f19c200
.long 0x3f800000,0x3f7fba9e,0x3f7eea9d,0x3f7d906e,0x3f7baccd,0x3f7940c0,0x3f764d97,0x3f72d4eb
.long 0x3f6ed89e,0x3f6a5ad9,0x3f655e0b,0x3f5fe4e9,0x3f59f26a,0x3f5389c7,0x3f4cae79,0x3f456439
.long 0x0,0x3d3c6dd5,0x3dbc3ac3,0x3e0cec4a,0x3e3b6ecf,0x3e698bba,0x3e8b9507,0x3ea21887
.long 0x3eb8442a,0x3ece0bea,0x3ee363fa,0x3ef840c8,0x3f064b82,0x3f102dd5,0x3f19c200,0x3f2302d3
.long 0x3f800000,0x3f7fb10f,0x3f7ec46d,0x3f7d3aac,0x3f7b14be,0x3f7853f8,0x3f74fa0b,0x3f710908
.long 0x3f6c835e,0x3f676bd8,0x3f61c598,0x3f5b941a,0x3f54db31,0x3f4d9f02,0x3f45e403,0x3f3daef9
.long 0x0,0x3d48fb30,0x3dc8bd36,0x3e164083,0x3e47c5c2,0x3e78cfcc,0x3e94a031,0x3eac7cd4
.long 0x3ec3ef15,0x3edae880,0x3ef15aea,0x3f039c3d,0x3f0e39da,0x3f187fc0,0x3f226799,0x3f2beb4a
.long 0x3f800000,0x3f7fa6e3,0x3f7e9bc9,0x3f7cdf6c,0x3f7a7302,0x3f77583a,0x3f73913f,0x3f6f20b0
.long 0x3f6a09a7,0x3f644fac,0x3f5df6be,0x3f570348,0x3f4f7a1f,0x3f476085,0x3f3ebc1b,0x3f3592e7
.long 0x0,0x3d55880e,0x3dd53db9,0x3e1f917b,0x3e541501,0x3e840270,0x3e9d9e78,0x3eb6ccc3
.long 0x3ecf7bca,0x3ee79a5d,0x3eff17b2,0x3f0af1b7,0x3f15f6d9,0x3f209393,0x3f2ac082,0x3f34768f
.long 0x3f800000,0x3f7f9c18,0x3f7e70b0,0x3f7c7eb0,0x3f79c79d,0x3f764d97,0x3f721352,0x3f6d1c1d
.long 0x3f676bd8,0x3f6106f2,0x3f59f26a,0x3f5233c6,0x3f49d112,0x3f40d0da,0x3f373a23,0x3f2d1469
.long 0x0,0x3d621469,0x3de1bc2e,0x3e28defc,0x3e605c13,0x3e8b9507,0x3ea68f12,0x3ec1071e
.long 0x3edae880,0x3ef41f07,0x3f064b82,0x3f121eb0,0x3f1d7fd1,0x3f286605,0x3f32c8c9,0x3f3ca003
.long 0x3f800000,0x3f7f90b1,0x3f7e4323,0x3f7c187a,0x3f791298,0x3f75341d,0x3f708066,0x3f6afb8c
.long 0x3f64aa59,0x3f5d924d,0x3f55b993,0x3f4d26fd,0x3f43e200,0x3f39f2ac,0x3f2f61a5,0x3f24381a
.long 0x0,0x3d6ea038,0x3dee3876,0x3e3228d4,0x3e6c9a7f,0x3e931f35,0x3eaf713a,0x3ecb2aae
.long 0x3ee63375,0x3f003a06,0x3f0cead0,0x3f19210f,0x3f24d225,0x3f2ff3e6,0x3f3a7ca4,0x3f446337
.long 0x3f800000,0x3f7f84ab,0x3f7e1324,0x3f7baccd,0x3f7853f8,0x3f740bdd,0x3f6ed89e,0x3f68bf3c
.long 0x3f61c598,0x3f59f26a,0x3f514d3d,0x3f47de65,0x3f3daef9,0x3f32c8c9,0x3f273656,0x3f1b02c6
.long 0x0,0x3d7b2b74,0x3dfab273,0x3e3b6ecf,0x3e78cfcc,0x3e9aa086,0x3eb8442a,0x3ed53641
.long 0x3ef15aea,0x3f064b82,0x3f13682a,0x3f1ff6cb,0x3f2beb4a,0x3f373a23,0x3f41d870,0x3f4bbbf8
.long 0x3f800000,0x3f7f7808,0x3f7de0b1,0x3f7b3bab,0x3f778bc5,0x3f72d4eb,0x3f6d1c1d,0x3f666771
.long 0x3f5ebe05,0x3f5627fe,0x3f4cae79,0x3f425b89,0x3f373a23,0x3f2b561b,0x3f1ebc12,0x3f11796b
.long 0x0,0x3d83db0a,0x3e039502,0x3e44b0b9,0x3e827dc0,0x3ea21887,0x3ec1071e,0x3edf28a9
.long 0x3efc5d27,0x3f0c42c9,0x3f19c200,0x3f269de3,0x3f32c8c9,0x3f3e35c5,0x3f48d8b3,0x3f52a649
.long 0x3f800000,0x3f7f6ac7,0x3f7dabcc,0x3f7ac516,0x3f76ba07,0x3f718f57,0x3f6b4b0c,0x3f63f473
.long 0x3f5b941a,0x3f5233c6,0x3f47de65,0x3f3ca003,0x3f3085bb,0x3f239da9,0x3f15f6d9,0x3f07a136
.long 0x0,0x3d8a200a,0x3e09cf86,0x3e4dee60,0x3e888e93,0x3ea986c4,0x3ec9b953,0x3ee900b7
.long 0x3f039c3d,0x3f121eb0,0x3f1ff6cb,0x3f2d1469,0x3f396842,0x3f44e3f5,0x3f4f7a1f,0x3f591e6a
.long 0x3f800000,0x3f7f5ce9,0x3f7d7474,0x3f7a4910,0x3f75dec6,0x3f703b37,0x3f696591,0x3f61668a
.long 0x3f584853,0x3f4e1689,0x3f42de29,0x3f36ad7f,0x3f299415,0x3f1ba299,0x3f0cead0,0x3efafef7
.long 0x0,0x3d9064b4,0x3e1008b7,0x3e57278f,0x3e8e9a22,0x3eb0eacb,0x3ed25a09,0x3ef2bd43
.long 0x3f08f59b,0x3f17de12,0x3f26050a,0x3f33587a,0x3f3fc767,0x3f4b41fa,0x3f55b993,0x3f5f20db
.long 0x3f800000,0x3f7f4e6d,0x3f7d3aac,0x3f79c79d,0x3f74fa0b,0x3f6ed89e,0x3f676bd8,0x3f5ebe05
.long 0x3f54db31,0x3f49d112,0x3f3daef9,0x3f3085bb,0x3f226799,0x3f13682a,0x3f039c3d,0x3ee63375
.long 0x0,0x3d96a905,0x3e164083,0x3e605c13,0x3e94a031,0x3eb8442a,0x3edae880,0x3efc5d27
.long 0x3f0e39da,0x3f1d7fd1,0x3f2beb4a,0x3f396842,0x3f45e403,0x3f514d3d,0x3f5b941a,0x3f64aa59
.long 0x3f800000,0x3f7f3f54,0x3f7cfe73,0x3f7940c0,0x3f740bdd,0x3f6d67a1,0x3f655e0b,0x3f5bfb34
.long 0x3f514d3d,0x3f456439,0x3f385216,0x3f2a2a80,0x3f1b02c6,0x3f0af1b7,0x3ef41f07,0x3ed0eb2a
.long 0x0,0x3d9cecf9,0x3e1c76de,0x3e698bba,0x3e9aa086,0x3ebf926f,0x3ee363fa,0x3f02ef9f
.long 0x3f13682a,0x3f2302d3,0x3f31a81d,0x3f3f41fc,0x3f4bbbf8,0x3f570348,0x3f6106f2,0x3f69b7e4
.long 0x3f800000,0x3f7f2f9d,0x3f7cbfc9,0x3f78b47b,0x3f731447,0x3f6be858,0x3f633c5a,0x3f591e6a
.long 0x3f4d9f02,0x3f40d0da,0x3f32c8c9,0x3f239da9,0x3f13682a,0x3f0242b1,0x3ee0924f,0x3ebb31a0
.long 0x0,0x3da3308c,0x3e22abb6,0x3e72b651,0x3ea09ae5,0x3ec6d529,0x3eebcbbb,0x3f07a136
.long 0x3f187fc0,0x3f286605,0x3f373a23,0x3f44e3f5,0x3f514d3d,0x3f5c61c7,0x3f660f88,0x3f6e46be
.long 0x3f800000,0x3f7f1f49,0x3f7c7eb0,0x3f7822d1,0x3f721352,0x3f6a5ad9,0x3f6106f2,0x3f5627fe
.long 0x3f49d112,0x3f3c17d9,0x3f2d1469,0x3f1ce11f,0x3f0b9a6b,0x3ef2bd43,0x3ecc9b8b,0x3ea5129f
.long 0x0,0x3da973ba,0x3e28defc,0x3e7bdba4,0x3ea68f12,0x3ece0bea,0x3ef41f07,0x3f0c42c9
.long 0x3f1d7fd1,0x3f2da859,0x3f3ca003,0x3f4a4c87,0x3f5695e5,0x3f61668a,0x3f6aab7b,0x3f725470
.long 0x3f800000,0x3f7f0e58,0x3f7c3b28,0x3f778bc5,0x3f710908,0x3f68bf3c,0x3f5ebe05,0x3f531849
.long 0x3f45e403,0x3f373a23,0x3f273656,0x3f15f6d9,0x3f039c3d,0x3ee0924f,0x3eb8442a,0x3e8e9a22
.long 0x0,0x3dafb680,0x3e2f10a2,0x3e827dc0,0x3eac7cd4,0x3ed53641,0x3efc5d27,0x3f10d3cd
.long 0x3f226799,0x3f32c8c9,0x3f41d870,0x3f4f7a1f,0x3f5b941a,0x3f660f88,0x3f6ed89e,0x3f75dec6
.long 0x3f800000,0x3f7efcc9,0x3f7bf531,0x3f76ef5b,0x3f6ff573,0x3f671599,0x3f5c61c7,0x3f4fefa8
.long 0x3f41d870,0x3f3238aa,0x3f212ff9,0x3f0ee0db,0x3ef6e0cb,0x3ece0bea,0x3ea395c5,0x3e6fa8b2
.long 0x0,0x3db5f8da,0x3e354098,0x3e870ada,0x3eb263ef,0x3edc53c1,0x3f0242b1,0x3f1553b7
.long 0x3f273656,0x3f37c655,0x3f46e22a,0x3f546b3b,0x3f604621,0x3f6a5ad9,0x3f7294f8,0x3f78e3d6
.long 0x3f800000,0x3f7eea9d,0x3f7baccd,0x3f764d97,0x3f6ed89e,0x3f655e0b,0x3f59f26a,0x3f4cae79
.long 0x3f3daef9,0x3f2d1469,0x3f1b02c6,0x3f07a136,0x3ee63375,0x3ebb31a0,0x3e8e9a22,0x3e419b37
.long 0x0,0x3dbc3ac3,0x3e3b6ecf,0x3e8b9507,0x3eb8442a,0x3ee363fa,0x3f064b82,0x3f19c200
.long 0x3f2beb4a,0x3f3ca003,0x3f4bbbf8,0x3f591e6a,0x3f64aa59,0x3f6e46be,0x3f75dec6,0x3f7b61fc
.long 0x3f800000,0x3f7ed7d4,0x3f7b61fc,0x3f75a67b,0x3f6db293,0x3f6398ac,0x3f577026,0x3f495521
.long 0x3f396842,0x3f27ce61,0x3f14b039,0x3f003a06,0x3ed53641,0x3ea80b1f,0x3e72b651,0x3e1324ca
.long 0x0,0x3dc27c39,0x3e419b37,0x3e901c2c,0x3ebe1d4a,0x3eea6681,0x3f0a48ad,0x3f1e1e22
.long 0x3f3085bb,0x3f4154e1,0x3f5064af,0x3f5d924d,0x3f68bf3c,0x3f71d19f,0x3f78b47b,0x3f7d57de
.long 0x3f800000,0x3f800000,0x3f800000,0x3f800000,0x3f800000,0x3f800000,0x3f800000,0x3f800000
.long 0x3f800000,0x3f800000,0x3f800000,0x3f800000,0x3f800000,0x3f800000,0x3f800000,0x3f800000
.long 0x0,0x0,0x0,0x0,0x0,0x0,0x0,0x0
.long 0x0,0x0,0x0,0x0,0x0,0x0,0x0,0x0
.long 0x3f7fb10f,0x3f7fa6e3,0x3f7f9c18,0x3f7f90b1,0x3f7f84ab,0x3f7f7808,0x3f7f6ac7,0x3f7f5ce9
.long 0x3f7f4e6d,0x3f7f3f54,0x3f7f2f9d,0x3f7f1f49,0x3f7f0e58,0x3f7efcc9,0x3f7eea9d,0x3f7ed7d4
.long 0x3d48fb30,0x3d55880e,0x3d621469,0x3d6ea038,0x3d7b2b74,0x3d83db0a,0x3d8a200a,0x3d9064b4
.long 0x3d96a905,0x3d9cecf9,0x3da3308c,0x3da973ba,0x3dafb680,0x3db5f8da,0x3dbc3ac3,0x3dc27c39
.long 0x3f7ec46d,0x3f7e9bc9,0x3f7e70b0,0x3f7e4323,0x3f7e1324,0x3f7de0b1,0x3f7dabcc,0x3f7d7474
.long 0x3f7d3aac,0x3f7cfe73,0x3f7cbfc9,0x3f7c7eb0,0x3f7c3b28,0x3f7bf531,0x3f7baccd,0x3f7b61fc
.long 0x3dc8bd36,0x3dd53db9,0x3de1bc2e,0x3dee3876,0x3dfab273,0x3e039502,0x3e09cf86,0x3e1008b7
.long 0x3e164083,0x3e1c76de,0x3e22abb6,0x3e28defc,0x3e2f10a2,0x3e354098,0x3e3b6ecf,0x3e419b37
.long 0x3f7d3aac,0x3f7cdf6c,0x3f7c7eb0,0x3f7c187a,0x3f7baccd,0x3f7b3bab,0x3f7ac516,0x3f7a4910
.long 0x3f79c79d,0x3f7940c0,0x3f78b47b,0x3f7822d1,0x3f778bc5,0x3f76ef5b,0x3f764d97,0x3f75a67b
.long 0x3e164083,0x3e1f917b,0x3e28defc,0x3e3228d4,0x3e3b6ecf,0x3e44b0b9,0x3e4dee60,0x3e57278f
.long 0x3e605c13,0x3e698bba,0x3e72b651,0x3e7bdba4,0x3e827dc0,0x3e870ada,0x3e8b9507,0x3e901c2c
.long 0x3f7b14be,0x3f7a7302,0x3f79c79d,0x3f791298,0x3f7853f8,0x3f778bc5,0x3f76ba07,0x3f75dec6
.long 0x3f74fa0b,0x3f740bdd,0x3f731447,0x3f721352,0x3f710908,0x3f6ff573,0x3f6ed89e,0x3f6db293
.long 0x3e47c5c2,0x3e541501,0x3e605c13,0x3e6c9a7f,0x3e78cfcc,0x3e827dc0,0x3e888e93,0x3e8e9a22
.long 0x3e94a031,0x3e9aa086,0x3ea09ae5,0x3ea68f12,0x3eac7cd4,0x3eb263ef,0x3eb8442a,0x3ebe1d4a
.long 0x3f7853f8,0x3f77583a,0x3f764d97,0x3f75341d,0x3f740bdd,0x3f72d4eb,0x3f718f57,0x3f703b37
.long 0x3f6ed89e,0x3f6d67a1,0x3f6be858,0x3f6a5ad9,0x3f68bf3c,0x3f671599,0x3f655e0b,0x3f6398ac
.long 0x3e78cfcc,0x3e840270,0x3e8b9507,0x3e931f35,0x3e9aa086,0x3ea21887,0x3ea986c4,0x3eb0eacb
.long 0x3eb8442a,0x3ebf926f,0x3ec6d529,0x3ece0bea,0x3ed53641,0x3edc53c1,0x3ee363fa,0x3eea6681
.long 0x3f74fa0b,0x3f73913f,0x3f721352,0x3f708066,0x3f6ed89e,0x3f6d1c1d,0x3f6b4b0c,0x3f696591
.long 0x3f676bd8,0x3f655e0b,0x3f633c5a,0x3f6106f2,0x3f5ebe05,0x3f5c61c7,0x3f59f26a,0x3f577026
.long 0x3e94a031,0x3e9d9e78,0x3ea68f12,0x3eaf713a,0x3eb8442a,0x3ec1071e,0x3ec9b953,0x3ed25a09
.long 0x3edae880,0x3ee363fa,0x3eebcbbb,0x3ef41f07,0x3efc5d27,0x3f0242b1,0x3f064b82,0x3f0a48ad
.long 0x3f710908,0x3f6f20b0,0x3f6d1c1d,0x3f6afb8c,0x3f68bf3c,0x3f666771,0x3f63f473,0x3f61668a
.long 0x3f5ebe05,0x3f5bfb34,0x3f591e6a,0x3f5627fe,0x3f531849,0x3f4fefa8,0x3f4cae79,0x3f495521
.long 0x3eac7cd4,0x3eb6ccc3,0x3ec1071e,0x3ecb2aae,0x3ed53641,0x3edf28a9,0x3ee900b7,0x3ef2bd43
.long 0x3efc5d27,0x3f02ef9f,0x3f07a136,0x3f0c42c9,0x3f10d3cd,0x3f1553b7,0x3f19c200,0x3f1e1e22
.long 0x3f6c835e,0x3f6a09a7,0x3f676bd8,0x3f64aa59,0x3f61c598,0x3f5ebe05,0x3f5b941a,0x3f584853
.long 0x3f54db31,0x3f514d3d,0x3f4d9f02,0x3f49d112,0x3f45e403,0x3f41d870,0x3f3daef9,0x3f396842
.long 0x3ec3ef15,0x3ecf7bca,0x3edae880,0x3ee63375,0x3ef15aea,0x3efc5d27,0x3f039c3d,0x3f08f59b
.long 0x3f0e39da,0x3f13682a,0x3f187fc0,0x3f1d7fd1,0x3f226799,0x3f273656,0x3f2beb4a,0x3f3085bb
.long 0x3f676bd8,0x3f644fac,0x3f6106f2,0x3f5d924d,0x3f59f26a,0x3f5627fe,0x3f5233c6,0x3f4e1689
.long 0x3f49d112,0x3f456439,0x3f40d0da,0x3f3c17d9,0x3f373a23,0x3f3238aa,0x3f2d1469,0x3f27ce61
.long 0x3edae880,0x3ee79a5d,0x3ef41f07,0x3f003a06,0x3f064b82,0x3f0c42c9,0x3f121eb0,0x3f17de12
.long 0x3f1d7fd1,0x3f2302d3,0x3f286605,0x3f2da859,0x3f32c8c9,0x3f37c655,0x3f3ca003,0x3f4154e1
.long 0x3f61c598,0x3f5df6be,0x3f59f26a,0x3f55b993,0x3f514d3d,0x3f4cae79,0x3f47de65,0x3f42de29
.long 0x3f3daef9,0x3f385216,0x3f32c8c9,0x3f2d1469,0x3f273656,0x3f212ff9,0x3f1b02c6,0x3f14b039
.long 0x3ef15aea,0x3eff17b2,0x3f064b82,0x3f0cead0,0x3f13682a,0x3f19c200,0x3f1ff6cb,0x3f26050a
.long 0x3f2beb4a,0x3f31a81d,0x3f373a23,0x3f3ca003,0x3f41d870,0x3f46e22a,0x3f4bbbf8,0x3f5064af
.long 0x3f5b941a,0x3f570348,0x3f5233c6,0x3f4d26fd,0x3f47de65,0x3f425b89,0x3f3ca003,0x3f36ad7f
.long 0x3f3085bb,0x3f2a2a80,0x3f239da9,0x3f1ce11f,0x3f15f6d9,0x3f0ee0db,0x3f07a136,0x3f003a06
.long 0x3f039c3d,0x3f0af1b7,0x3f121eb0,0x3f19210f,0x3f1ff6cb,0x3f269de3,0x3f2d1469,0x3f33587a
.long 0x3f396842,0x3f3f41fc,0x3f44e3f5,0x3f4a4c87,0x3f4f7a1f,0x3f546b3b,0x3f591e6a,0x3f5d924d
.long 0x3f54db31,0x3f4f7a1f,0x3f49d112,0x3f43e200,0x3f3daef9,0x3f373a23,0x3f3085bb,0x3f299415
.long 0x3f226799,0x3f1b02c6,0x3f13682a,0x3f0b9a6b,0x3f039c3d,0x3ef6e0cb,0x3ee63375,0x3ed53641
.long 0x3f0e39da,0x3f15f6d9,0x3f1d7fd1,0x3f24d225,0x3f2beb4a,0x3f32c8c9,0x3f396842,0x3f3fc767
.long 0x3f45e403,0x3f4bbbf8,0x3f514d3d,0x3f5695e5,0x3f5b941a,0x3f604621,0x3f64aa59,0x3f68bf3c
.long 0x3f4d9f02,0x3f476085,0x3f40d0da,0x3f39f2ac,0x3f32c8c9,0x3f2b561b,0x3f239da9,0x3f1ba299
.long 0x3f13682a,0x3f0af1b7,0x3f0242b1,0x3ef2bd43,0x3ee0924f,0x3ece0bea,0x3ebb31a0,0x3ea80b1f
.long 0x3f187fc0,0x3f209393,0x3f286605,0x3f2ff3e6,0x3f373a23,0x3f3e35c5,0x3f44e3f5,0x3f4b41fa
.long 0x3f514d3d,0x3f570348,0x3f5c61c7,0x3f61668a,0x3f660f88,0x3f6a5ad9,0x3f6e46be,0x3f71d19f
.long 0x3f45e403,0x3f3ebc1b,0x3f373a23,0x3f2f61a5,0x3f273656,0x3f1ebc12,0x3f15f6d9,0x3f0cead0
.long 0x3f039c3d,0x3ef41f07,0x3ee0924f,0x3ecc9b8b,0x3eb8442a,0x3ea395c5,0x3e8e9a22,0x3e72b651
.long 0x3f226799,0x3f2ac082,0x3f32c8c9,0x3f3a7ca4,0x3f41d870,0x3f48d8b3,0x3f4f7a1f,0x3f55b993
.long 0x3f5b941a,0x3f6106f2,0x3f660f88,0x3f6aab7b,0x3f6ed89e,0x3f7294f8,0x3f75dec6,0x3f78b47b
.long 0x3f3daef9,0x3f3592e7,0x3f2d1469,0x3f24381a,0x3f1b02c6,0x3f11796b,0x3f07a136,0x3efafef7
.long 0x3ee63375,0x3ed0eb2a,0x3ebb31a0,0x3ea5129f,0x3e8e9a22,0x3e6fa8b2,0x3e419b37,0x3e1324ca
.long 0x3f2beb4a,0x3f34768f,0x3f3ca003,0x3f446337,0x3f4bbbf8,0x3f52a649,0x3f591e6a,0x3f5f20db
.long 0x3f64aa59,0x3f69b7e4,0x3f6e46be,0x3f725470,0x3f75dec6,0x3f78e3d6,0x3f7b61fc,0x3f7d57de
.long 0x3f3504f3,0x3f2beb4a,0x3f226799,0x3f187fc0,0x3f0e39da,0x3f039c3d,0x3ef15aea,0x3edae880
.long 0x3ec3ef15,0x3eac7cd4,0x3e94a031,0x3e78cfcc,0x3e47c5c2,0x3e164083,0x3dc8bd36,0x3d48fb30
.long 0x3f3504f3,0x3f3daef9,0x3f45e403,0x3f4d9f02,0x3f54db31,0x3f5b941a,0x3f61c598,0x3f676bd8
.long 0x3f6c835e,0x3f710908,0x3f74fa0b,0x3f7853f8,0x3f7b14be,0x3f7d3aac,0x3f7ec46d,0x3f7fb10f
.long 0x3f2beb4a,0x3f21cbfb,0x3f173c07,0x3f0c42c9,0x3f00e7e4,0x3eea6681,0x3ed25a09,0x3eb9bb1e
.long 0x3ea09ae5,0x3e870ada,0x3e5a3997,0x3e25c58c,0x3de1bc2e,0x3d6ea038,0x3bc90f88,0xbd3c6dd5
.long 0x3f3daef9,0x3f466354,0x3f4e8d90,0x3f5627fe,0x3f5d2d53,0x3f6398ac,0x3f696591,0x3f6e8ff8
.long 0x3f731447,0x3f76ef5b,0x3f7a1e84,0x3f7c9f8a,0x3f7e70b0,0x3f7f90b1,0x3f7ffec4,0x3f7fba9e
.long 0x3f226799,0x3f173c07,0x3f0b9a6b,0x3eff17b2,0x3ee63375,0x3ecc9b8b,0x3eb263ef,0x3e97a117
.long 0x3e78cfcc,0x3e419b37,0x3e09cf86,0x3da3308c,0x3cc90ab0,0xbcfb49ba,0xbdafb680,0xbe1008b7
.long 0x3f45e403,0x3f4e8d90,0x3f5695e5,0x3f5df6be,0x3f64aa59,0x3f6aab7b,0x3f6ff573,0x3f748422
.long 0x3f7853f8,0x3f7b61fc,0x3f7dabcc,0x3f7f2f9d,0x3f7fec43,0x3f7fe129,0x3f7f0e58,0x3f7d7474
.long 0x3f187fc0,0x3f0c42c9,0x3eff17b2,0x3ee4cbfe,0x3ec9b953,0x3eadf73c,0x3e919ddd,0x3e698bba
.long 0x3e2f10a2,0x3de7fa9a,0x3d621469,0xbb490fc6,0xbd7b2b74,0xbdf475c0,0xbe354098,0xbe6fa8b2
.long 0x3f4d9f02,0x3f5627fe,0x3f5df6be,0x3f650479,0x3f6b4b0c,0x3f70c501,0x3f756d97,0x3f7940c0
.long 0x3f7c3b28,0x3f7e5a38,0x3f7f9c18,0x3f7fffb1,0x3f7f84ab,0x3f7e2b72,0x3f7bf531,0x3f78e3d6
.long 0x3f0e39da,0x3f00e7e4,0x3ee63375,0x3ec9b953,0x3eac7cd4,0x3e8e9a22,0x3e605c13,0x3e22abb6
.long 0x3dc8bd36,0x3d16c32c,0xbcc90ab0,0xbdafb680,0xbe164083,0xbe541501,0xbe888e93,0xbea68f12
.long 0x3f54db31,0x3f5d2d53,0x3f64aa59,0x3f6b4b0c,0x3f710908,0x3f75dec6,0x3f79c79d,0x3f7cbfc9
.long 0x3f7ec46d,0x3f7fd397,0x3f7fec43,0x3f7f0e58,0x3f7d3aac,0x3f7a7302,0x3f76ba07,0x3f721352
.long 0x3f039c3d,0x3eea6681,0x3ecc9b8b,0x3eadf73c,0x3e8e9a22,0x3e5d4b1a,0x3e1c76de,0x3db5f8da
.long 0x3cc90ab0,0xbd2351cb,0xbdd53db9,0xbe2bf804,0xbe6c9a7f,0xbe9620d2,0xbeb554ec,0xbed3c867
.long 0x3f5b941a,0x3f6398ac,0x3f6aab7b,0x3f70c501,0x3f75dec6,0x3f79f35e,0x3f7cfe73,0x3f7efcc9
.long 0x3f7fec43,0x3f7fcbe2,0x3f7e9bc9,0x3f7c5d3a,0x3f791298,0x3f74bf62,0x3f6f6830,0x3f6912ae
.long 0x3ef15aea,0x3ed25a09,0x3eb263ef,0x3e919ddd,0x3e605c13,0x3e1c76de,0x3dafb680,0x3c96c9b6
.long 0xbd48fb30,0xbdee3876,0xbe3b6ecf,0xbe7ee6e1,0xbea09ae5,0xbec1071e,0xbee0924f,0xbeff17b2
.long 0x3f61c598,0x3f696591,0x3f6ff573,0x3f756d97,0x3f79c79d,0x3f7cfe73,0x3f7f0e58,0x3f7ff4e6
.long 0x3f7fb10f,0x3f7e4323,0x3f7baccd,0x3f77f110,0x3f731447,0x3f6d1c1d,0x3f660f88,0x3f5df6be
.long 0x3edae880,0x3eb9bb1e,0x3e97a117,0x3e698bba,0x3e22abb6,0x3db5f8da,0x3c96c9b6,0xbd55880e
.long 0xbdfab273,0xbe44b0b9,0xbe8586ce,0xbea80b1f,0xbec9b953,0xbeea6681,0xbf04f484,0xbf140c5f
.long 0x3f676bd8,0x3f6e8ff8,0x3f748422,0x3f7940c0,0x3f7cbfc9,0x3f7efcc9,0x3f7ff4e6,0x3f7fa6e3
.long 0x3f7e1324,0x3f7b3bab,0x3f772417,0x3f71d19f,0x3f6b4b0c,0x3f6398ac,0x3f5ac450,0x3f50d937
.long 0x3ec3ef15,0x3ea09ae5,0x3e78cfcc,0x3e2f10a2,0x3dc8bd36,0x3cc90ab0,0xbd48fb30,0xbdfab273
.long 0xbe47c5c2,0xbe888e93,0xbeac7cd4,0xbecf7bca,0xbef15aea,0xbf08f59b,0xbf187fc0,0xbf273656
.long 0x3f6c835e,0x3f731447,0x3f7853f8,0x3f7c3b28,0x3f7ec46d,0x3f7fec43,0x3f7fb10f,0x3f7e1324
.long 0x3f7b14be,0x3f76ba07,0x3f710908,0x3f6a09a7,0x3f61c598,0x3f584853,0x3f4d9f02,0x3f41d870
.long 0x3eac7cd4,0x3e870ada,0x3e419b37,0x3de7fa9a,0x3d16c32c,0xbd2351cb,0xbdee3876,0xbe44b0b9
.long 0xbe888e93,0xbeadf73c,0xbed25a09,0xbef58035,0xbf0b9a6b,0xbf1ba299,0xbf2ac082,0xbf38dd65
.long 0x3f710908,0x3f76ef5b,0x3f7b61fc,0x3f7e5a38,0x3f7fd397,0x3f7fcbe2,0x3f7e4323,0x3f7b3bab
.long 0x3f76ba07,0x3f70c501,0x3f696591,0x3f60a6cf,0x3f5695e5,0x3f4b41fa,0x3f3ebc1b,0x3f311722
.long 0x3e94a031,0x3e5a3997,0x3e09cf86,0x3d621469,0xbcc90ab0,0xbdd53db9,0xbe3b6ecf,0xbe8586ce
.long 0xbeac7cd4,0xbed25a09,0xbef6e0cb,0xbf0cead0,0xbf1d7fd1,0xbf2d1469,0xbf3b8f3b,0xbf48d8b3
.long 0x3f74fa0b,0x3f7a1e84,0x3f7dabcc,0x3f7f9c18,0x3f7fec43,0x3f7e9bc9,0x3f7baccd,0x3f772417
.long 0x3f710908,0x3f696591,0x3f604621,0x3f55b993,0x3f49d112,0x3f3ca003,0x3f2e3bde,0x3f1ebc12
.long 0x3e78cfcc,0x3e25c58c,0x3da3308c,0xbb490fc6,0xbdafb680,0xbe2bf804,0xbe7ee6e1,0xbea80b1f
.long 0xbecf7bca,0xbef58035,0xbf0cead0,0xbf1e1e22,0xbf2e3bde,0xbf3d27b8,0xbf4ac77f,0xbf570348
.long 0x3f7853f8,0x3f7c9f8a,0x3f7f2f9d,0x3f7fffb1,0x3f7f0e58,0x3f7c5d3a,0x3f77f110,0x3f71d19f
.long 0x3f6a09a7,0x3f60a6cf,0x3f55b993,0x3f495521,0x3f3b8f3b,0x3f2c800f,0x3f1c420c,0x3f0af1b7
.long 0x3e47c5c2,0x3de1bc2e,0x3cc90ab0,0xbd7b2b74,0xbe164083,0xbe6c9a7f,0xbea09ae5,0xbec9b953
.long 0xbef15aea,0xbf0b9a6b,0xbf1d7fd1,0xbf2e3bde,0xbf3daef9,0xbf4bbbf8,0xbf584853,0xbf633c5a
.long 0x3f7b14be,0x3f7e70b0,0x3f7fec43,0x3f7f84ab,0x3f7d3aac,0x3f791298,0x3f731447,0x3f6b4b0c
.long 0x3f61c598,0x3f5695e5,0x3f49d112,0x3f3b8f3b,0x3f2beb4a,0x3f1b02c6,0x3f08f59b,0x3eebcbbb
.long 0x3e164083,0x3d6ea038,0xbcfb49ba,0xbdf475c0,0xbe541501,0xbe9620d2,0xbec1071e,0xbeea6681
.long 0xbf08f59b,0xbf1ba299,0xbf2d1469,0xbf3d27b8,0xbf4bbbf8,0xbf58b3a1,0xbf63f473,0xbf6d67a1
.long 0x3f7d3aac,0x3f7f90b1,0x3f7fe129,0x3f7e2b72,0x3f7a7302,0x3f74bf62,0x3f6d1c1d,0x3f6398ac
.long 0x3f584853,0x3f4b41fa,0x3f3ca003,0x3f2c800f,0x3f1b02c6,0x3f084b92,0x3ee900b7,0x3ebf926f
.long 0x3dc8bd36,0x3bc90f88,0xbdafb680,0xbe354098,0xbe888e93,0xbeb554ec,0xbee0924f,0xbf04f484
.long 0xbf187fc0,0xbf2ac082,0xbf3b8f3b,0xbf4ac77f,0xbf584853,0xbf63f473,0xbf6db293,0xbf756d97
.long 0x3f7ec46d,0x3f7ffec4,0x3f7f0e58,0x3f7bf531,0x3f76ba07,0x3f6f6830,0x3f660f88,0x3f5ac450
.long 0x3f4d9f02,0x3f3ebc1b,0x3f2e3bde,0x3f1c420c,0x3f08f59b,0x3ee900b7,0x3ebe1d4a,0x3e919ddd
.long 0x3d48fb30,0xbd3c6dd5,0xbe1008b7,0xbe6fa8b2,0xbea68f12,0xbed3c867,0xbeff17b2,0xbf140c5f
.long 0xbf273656,0xbf38dd65,0xbf48d8b3,0xbf570348,0xbf633c5a,0xbf6d67a1,0xbf756d97,0xbf7b3bab
.long 0x3f7fb10f,0x3f7fba9e,0x3f7d7474,0x3f78e3d6,0x3f721352,0x3f6912ae,0x3f5df6be,0x3f50d937
.long 0x3f41d870,0x3f311722,0x3f1ebc12,0x3f0af1b7,0x3eebcbbb,0x3ebf926f,0x3e919ddd,0x3e44b0b9
.long 0x3f800000,0x3f800000,0x3f800000,0x3f800000,0x3f800000,0x3f800000,0x3f800000,0x3f800000
.long 0x3f800000,0x3f800000,0x3f800000,0x3f800000,0x3f800000,0x3f800000,0x3f800000,0x3f800000
.long 0x0,0x0,0x0,0x0,0x0,0x0,0x0,0x0
.long 0x0,0x0,0x0,0x0,0x0,0x0,0x0,0x0
.long 0x3f7ec46d,0x3f7eb069,0x3f7e9bc9,0x3f7e868b,0x3f7e70b0,0x3f7e5a38,0x3f7e4323,0x3f7e2b72
.long 0x3f7e1324,0x3f7dfa38,0x3f7de0b1,0x3f7dc68c,0x3f7dabcc,0x3f7d906e,0x3f7d7474,0x3f7d57de
.long 0x3dc8bd36,0x3dcefdb7,0x3dd53db9,0x3ddb7d37,0x3de1bc2e,0x3de7fa9a,0x3dee3876,0x3df475c0
.long 0x3dfab273,0x3e007745,0x3e039502,0x3e06b26e,0x3e09cf86,0x3e0cec4a,0x3e1008b7,0x3e1324ca
.long 0x3f7b14be,0x3f7ac516,0x3f7a7302,0x3f7a1e84,0x3f79c79d,0x3f796e4e,0x3f791298,0x3f78b47b
.long 0x3f7853f8,0x3f77f110,0x3f778bc5,0x3f772417,0x3f76ba07,0x3f764d97,0x3f75dec6,0x3f756d97
.long 0x3e47c5c2,0x3e4dee60,0x3e541501,0x3e5a3997,0x3e605c13,0x3e667c66,0x3e6c9a7f,0x3e72b651
.long 0x3e78cfcc,0x3e7ee6e1,0x3e827dc0,0x3e8586ce,0x3e888e93,0x3e8b9507,0x3e8e9a22,0x3e919ddd
.long 0x3f74fa0b,0x3f74484b,0x3f73913f,0x3f72d4eb,0x3f721352,0x3f714c7a,0x3f708066,0x3f6faf1b
.long 0x3f6ed89e,0x3f6dfcf2,0x3f6d1c1d,0x3f6c3624,0x3f6b4b0c,0x3f6a5ad9,0x3f696591,0x3f686b39
.long 0x3e94a031,0x3e9920fe,0x3e9d9e78,0x3ea21887,0x3ea68f12,0x3eab0201,0x3eaf713a,0x3eb3dca5
.long 0x3eb8442a,0x3ebca7af,0x3ec1071e,0x3ec5625c,0x3ec9b953,0x3ece0bea,0x3ed25a09,0x3ed6a399
.long 0x3f6c835e,0x3f6b4b0c,0x3f6a09a7,0x3f68bf3c,0x3f676bd8,0x3f660f88,0x3f64aa59,0x3f633c5a
.long 0x3f61c598,0x3f604621,0x3f5ebe05,0x3f5d2d53,0x3f5b941a,0x3f59f26a,0x3f584853,0x3f5695e5
.long 0x3ec3ef15,0x3ec9b953,0x3ecf7bca,0x3ed53641,0x3edae880,0x3ee0924f,0x3ee63375,0x3eebcbbb
.long 0x3ef15aea,0x3ef6e0cb,0x3efc5d27,0x3f00e7e4,0x3f039c3d,0x3f064b82,0x3f08f59b,0x3f0b9a6b
.long 0x3f61c598,0x3f5fe4e9,0x3f5df6be,0x3f5bfb34,0x3f59f26a,0x3f57dc7f,0x3f55b993,0x3f5389c7
.long 0x3f514d3d,0x3f4f0417,0x3f4cae79,0x3f4a4c87,0x3f47de65,0x3f456439,0x3f42de29,0x3f404c5c
.long 0x3ef15aea,0x3ef840c8,0x3eff17b2,0x3f02ef9f,0x3f064b82,0x3f099f4e,0x3f0cead0,0x3f102dd5
.long 0x3f13682a,0x3f16999f,0x3f19c200,0x3f1ce11f,0x3f1ff6cb,0x3f2302d3,0x3f26050a,0x3f28fd41
.long 0x3f54db31,0x3f5233c6,0x3f4f7a1f,0x3f4cae79,0x3f49d112,0x3f46e22a,0x3f43e200,0x3f40d0da
.long 0x3f3daef9,0x3f3a7ca4,0x3f373a23,0x3f33e7bc,0x3f3085bb,0x3f2d1469,0x3f299415,0x3f26050a
.long 0x3f0e39da,0x3f121eb0,0x3f15f6d9,0x3f19c200,0x3f1d7fd1,0x3f212ff9,0x3f24d225,0x3f286605
.long 0x3f2beb4a,0x3f2f61a5,0x3f32c8c9,0x3f36206c,0x3f396842,0x3f3ca003,0x3f3fc767,0x3f42de29
.long 0x3f45e403,0x3f425b89,0x3f3ebc1b,0x3f3b0629,0x3f373a23,0x3f33587a,0x3f2f61a5,0x3f2b561b
.long 0x3f273656,0x3f2302d3,0x3f1ebc12,0x3f1a6293,0x3f15f6d9,0x3f11796b,0x3f0cead0,0x3f084b92
.long 0x3f226799,0x3f269de3,0x3f2ac082,0x3f2ecef7,0x3f32c8c9,0x3f36ad7f,0x3f3a7ca4,0x3f3e35c5
.long 0x3f41d870,0x3f456439,0x3f48d8b3,0x3f4c3578,0x3f4f7a1f,0x3f52a649,0x3f55b993,0x3f58b3a1
.long 0x3f3504f3,0x3f3085bb,0x3f2beb4a,0x3f273656,0x3f226799,0x3f1d7fd1,0x3f187fc0,0x3f13682a
.long 0x3f0e39da,0x3f08f59b,0x3f039c3d,0x3efc5d27,0x3ef15aea,0x3ee63375,0x3edae880,0x3ecf7bca
.long 0x3f3504f3,0x3f396842,0x3f3daef9,0x3f41d870,0x3f45e403,0x3f49d112,0x3f4d9f02,0x3f514d3d
.long 0x3f54db31,0x3f584853,0x3f5b941a,0x3f5ebe05,0x3f61c598,0x3f64aa59,0x3f676bd8,0x3f6a09a7
.long 0x3f226799,0x3f1ce11f,0x3f173c07,0x3f11796b,0x3f0b9a6b,0x3f05a02c,0x3eff17b2,0x3ef2bd43
.long 0x3ee63375,0x3ed97cb9,0x3ecc9b8b,0x3ebf926f,0x3eb263ef,0x3ea5129f,0x3e97a117,0x3e8a11f7
.long 0x3f45e403,0x3f4a4c87,0x3f4e8d90,0x3f52a649,0x3f5695e5,0x3f5a5ba0,0x3f5df6be,0x3f61668a
.long 0x3f64aa59,0x3f67c187,0x3f6aab7b,0x3f6d67a1,0x3f6ff573,0x3f725470,0x3f748422,0x3f76841b
.long 0x3f0e39da,0x3f07a136,0x3f00e7e4,0x3ef41f07,0x3ee63375,0x3ed8106b,0x3ec9b953,0x3ebb31a0
.long 0x3eac7cd4,0x3e9d9e78,0x3e8e9a22,0x3e7ee6e1,0x3e605c13,0x3e419b37,0x3e22abb6,0x3e039502
.long 0x3f54db31,0x3f591e6a,0x3f5d2d53,0x3f6106f2,0x3f64aa59,0x3f6816a8,0x3f6b4b0c,0x3f6e46be
.long 0x3f710908,0x3f73913f,0x3f75dec6,0x3f77f110,0x3f79c79d,0x3f7b61fc,0x3f7cbfc9,0x3f7de0b1
.long 0x3ef15aea,0x3ee1fb6a,0x3ed25a09,0x3ec27b55,0x3eb263ef,0x3ea21887,0x3e919ddd,0x3e80f8c0
.long 0x3e605c13,0x3e3e853e,0x3e1c76de,0x3df475c0,0x3dafb680,0x3d55880e,0x3c96c9b6,0xbc7b514b
.long 0x3f61c598,0x3f65b710,0x3f696591,0x3f6cd007,0x3f6ff573,0x3f72d4eb,0x3f756d97,0x3f77beb7
.long 0x3f79c79d,0x3f7b87b2,0x3f7cfe73,0x3f7e2b72,0x3f7f0e58,0x3f7fa6e3,0x3f7ff4e6,0x3f7ff84a
.long 0x3ec3ef15,0x3eb263ef,0x3ea09ae5,0x3e8e9a22,0x3e78cfcc,0x3e541501,0x3e2f10a2,0x3e09cf86
.long 0x3dc8bd36,0x3d7b2b74,0x3cc90ab0,0xbc490e90,0xbd48fb30,0xbdafb680,0xbdfab273,0xbe22abb6
.long 0x3f6c835e,0x3f6ff573,0x3f731447,0x3f75dec6,0x3f7853f8,0x3f7a7302,0x3f7c3b28,0x3f7dabcc
.long 0x3f7ec46d,0x3f7f84ab,0x3f7fec43,0x3f7ffb11,0x3f7fb10f,0x3f7f0e58,0x3f7e1324,0x3f7cbfc9
.long 0x3e94a031,0x3e80f8c0,0x3e5a3997,0x3e3228d4,0x3e09cf86,0x3dc27c39,0x3d621469,0x3c7b514b
.long 0xbcc90ab0,0xbd83db0a,0xbdd53db9,0xbe1324ca,0xbe3b6ecf,0xbe636c83,0xbe8586ce,0xbe9920fe
.long 0x3f74fa0b,0x3f77beb7,0x3f7a1e84,0x3f7c187a,0x3f7dabcc,0x3f7ed7d4,0x3f7f9c18,0x3f7ff84a
.long 0x3f7fec43,0x3f7f7808,0x3f7e9bc9,0x3f7d57de,0x3f7baccd,0x3f799b43,0x3f772417,0x3f74484b
.long 0x3e47c5c2,0x3e1c76de,0x3de1bc2e,0x3d8a200a,0x3cc90ab0,0xbc96c9b6,0xbd7b2b74,0xbdd53db9
.long 0xbe164083,0xbe419b37,0xbe6c9a7f,0xbe8b9507,0xbea09ae5,0xbeb554ec,0xbec9b953,0xbeddbe79
.long 0x3f7b14be,0x3f7cfe73,0x3f7e70b0,0x3f7f6ac7,0x3f7fec43,0x3f7ff4e6,0x3f7f84ab,0x3f7e9bc9
.long 0x3f7d3aac,0x3f7b61fc,0x3f791298,0x3f764d97,0x3f731447,0x3f6f6830,0x3f6b4b0c,0x3f66becc
.long 0x3dc8bd36,0x3d55880e,0x3bc90f88,0xbd2351cb,0xbdafb680,0xbe06b26e,0xbe354098,0xbe636c83
.long 0xbe888e93,0xbe9f1cdf,0xbeb554ec,0xbecb2aae,0xbee0924f,0xbef58035,0xbf04f484,0xbf0ee0db
.long 0x3f7ec46d,0x3f7fa6e3,0x3f7ffec4,0x3f7fcbe2,0x3f7f0e58,0x3f7dc68c,0x3f7bf531,0x3f799b43
.long 0x3f76ba07,0x3f73530e,0x3f6f6830,0x3f6afb8c,0x3f660f88,0x3f60a6cf,0x3f5ac450,0x3f546b3b
.long 0x248d3132,0xbd48fb30,0xbdc8bd36,0xbe164083,0xbe47c5c2,0xbe78cfcc,0xbe94a031,0xbeac7cd4
.long 0xbec3ef15,0xbedae880,0xbef15aea,0xbf039c3d,0xbf0e39da,0xbf187fc0,0xbf226799,0xbf2beb4a
.long 0x3f800000,0x3f7fb10f,0x3f7ec46d,0x3f7d3aac,0x3f7b14be,0x3f7853f8,0x3f74fa0b,0x3f710908
.long 0x3f6c835e,0x3f676bd8,0x3f61c598,0x3f5b941a,0x3f54db31,0x3f4d9f02,0x3f45e403,0x3f3daef9
.long 0xbdc8bd36,0xbe195be0,0xbe4dee60,0xbe80f8c0,0xbe9aa086,0xbeb3dca5,0xbecc9b8b,0xbee4cbfe
.long 0xbefc5d27,0xbf099f4e,0xbf14b039,0xbf1f599f,0xbf299415,0xbf33587a,0xbf3ca003,0xbf456439
.long 0x3f7ec46d,0x3f7d1cdd,0x3f7ac516,0x3f77beb7,0x3f740bdd,0x3f6faf1b,0x3f6aab7b,0x3f650479
.long 0x3f5ebe05,0x3f57dc7f,0x3f5064af,0x3f485bca,0x3f3fc767,0x3f36ad7f,0x3f2d1469,0x3f2302d3
.long 0xbe47c5c2,0xbe7ee6e1,0xbe9aa086,0xbeb554ec,0xbecf7bca,0xbee900b7,0xbf00e7e4,0xbf0cead0
.long 0xbf187fc0,0xbf239da9,0xbf2e3bde,0xbf385216,0xbf41d870,0xbf4ac77f,0xbf531849,0xbf5ac450
.long 0x3f7b14be,0x3f77f110,0x3f740bdd,0x3f6f6830,0x3f6a09a7,0x3f63f473,0x3f5d2d53,0x3f55b993
.long 0x3f4d9f02,0x3f44e3f5,0x3f3b8f3b,0x3f31a81d,0x3f273656,0x3f1c420c,0x3f10d3cd,0x3f04f484
.long 0xbe94a031,0xbeb0eacb,0xbecc9b8b,0xbee79a5d,0xbf00e7e4,0xbf0d9281,0xbf19c200,0xbf256bcb
.long 0xbf3085bb,0xbf3b0629,0xbf44e3f5,0xbf4e1689,0xbf5695e5,0xbf5e5aa6,0xbf655e0b,0xbf6b99fb
.long 0x3f74fa0b,0x3f703b37,0x3f6aab7b,0x3f644fac,0x3f5d2d53,0x3f554aa4,0x3f4cae79,0x3f436051
.long 0x3f396842,0x3f2ecef7,0x3f239da9,0x3f17de12,0x3f0b9a6b,0x3efdbabb,0x3ee363fa,0x3ec8477c
.long 0xbec3ef15,0xbee0924f,0xbefc5d27,0xbf0b9a6b,0xbf187fc0,0xbf24d225,0xbf3085bb,0xbf3b8f3b
.long 0xbf45e403,0xbf4f7a1f,0xbf584853,0xbf604621,0xbf676bd8,0xbf6db293,0xbf731447,0xbf778bc5
.long 0x3f6c835e,0x3f660f88,0x3f5ebe05,0x3f5695e5,0x3f4d9f02,0x3f43e200,0x3f396842,0x3f2e3bde
.long 0x3f226799,0x3f15f6d9,0x3f08f59b,0x3ef6e0cb,0x3edae880,0x3ebe1d4a,0x3ea09ae5,0x3e827dc0
.long 0xbef15aea,0xbf06f686,0xbf14b039,0xbf21cbfb,0xbf2e3bde,0xbf39f2ac,0xbf44e3f5,0xbf4f0417
.long 0xbf584853,0xbf60a6cf,0xbf6816a8,0xbf6e8ff8,0xbf740bdd,0xbf788486,0xbf7bf531,0xbf7e5a38
.long 0x3f61c598,0x3f5988ad,0x3f5064af,0x3f466354,0x3f3b8f3b,0x3f2ff3e6,0x3f239da9,0x3f16999f
.long 0x3f08f59b,0x3ef58035,0x3ed8106b,0x3eb9bb1e,0x3e9aa086,0x3e75c35a,0x3e354098,0x3de7fa9a
.long 0xbf0e39da,0xbf1c420c,0xbf299415,0xbf36206c,0xbf41d870,0xbf4cae79,0xbf5695e5,0xbf5f8327
.long 0xbf676bd8,0xbf6e46be,0xbf740bdd,0xbf78b47b,0xbf7c3b28,0xbf7e9bc9,0xbf7fd397,0xbf7fe129
.long 0x3f54db31,0x3f4ac77f,0x3f3fc767,0x3f33e7bc,0x3f273656,0x3f19c200,0x3f0b9a6b,0x3ef9a02d
.long 0x3edae880,0x3ebb31a0,0x3e9aa086,0x3e72b651,0x3e2f10a2,0x3dd53db9,0x3d16c32c,0xbcfb49ba
.long 0xbf226799,0xbf2ff3e6,0xbf3ca003,0xbf485bca,0xbf531849,0xbf5cc7d1,0xbf655e0b,0xbf6cd007
.long 0xbf731447,0xbf7822d1,0xbf7bf531,0xbf7e868b,0xbf7fd397,0xbf7fdaaf,0xbf7e9bc9,0xbf7c187a
.long 0x3f45e403,0x3f39f2ac,0x3f2d1469,0x3f1f599f,0x3f10d3cd,0x3f019573,0x3ee363fa,0x3ec27b55
.long 0x3ea09ae5,0x3e7bdba4,0x3e354098,0x3ddb7d37,0x3d16c32c,0xbd0a342f,0xbdd53db9,0xbe3228d4
.long 0xbf3504f3,0xbf41d870,0xbf4d9f02,0xbf584853,0xbf61c598,0xbf6a09a7,0xbf710908,0xbf76ba07
.long 0xbf7b14be,0xbf7e1324,0xbf7fb10f,0xbf7fec43,0xbf7ec46d,0xbf7c3b28,0xbf7853f8,0xbf731447
.long 0x3f3504f3,0x3f273656,0x3f187fc0,0x3f08f59b,0x3ef15aea,0x3ecf7bca,0x3eac7cd4,0x3e888e93
.long 0x3e47c5c2,0x3dfab273,0x3d48fb30,0xbcc90ab0,0xbdc8bd36,0xbe2f10a2,0xbe78cfcc,0xbea09ae5
.long 0xbf45e403,0xbf51c0c2,0xbf5c61c7,0xbf65b710,0xbf6db293,0xbf74484b,0xbf796e4e,0xbf7d1cdd
.long 0xbf7f4e6d,0xbf7fffb1,0xbf7f2f9d,0xbf7cdf6c,0xbf791298,0xbf73ced9,0xbf6d1c1d,0xbf650479
.long 0x3f226799,0x3f12c39a,0x3f0242b1,0x3ee1fb6a,0x3ebe1d4a,0x3e9920fe,0x3e667c66,0x3e195be0
.long 0x3d96a905,0xbb490fc6,0xbda3308c,0xbe1f917b,0xbe6c9a7f,0xbe9c1faf,0xbec1071e,0xbee4cbfe
.long 0xbf54db31,0xbf5f8327,0xbf68bf3c,0xbf708066,0xbf76ba07,0xbf7b61fc,0xbf7e70b0,0xbf7fe129
.long 0xbf7fb10f,0xbf7de0b1,0xbf7a7302,0xbf756d97,0xbf6ed89e,0xbf66becc,0xbf5d2d53,0xbf5233c6
.long 0x3f0e39da,0x3ef9a02d,0x3ed53641,0x3eaf713a,0x3e888e93,0x3e419b37,0x3de1bc2e,0x3cfb49ba
.long 0xbd48fb30,0xbe039502,0xbe541501,0xbe919ddd,0xbeb8442a,0xbeddbe79,0xbf00e7e4,0xbf121eb0
.long 0xbf61c598,0xbf6afb8c,0xbf7294f8,0xbf788486,0xbf7cbfc9,0xbf7f3f54,0xbf7ffec4,0xbf7efcc9
.long 0xbf7c3b28,0xbf77beb7,0xbf718f57,0xbf69b7e4,0xbf604621,0xbf554aa4,0xbf48d8b3,0xbf3b0629
.long 0x3ef15aea,0x3ecb2aae,0x3ea395c5,0x3e75c35a,0x3e22abb6,0x3d9cecf9,0xbbc90f88,0xbdb5f8da
.long 0xbe2f10a2,0xbe80f8c0,0xbea986c4,0xbed0eb2a,0xbef6e0cb,0xbf0d9281,0xbf1ebc12,0xbf2ecef7
.long 0xbf6c835e,0xbf740bdd,0xbf79c79d,0xbf7dabcc,0xbf7fb10f,0xbf7fd397,0xbf7e1324,0xbf7a7302
.long 0xbf74fa0b,0xbf6db293,0xbf64aa59,0xbf59f26a,0xbf4d9f02,0xbf3fc767,0xbf3085bb,0xbf1ff6cb
.long 0x3ec3ef15,0x3e9aa086,0x3e605c13,0x3e09cf86,0x3d48fb30,0xbd16c32c,0xbdfab273,0xbe541501
.long 0xbe94a031,0xbebe1d4a,0xbee63375,0xbf064b82,0xbf187fc0,0xbf299415,0xbf396842,0xbf47de65
.long 0xbf74fa0b,0xbf7a9c59,0xbf7e4323,0xbf7fe705,0xbf7f84ab,0xbf7d1cdd,0xbf78b47b,0xbf725470
.long 0xbf6a09a7,0xbf5fe4e9,0xbf53fac3,0xbf466354,0xbf373a23,0xbf269de3,0xbf14b039,0xbf019573
.long 0x3e94a031,0x3e5101f1,0x3dee3876,0x3ce22a7a,0xbd7b2b74,0xbe195be0,0xbe72b651,0xbea5129f
.long 0xbecf7bca,0xbef840c8,0xbf0f8784,0xbf21cbfb,0xbf32c8c9,0xbf425b89,0xbf5064af,0xbf5cc7d1
.long 0xbf7b14be,0xbf7e9bc9,0xbf7ffb11,0xbf7f2f9d,0xbf7c3b28,0xbf772417,0xbf6ff573,0xbf66becc
.long 0xbf5b941a,0xbf4e8d90,0xbf3fc767,0xbf2f61a5,0xbf1d7fd1,0xbf0a48ad,0xbeebcbbb,0xbec1071e
.long 0x3e47c5c2,0x3dd53db9,0x3c490e90,0xbda3308c,0xbe2f10a2,0xbe8586ce,0xbeb263ef,0xbeddbe79
.long 0xbf039c3d,0xbf173c07,0xbf299415,0xbf3a7ca4,0xbf49d112,0xbf577026,0xbf633c5a,0xbf6d1c1d
.long 0xbf7ec46d,0xbf7fffb1,0xbf7eea9d,0xbf7b87b2,0xbf75dec6,0xbf6dfcf2,0xbf63f473,0xbf57dc7f
.long 0xbf49d112,0xbf39f2ac,0xbf286605,0xbf1553b7,0xbf00e7e4,0xbed6a399,0xbea986c4,0xbe75c35a
.long 0x3dc8bd36,0x3b490fc6,0xbdbc3ac3,0xbe3e853e,0xbe8e9a22,0xbebca7af,0xbee900b7,0xbf099f4e
.long 0xbf1d7fd1,0xbf2ff3e6,0xbf40d0da,0xbf4fefa8,0xbf5d2d53,0xbf686b39,0xbf718f57,0xbf788486
.long 0x3f800000,0x3f800000,0x3f800000,0x3f800000,0x3f800000,0x3f800000,0x3f800000,0x3f800000
.long 0x3f800000,0x3f800000,0x3f800000,0x3f800000,0x3f800000,0x3f800000,0x3f800000,0x3f800000
.long 0x0,0x0,0x0,0x0,0x0,0x0,0x0,0x0
.long 0x0,0x0,0x0,0x0,0x0,0x0,0x0,0x0
.long 0x3f7d3aac,0x3f7d1cdd,0x3f7cfe73,0x3f7cdf6c,0x3f7cbfc9,0x3f7c9f8a,0x3f7c7eb0,0x3f7c5d3a
.long 0x3f7c3b28,0x3f7c187a,0x3f7bf531,0x3f7bd14d,0x3f7baccd,0x3f7b87b2,0x3f7b61fc,0x3f7b3bab
.long 0x3e164083,0x3e195be0,0x3e1c76de,0x3e1f917b,0x3e22abb6,0x3e25c58c,0x3e28defc,0x3e2bf804
.long 0x3e2f10a2,0x3e3228d4,0x3e354098,0x3e3857ec,0x3e3b6ecf,0x3e3e853e,0x3e419b37,0x3e44b0b9
.long 0x3f74fa0b,0x3f748422,0x3f740bdd,0x3f73913f,0x3f731447,0x3f7294f8,0x3f721352,0x3f718f57
.long 0x3f710908,0x3f708066,0x3f6ff573,0x3f6f6830,0x3f6ed89e,0x3f6e46be,0x3f6db293,0x3f6d1c1d
.long 0x3e94a031,0x3e97a117,0x3e9aa086,0x3e9d9e78,0x3ea09ae5,0x3ea395c5,0x3ea68f12,0x3ea986c4
.long 0x3eac7cd4,0x3eaf713a,0x3eb263ef,0x3eb554ec,0x3eb8442a,0x3ebb31a0,0x3ebe1d4a,0x3ec1071e
.long 0x3f676bd8,0x3f666771,0x3f655e0b,0x3f644fac,0x3f633c5a,0x3f62241a,0x3f6106f2,0x3f5fe4e9
.long 0x3f5ebe05,0x3f5d924d,0x3f5c61c7,0x3f5b2c79,0x3f59f26a,0x3f58b3a1,0x3f577026,0x3f5627fe
.long 0x3edae880,0x3edf28a9,0x3ee363fa,0x3ee79a5d,0x3eebcbbb,0x3eeff7fb,0x3ef41f07,0x3ef840c8
.long 0x3efc5d27,0x3f003a06,0x3f0242b1,0x3f044889,0x3f064b82,0x3f084b92,0x3f0a48ad,0x3f0c42c9
.long 0x3f54db31,0x3f531849,0x3f514d3d,0x3f4f7a1f,0x3f4d9f02,0x3f4bbbf8,0x3f49d112,0x3f47de65
.long 0x3f45e403,0x3f43e200,0x3f41d870,0x3f3fc767,0x3f3daef9,0x3f3b8f3b,0x3f396842,0x3f373a23
.long 0x3f0e39da,0x3f10d3cd,0x3f13682a,0x3f15f6d9,0x3f187fc0,0x3f1b02c6,0x3f1d7fd1,0x3f1ff6cb
.long 0x3f226799,0x3f24d225,0x3f273656,0x3f299415,0x3f2beb4a,0x3f2e3bde,0x3f3085bb,0x3f32c8c9
.long 0x3f3daef9,0x3f3b0629,0x3f385216,0x3f3592e7,0x3f32c8c9,0x3f2ff3e6,0x3f2d1469,0x3f2a2a80
.long 0x3f273656,0x3f24381a,0x3f212ff9,0x3f1e1e22,0x3f1b02c6,0x3f17de12,0x3f14b039,0x3f11796b
.long 0x3f2beb4a,0x3f2ecef7,0x3f31a81d,0x3f34768f,0x3f373a23,0x3f39f2ac,0x3f3ca003,0x3f3f41fc
.long 0x3f41d870,0x3f446337,0x3f46e22a,0x3f495521,0x3f4bbbf8,0x3f4e1689,0x3f5064af,0x3f52a649
.long 0x3f226799,0x3f1ebc12,0x3f1b02c6,0x3f173c07,0x3f13682a,0x3f0f8784,0x3f0b9a6b,0x3f07a136
.long 0x3f039c3d,0x3eff17b2,0x3ef6e0cb,0x3eee9479,0x3ee63375,0x3eddbe79,0x3ed53641,0x3ecc9b8b
.long 0x3f45e403,0x3f48d8b3,0x3f4bbbf8,0x3f4e8d90,0x3f514d3d,0x3f53fac3,0x3f5695e5,0x3f591e6a
.long 0x3f5b941a,0x3f5df6be,0x3f604621,0x3f628210,0x3f64aa59,0x3f66becc,0x3f68bf3c,0x3f6aab7b
.long 0x3f039c3d,0x3efdbabb,0x3ef41f07,0x3eea6681,0x3ee0924f,0x3ed6a399,0x3ecc9b8b,0x3ec27b55
.long 0x3eb8442a,0x3eadf73c,0x3ea395c5,0x3e9920fe,0x3e8e9a22,0x3e840270,0x3e72b651,0x3e5d4b1a
.long 0x3f5b941a,0x3f5e5aa6,0x3f6106f2,0x3f6398ac,0x3f660f88,0x3f686b39,0x3f6aab7b,0x3f6cd007
.long 0x3f6ed89e,0x3f70c501,0x3f7294f8,0x3f74484b,0x3f75dec6,0x3f77583a,0x3f78b47b,0x3f79f35e
.long 0x3ec3ef15,0x3eb8442a,0x3eac7cd4,0x3ea09ae5,0x3e94a031,0x3e888e93,0x3e78cfcc,0x3e605c13
.long 0x3e47c5c2,0x3e2f10a2,0x3e164083,0x3dfab273,0x3dc8bd36,0x3d96a905,0x3d48fb30,0x3cc90ab0
.long 0x3f6c835e,0x3f6ed89e,0x3f710908,0x3f731447,0x3f74fa0b,0x3f76ba07,0x3f7853f8,0x3f79c79d
.long 0x3f7b14be,0x3f7c3b28,0x3f7d3aac,0x3f7e1324,0x3f7ec46d,0x3f7f4e6d,0x3f7fb10f,0x3f7fec43
.long 0x3e78cfcc,0x3e5d4b1a,0x3e419b37,0x3e25c58c,0x3e09cf86,0x3ddb7d37,0x3da3308c,0x3d55880e
.long 0x3cc90ab0,0xbb490fc6,0xbcfb49ba,0xbd6ea038,0xbdafb680,0xbde7fa9a,0xbe1008b7,0xbe2bf804
.long 0x3f7853f8,0x3f79f35e,0x3f7b61fc,0x3f7c9f8a,0x3f7dabcc,0x3f7e868b,0x3f7f2f9d,0x3f7fa6e3
.long 0x3f7fec43,0x3f7fffb1,0x3f7fe129,0x3f7f90b1,0x3f7f0e58,0x3f7e5a38,0x3f7d7474,0x3f7c5d3a
.long 0x3dc8bd36,0x3d8a200a,0x3d16c32c,0x3bc90f88,0xbcc90ab0,0xbd621469,0xbdafb680,0xbdee3876
.long 0xbe164083,0xbe354098,0xbe541501,0xbe72b651,0xbe888e93,0xbe97a117,0xbea68f12,0xbeb554ec
.long 0x3f7ec46d,0x3f7f6ac7,0x3f7fd397,0x3f7ffec4,0x3f7fec43,0x3f7f9c18,0x3f7f0e58,0x3f7e4323
.long 0x3f7d3aac,0x3f7bf531,0x3f7a7302,0x3f78b47b,0x3f76ba07,0x3f748422,0x3f721352,0x3f6f6830
.long 0xbd48fb30,0xbda973ba,0xbdee3876,0xbe195be0,0xbe3b6ecf,0xbe5d4b1a,0xbe7ee6e1,0xbe901c2c
.long 0xbea09ae5,0xbeb0eacb,0xbec1071e,0xbed0eb2a,0xbee0924f,0xbeeff7fb,0xbeff17b2,0xbf06f686
.long 0x3f7fb10f,0x3f7f1f49,0x3f7e4323,0x3f7d1cdd,0x3f7baccd,0x3f79f35e,0x3f77f110,0x3f75a67b
.long 0x3f731447,0x3f703b37,0x3f6d1c1d,0x3f69b7e4,0x3f660f88,0x3f62241a,0x3f5df6be,0x3f5988ad
.long 0xbe47c5c2,0xbe6c9a7f,0xbe888e93,0xbe9aa086,0xbeac7cd4,0xbebe1d4a,0xbecf7bca,0xbee0924f
.long 0xbef15aea,0xbf00e7e4,0xbf08f59b,0xbf10d3cd,0xbf187fc0,0xbf1ff6cb,0xbf273656,0xbf2e3bde
.long 0x3f7b14be,0x3f791298,0x3f76ba07,0x3f740bdd,0x3f710908,0x3f6db293,0x3f6a09a7,0x3f660f88
.long 0x3f61c598,0x3f5d2d53,0x3f584853,0x3f531849,0x3f4d9f02,0x3f47de65,0x3f41d870,0x3f3b8f3b
.long 0xbeac7cd4,0xbebf926f,0xbed25a09,0xbee4cbfe,0xbef6e0cb,0xbf044889,0xbf0cead0,0xbf1553b7
.long 0xbf1d7fd1,0xbf256bcb,0xbf2d1469,0xbf34768f,0xbf3b8f3b,0xbf425b89,0xbf48d8b3,0xbf4f0417
.long 0x3f710908,0x3f6d67a1,0x3f696591,0x3f650479,0x3f604621,0x3f5b2c79,0x3f55b993,0x3f4fefa8
.long 0x3f49d112,0x3f436051,0x3f3ca003,0x3f3592e7,0x3f2e3bde,0x3f269de3,0x3f1ebc12,0x3f16999f
.long 0xbef15aea,0xbf0242b1,0xbf0b9a6b,0xbf14b039,0xbf1d7fd1,0xbf26050a,0xbf2e3bde,0xbf36206c
.long 0xbf3daef9,0xbf44e3f5,0xbf4bbbf8,0xbf5233c6,0xbf584853,0xbf5df6be,0xbf633c5a,0xbf6816a8
.long 0x3f61c598,0x3f5c61c7,0x3f5695e5,0x3f5064af,0x3f49d112,0x3f42de29,0x3f3b8f3b,0x3f33e7bc
.long 0x3f2beb4a,0x3f239da9,0x3f1b02c6,0x3f121eb0,0x3f08f59b,0x3eff17b2,0x3eebcbbb,0x3ed8106b
.long 0xbf187fc0,0xbf21cbfb,0xbf2ac082,0xbf33587a,0xbf3b8f3b,0xbf436051,0xbf4ac77f,0xbf51c0c2
.long 0xbf584853,0xbf5e5aa6,0xbf63f473,0xbf6912ae,0xbf6db293,0xbf71d19f,0xbf756d97,0xbf788486
.long 0x3f4d9f02,0x3f466354,0x3f3ebc1b,0x3f36ad7f,0x3f2e3bde,0x3f256bcb,0x3f1c420c,0x3f12c39a
.long 0x3f08f59b,0x3efdbabb,0x3ee900b7,0x3ed3c867,0x3ebe1d4a,0x3ea80b1f,0x3e919ddd,0x3e75c35a
.long 0xbf3504f3,0xbf3daef9,0xbf45e403,0xbf4d9f02,0xbf54db31,0xbf5b941a,0xbf61c598,0xbf676bd8
.long 0xbf6c835e,0xbf710908,0xbf74fa0b,0xbf7853f8,0xbf7b14be,0xbf7d3aac,0xbf7ec46d,0xbf7fb10f
.long 0x3f3504f3,0x3f2beb4a,0x3f226799,0x3f187fc0,0x3f0e39da,0x3f039c3d,0x3ef15aea,0x3edae880
.long 0x3ec3ef15,0x3eac7cd4,0x3e94a031,0x3e78cfcc,0x3e47c5c2,0x3e164083,0x3dc8bd36,0x3d48fb30
.long 0xbf4d9f02,0xbf554aa4,0xbf5c61c7,0xbf62df7b,0xbf68bf3c,0xbf6dfcf2,0xbf7294f8,0xbf76841b
.long 0xbf79c79d,0xbf7c5d3a,0xbf7e4323,0xbf7f7808,0xbf7ffb11,0xbf7fcbe2,0xbf7eea9d,0xbf7d57de
.long 0x3f187fc0,0x3f0d9281,0x3f0242b1,0x3eed3063,0x3ed53641,0x3ebca7af,0x3ea395c5,0x3e8a11f7
.long 0x3e605c13,0x3e2bf804,0x3dee3876,0x3d83db0a,0x3c490e90,0xbd2351cb,0xbdbc3ac3,0xbe1324ca
.long 0xbf61c598,0xbf6816a8,0xbf6db293,0xbf7294f8,0xbf76ba07,0xbf7a1e84,0xbf7cbfc9,0xbf7e9bc9
.long 0xbf7fb10f,0xbf7ffec4,0xbf7f84ab,0xbf7e4323,0xbf7c3b28,0xbf796e4e,0xbf75dec6,0xbf718f57
.long 0x3ef15aea,0x3ed8106b,0x3ebe1d4a,0x3ea395c5,0x3e888e93,0x3e5a3997,0x3e22abb6,0x3dd53db9
.long 0x3d48fb30,0xbbc90f88,0xbd7b2b74,0xbdee3876,0xbe2f10a2,0xbe667c66,0xbe8e9a22,0xbea986c4
.long 0xbf710908,0xbf75a67b,0xbf796e4e,0xbf7c5d3a,0xbf7e70b0,0xbf7fa6e3,0xbf7ffec4,0xbf7f7808
.long 0xbf7e1324,0xbf7bd14d,0xbf78b47b,0xbf74bf62,0xbf6ff573,0xbf6a5ad9,0xbf63f473,0xbf5cc7d1
.long 0x3eac7cd4,0x3e901c2c,0x3e667c66,0x3e2bf804,0x3de1bc2e,0x3d55880e,0xbbc90f88,0xbd83db0a
.long 0xbdfab273,0xbe3857ec,0xbe72b651,0xbe9620d2,0xbeb263ef,0xbece0bea,0xbee900b7,0xbf019573
.long 0xbf7b14be,0xbf7dabcc,0xbf7f4e6d,0xbf7ffb11,0xbf7fb10f,0xbf7e70b0,0xbf7c3b28,0xbf791298
.long 0xbf74fa0b,0xbf6ff573,0xbf6a09a7,0xbf633c5a,0xbf5b941a,0xbf531849,0xbf49d112,0xbf3fc767
.long 0x3e47c5c2,0x3e09cf86,0x3d96a905,0x3c490e90,0xbd48fb30,0xbde1bc2e,0xbe2f10a2,0xbe6c9a7f
.long 0xbe94a031,0xbeb263ef,0xbecf7bca,0xbeebcbbb,0xbf039c3d,0xbf10d3cd,0xbf1d7fd1,0xbf299415
.long 0xbf7fb10f,0xbf7ff84a,0xbf7f2f9d,0xbf7d57de,0xbf7a7302,0xbf76841b,0xbf718f57,0xbf6b99fb
.long 0xbf64aa59,0xbf5cc7d1,0xbf53fac3,0xbf4a4c87,0xbf3fc767,0xbf34768f,0xbf286605,0xbf1ba299
.long 0x3d48fb30,0xbc7b514b,0xbda3308c,0xbe1324ca,0xbe541501,0xbe8a11f7,0xbea986c4,0xbec8477c
.long 0xbee63375,0xbf019573,0xbf0f8784,0xbf1ce11f,0xbf299415,0xbf3592e7,0xbf40d0da,0xbf4b41fa
.long 0xbf7ec46d,0xbf7c7eb0,0xbf791298,0xbf748422,0xbf6ed89e,0xbf6816a8,0xbf604621,0xbf577026
.long 0xbf4d9f02,0xbf42de29,0xbf373a23,0xbf2ac082,0xbf1d7fd1,0xbf0f8784,0xbf00e7e4,0xbee363fa
.long 0xbdc8bd36,0xbe28defc,0xbe6c9a7f,0xbe97a117,0xbeb8442a,0xbed8106b,0xbef6e0cb,0xbf0a48ad
.long 0xbf187fc0,0xbf26050a,0xbf32c8c9,0xbf3ebc1b,0xbf49d112,0xbf53fac3,0xbf5d2d53,0xbf655e0b
.long 0xbf7853f8,0xbf73530e,0xbf6d1c1d,0xbf65b710,0xbf5d2d53,0xbf5389c7,0xbf48d8b3,0xbf3d27b8
.long 0xbf3085bb,0xbf2302d3,0xbf14b039,0xbf05a02c,0xbeebcbbb,0xbecb2aae,0xbea986c4,0xbe870ada
.long 0xbe78cfcc,0xbe9f1cdf,0xbec1071e,0xbee1fb6a,0xbf00e7e4,0xbf102dd5,0xbf1ebc12,0xbf2c800f
.long 0xbf396842,0xbf456439,0xbf5064af,0xbf5a5ba0,0xbf633c5a,0xbf6afb8c,0xbf718f57,0xbf76ef5b
.long 0xbf6c835e,0xbf64aa59,0xbf5b941a,0xbf514d3d,0xbf45e403,0xbf396842,0xbf2beb4a,0xbf1d7fd1
.long 0xbf0e39da,0xbefc5d27,0xbedae880,0xbeb8442a,0xbe94a031,0xbe605c13,0xbe164083,0xbd96a905
.long 0xbec3ef15,0xbee63375,0xbf039c3d,0xbf13682a,0xbf226799,0xbf3085bb,0xbf3daef9,0xbf49d112
.long 0xbf54db31,0xbf5ebe05,0xbf676bd8,0xbf6ed89e,0xbf74fa0b,0xbf79c79d,0xbf7d3aac,0xbf7f4e6d
.long 0xbf5b941a,0xbf50d937,0xbf44e3f5,0xbf37c655,0xbf299415,0xbf1a6293,0xbf0a48ad,0xbef2bd43
.long 0xbecf7bca,0xbeab0201,0xbe8586ce,0xbe3e853e,0xbde1bc2e,0xbd0a342f,0x3d2fe007,0x3df475c0
.long 0xbf039c3d,0xbf140c5f,0xbf239da9,0xbf3238aa,0xbf3fc767,0xbf4c3578,0xbf577026,0xbf61668a
.long 0xbf6a09a7,0xbf714c7a,0xbf772417,0xbf7b87b2,0xbf7e70b0,0xbf7fdaaf,0xbf7fc38f,0xbf7e2b72
.long 0xbf45e403,0xbf385216,0xbf299415,0xbf19c200,0xbf08f59b,0xbeee9479,0xbec9b953,0xbea395c5
.long 0xbe78cfcc,0xbe28defc,0xbdafb680,0xbbc90f88,0x3d96a905,0x3e1c76de,0x3e6c9a7f,0x3e9d9e78
.long 0xbf226799,0xbf31a81d,0xbf3fc767,0xbf4cae79,0xbf584853,0xbf628210,0xbf6b4b0c,0xbf7294f8
.long 0xbf7853f8,0xbf7c7eb0,0xbf7f0e58,0xbf7ffec4,0xbf7f4e6d,0xbf7cfe73,0xbf791298,0xbf73913f
.long 0xbf2beb4a,0xbf1ba299,0xbf0a48ad,0xbeeff7fb,0xbec9b953,0xbea21887,0xbe72b651,0xbe1f917b
.long 0xbd96a905,0x3c16cb58,0x3dbc3ac3,0x3e3228d4,0x3e827dc0,0x3eab0201,0x3ed25a09,0x3ef840c8
.long 0xbf3daef9,0xbf4b41fa,0xbf577026,0xbf62241a,0xbf6b4b0c,0xbf72d4eb,0xbf78b47b,0xbf7cdf6c
.long 0xbf7f4e6d,0xbf7ffd39,0xbf7eea9d,0xbf7c187a,0xbf778bc5,0xbf714c7a,0xbf696591,0xbf5fe4e9
.long 0xbf0e39da,0xbef6e0cb,0xbecf7bca,0xbea68f12,0xbe78cfcc,0xbe22abb6,0xbd96a905,0x3c490e90
.long 0x3dc8bd36,0x3e3b6ecf,0x3e888e93,0x3eb263ef,0x3edae880,0x3f00e7e4,0x3f13682a,0x3f24d225
.long 0xbf54db31,0xbf604621,0xbf6a09a7,0xbf721352,0xbf7853f8,0xbf7cbfc9,0xbf7f4e6d,0xbf7ffb11
.long 0xbf7ec46d,0xbf7baccd,0xbf76ba07,0xbf6ff573,0xbf676bd8,0xbf5d2d53,0xbf514d3d,0xbf43e200
.long 0xbedae880,0xbeb0eacb,0xbe8586ce,0xbe3228d4,0xbdafb680,0x3b490fc6,0x3dbc3ac3,0x3e3857ec
.long 0x3e888e93,0x3eb3dca5,0x3eddbe79,0x3f02ef9f,0x3f15f6d9,0x3f27ce61,0x3f385216,0x3f476085
.long 0xbf676bd8,0xbf703b37,0xbf772417,0xbf7c187a,0xbf7f0e58,0xbf7fffb1,0xbf7eea9d,0xbf7bd14d
.long 0xbf76ba07,0xbf6faf1b,0xbf66becc,0xbf5bfb34,0xbf4f7a1f,0xbf4154e1,0xbf31a81d,0xbf209393
.long 0xbe94a031,0xbe4dee60,0xbde1bc2e,0xbc96c9b6,0x3d96a905,0x3e28defc,0x3e827dc0,0x3eaf713a
.long 0x3edae880,0x3f0242b1,0x3f15f6d9,0x3f286605,0x3f396842,0x3f48d8b3,0x3f5695e5,0x3f628210
.long 0xbf74fa0b,0xbf7ac516,0xbf7e70b0,0xbf7ff4e6,0xbf7f4e6d,0xbf7c7eb0,0xbf778bc5,0xbf708066
.long 0xbf676bd8,0xbf5c61c7,0xbf4f7a1f,0xbf40d0da,0xbf3085bb,0xbf1ebc12,0xbf0b9a6b,0xbeee9479
.long 0xbe164083,0xbd55880e,0x3d2fe007,0x3e0cec4a,0x3e6c9a7f,0x3ea5129f,0x3ed25a09,0x3efdbabb
.long 0x3f13682a,0x3f269de3,0x3f385216,0x3f485bca,0x3f5695e5,0x3f62df7b,0x3f6d1c1d,0x3f75341d
.long 0xbf7d3aac,0xbf7fa6e3,0xbf7fc38f,0xbf7d906e,0xbf791298,0xbf725470,0xbf696591,0xbf5e5aa6
.long 0xbf514d3d,0xbf425b89,0xbf31a81d,0xbf1f599f,0xbf0b9a6b,0xbeed3063,0xbec1071e,0xbe931f35
.long 0x3f803f80,0x3f803f80,0x3f803f80,0x3f803f80,0x3f973f80,0x3fb23fa7,0x3fb23fb5,0x3f973fa7
.long 0x3fa73f80,0x3fa73fb5,0x3f0b3f80,0xbf0b2500,0x3fb23f80,0x3f493fa7,0xbf492500,0xbfb2bfa7
.long 0x3fb53f80,0x25003f80,0xbfb5bf80,0xa5c0bf80,0x3fb23f80,0xbf493f0b,0xbf49bfb5,0x3fb23f0b
.long 0x3fa73f80,0xbfa72500,0x3f0bbf80,0x3f0b3fb5,0x3f973f80,0xbfb2bf0b,0x3fb2a5c0,0xbf973f0b
.long 0x3f803f80,0xbf80bf80,0x3f803f80,0xbf80bf80,0x3f493f80,0xbe8dbfa7,0xbe8d3fb5,0x3f49bfa7
.long 0x3f0b3f80,0x3f0bbfb5,0xbfa73f80,0x3fa7a708,0x3e8d3f80,0x3f97bfa7,0xbf9726f0,0xbe8d3fa7
.long 0x25003f80,0x3fb5bf80,0xa708bf80,0xbfb53f80,0xbe8d3f80,0x3f97bf0b,0x3f97bfb5,0xbe8dbf0b
.long 0xbf0b3f80,0x3f0ba5c0,0x3fa7bf80,0x3fa7bfb5,0xbf493f80,0xbe8d3f0b,0x3e8da708,0x3f49bf0b
.long 0x3f803f80,0x3f803f80,0x3f803f80,0x3f803f80,0x3f493f80,0x3e8d3f0b,0xbe8d2500,0xbf49bf0b
.long 0xbfa7bf80,0xbfa7bfb5,0xbf0bbf80,0x3f0ba5c0,0xbe8dbf80,0x3f973f0b,0x3f973fb5,0xbe8d3f0b
.long 0x3fb53f80,0x26f03f80,0xbfb5bf80,0xa708bf80,0xbe8d3f80,0xbf97bfa7,0x3f97a708,0x3e8d3fa7
.long 0xbfa7bf80,0x3fa7a708,0xbf0b3f80,0xbf0bbfb5,0x3f49bf80,0xbe8d3fa7,0xbe8dbfb5,0x3f493fa7
.long 0x3f803f80,0xbf80bf80,0x3f803f80,0xbf80bf80,0xbf973f80,0x3fb2bf0b,0xbfb22728,0x3f973f0b
.long 0xbf0bbf80,0xbf0b3fb5,0x3fa7bf80,0xbfa72748,0x3fb2bf80,0xbf49bf0b,0xbf493fb5,0x3fb2bf0b
.long 0x27283f80,0x3fb5bf80,0x2718bf80,0xbfb53f80,0xbfb23f80,0xbf493fa7,0x3f49a758,0x3fb2bfa7
.long 0x3f0bbf80,0xbf0b2748,0xbfa73f80,0xbfa73fb5,0x3f97bf80,0x3fb2bfa7,0x3fb2bfb5,0x3f97bfa7
.long 0x3f803f80,0x3f803f80,0x3f803f80,0x3f803f80,0xbf97bf80,0xbfb2bfa7,0xbfb2bfb5,0xbf97bfa7
.long 0x3fa73f80,0x3fa73fb5,0x3f0b3f80,0xbf0b26f0,0xbfb2bf80,0xbf49bfa7,0x3f49a708,0x3fb23fa7
.long 0x3fb53f80,0x27183f80,0xbfb5bf80,0xa728bf80,0xbfb2bf80,0x3f49bf0b,0x3f493fb5,0xbfb2bf0b
.long 0x3fa73f80,0xbfa72728,0x3f0bbf80,0x3f0b3fb5,0xbf97bf80,0x3fb23f0b,0xbfb22748,0x3f97bf0b
.long 0x3f803f80,0xbf80bf80,0x3f803f80,0xbf80bf80,0xbf49bf80,0x3e8d3fa7,0x3e8dbfb5,0xbf493fa7
.long 0x3f0b3f80,0x3f0bbfb5,0xbfa73f80,0x3fa7a81c,0xbe8dbf80,0xbf973fa7,0x3f9726d0,0x3e8dbfa7
.long 0xa7ec3f80,0x3fb5bf80,0x2690bf80,0xbfb53f80,0x3e8dbf80,0xbf973f0b,0xbf973fb5,0x3e8d3f0b
.long 0xbf0b3f80,0x3f0b2690,0x3fa7bf80,0x3fa7bfb5,0x3f49bf80,0x3e8dbf0b,0xbe8d27a4,0xbf493f0b
.long 0x3f803f80,0x3f803f80,0x3f803f80,0x3f803f80,0xbf49bf80,0xbe8dbf0b,0x3e8da5c0,0x3f493f0b
.long 0xbfa7bf80,0xbfa7bfb5,0xbf0bbf80,0x3f0ba708,0x3e8d3f80,0xbf97bf0b,0xbf97bfb5,0x3e8dbf0b
.long 0x3fb53f80,0x27283f80,0xbfb5bf80,0xa738bf80,0x3e8dbf80,0x3f973fa7,0xbf972748,0xbe8dbfa7
.long 0xbfa7bf80,0x3fa72718,0xbf0b3f80,0xbf0bbfb5,0xbf493f80,0x3e8dbfa7,0x3e8d3fb5,0xbf49bfa7
.long 0x3f803f80,0xbf80bf80,0x3f803f80,0xbf80bf80,0x3f97bf80,0xbfb23f0b,0x3fb22690,0xbf97bf0b
.long 0xbf0bbf80,0xbf0b3fb5,0x3fa7bf80,0xbfa727a4,0xbfb23f80,0x3f493f0b,0x3f49bfb5,0xbfb23f0b
.long 0x27a43f80,0x3fb5bf80,0xa836bf80,0xbfb53f80,0x3fb2bf80,0x3f49bfa7,0xbf4927bc,0xbfb23fa7
.long 0x3f0bbf80,0xbf0ba887,0xbfa73f80,0xbfa73fb5,0xbf973f80,0xbfb23fa7,0xbfb23fb5,0xbf973fa7
.long 0xbf80bf80,0xbf80bf80,0xbf80bf80,0xbf80bf80,0xbf49bf80,0xbe8dbf0b,0x3e8da500,0x3f493f0b
.long 0xbf0bbf80,0x3f0ba500,0x3fa73f80,0x3fa73fb5,0xbe8dbf80,0x3f973f0b,0x3f973fb5,0xbe8d3f0b
.long 0xa500bf80,0x3fb53f80,0x25803f80,0xbfb5bf80,0x3e8dbf80,0x3f973fa7,0xbf972580,0xbe8dbfa7
.long 0x3f0bbf80,0x3f0b3fb5,0xbfa7bf80,0x3fa7a5c0,0x3f49bf80,0xbe8d3fa7,0xbe8dbfb5,0x3f493fa7
.long 0x3f80bf80,0xbf803f80,0x3f80bf80,0xbf803f80,0x3f97bf80,0xbfb23f0b,0x3fb2a5c0,0xbf97bf0b
.long 0x3fa7bf80,0xbfa72580,0x3f0b3f80,0x3f0bbfb5,0x3fb2bf80,0xbf49bf0b,0xbf493fb5,0x3fb2bf0b
.long 0x3fb5bf80,0xa5c0bf80,0xbfb53f80,0xa5c03f80,0x3fb2bf80,0x3f49bfa7,0xbf49a660,0xbfb23fa7
.long 0x3fa7bf80,0x3fa7bfb5,0x3f0bbf80,0xbf0ba5c0,0x3f97bf80,0x3fb2bfa7,0x3fb2bfb5,0x3f97bfa7
.long 0xbf80bf80,0xbf80bf80,0xbf80bf80,0xbf80bf80,0x3f973f80,0x3fb23fa7,0x3fb23fb5,0x3f973fa7
.long 0x3f0b3f80,0xbf0b2580,0xbfa7bf80,0xbfa7bfb5,0xbfb2bf80,0xbf49bfa7,0x3f49a5c0,0x3fb23fa7
.long 0xa5c0bf80,0x3fb53f80,0xa6603f80,0xbfb5bf80,0x3fb23f80,0xbf493f0b,0xbf49bfb5,0x3fb23f0b
.long 0xbf0b3f80,0xbf0bbfb5,0x3fa73f80,0xbfa7a5c0,0xbf97bf80,0x3fb23f0b,0xbfb2a5c0,0x3f97bf0b
.long 0x3f80bf80,0xbf803f80,0x3f80bf80,0xbf803f80,0x3f493f80,0xbe8dbfa7,0xbe8d3fb5,0x3f49bfa7
.long 0xbfa73f80,0x3fa72500,0xbf0bbf80,0xbf0b3fb5,0xbe8dbf80,0xbf973fa7,0x3f97a500,0x3e8dbfa7
.long 0x3fb5bf80,0xa7bcbf80,0xbfb53f80,0x28423f80,0xbe8d3f80,0x3f97bf0b,0x3f97bfb5,0xbe8dbf0b
.long 0xbfa73f80,0xbfa73fb5,0xbf0b3f80,0x3f0ba7d4,0x3f49bf80,0x3e8dbf0b,0xbe8d2660,0xbf493f0b
.long 0xbf80bf80,0xbf80bf80,0xbf80bf80,0xbf80bf80,0x3f493f80,0x3e8d3f0b,0xbe8d2580,0xbf49bf0b
.long 0xbf0bbf80,0x3f0ba5c0,0x3fa73f80,0x3fa73fb5,0x3e8d3f80,0xbf97bf0b,0xbf97bfb5,0x3e8dbf0b
.long 0x2620bf80,0x3fb53f80,0xa5c03f80,0xbfb5bf80,0xbe8d3f80,0xbf97bfa7,0x3f972500,0x3e8d3fa7
.long 0x3f0bbf80,0x3f0b3fb5,0xbfa7bf80,0x3fa7a7bc,0xbf493f80,0x3e8dbfa7,0x3e8d3fb5,0xbf49bfa7
.long 0x3f80bf80,0xbf803f80,0x3f80bf80,0xbf803f80,0xbf973f80,0x3fb2bf0b,0xbfb22660,0x3f973f0b
.long 0x3fa7bf80,0xbfa72660,0x3f0b3f80,0x3f0bbfb5,0xbfb23f80,0x3f493f0b,0x3f49bfb5,0xbfb23f0b
.long 0x3fb5bf80,0xa7e4bf80,0xbfb53f80,0x26f03f80,0xbfb23f80,0xbf493fa7,0x3f49a7ec,0x3fb2bfa7
.long 0x3fa7bf80,0x3fa7bfb5,0x3f0bbf80,0xbf0b285a,0xbf973f80,0xbfb23fa7,0xbfb23fb5,0xbf973fa7
.long 0xbf80bf80,0xbf80bf80,0xbf80bf80,0xbf80bf80,0xbf97bf80,0xbfb2bfa7,0xbfb2bfb5,0xbf97bfa7
.long 0x3f0b3f80,0xbf0ba660,0xbfa7bf80,0xbfa7bfb5,0x3fb23f80,0x3f493fa7,0xbf49a5c0,0xbfb2bfa7
.long 0x2500bf80,0x3fb53f80,0x3f80,0xbfb5bf80,0xbfb2bf80,0x3f49bf0b,0x3f493fb5,0xbfb2bf0b
.long 0xbf0b3f80,0xbf0bbfb5,0x3fa73f80,0xbfa72842,0x3f973f80,0xbfb2bf0b,0x3fb2a7d4,0xbf973f0b
.long 0x3f80bf80,0xbf803f80,0x3f80bf80,0xbf803f80,0xbf49bf80,0x3e8d3fa7,0x3e8dbfb5,0xbf493fa7
.long 0xbfa73f80,0x3fa72778,0xbf0bbf80,0xbf0b3fb5,0x3e8d3f80,0x3f97bfa7,0xbf972718,0xbe8d3fa7
.long 0x3fb5bf80,0xa802bf80,0xbfb53f80,0x28663f80,0x3e8dbf80,0xbf973f0b,0xbf973fb5,0x3e8d3f0b
.long 0xbfa73f80,0xbfa73fb5,0xbf0b3f80,0x3f0ba8a5,0xbf493f80,0xbe8d3f0b,0x3e8d26f0,0x3f49bf0b
.long 0xbf803f80,0xbf803f80,0xbf803f80,0xbf803f80,0xbf973f80,0xbfb23fa7,0xbfb23fb5,0xbf973fa7
.long 0xbfa73f80,0xbfa73fb5,0xbf0b3f80,0x3f0b2728,0xbfb23f80,0xbf493fa7,0x3f492718,0x3fb2bfa7
.long 0xbfb53f80,0xa7083f80,0x3fb5bf80,0x2748bf80,0xbfb23f80,0x3f493f0b,0x3f49bfb5,0xbfb23f0b
.long 0xbfa73f80,0x3fa726f0,0xbf0bbf80,0xbf0b3fb5,0xbf973f80,0x3fb2bf0b,0xbfb2a728,0x3f973f0b
.long 0xbf803f80,0x3f80bf80,0xbf803f80,0x3f80bf80,0xbf493f80,0x3e8dbfa7,0x3e8d3fb5,0xbf49bfa7
.long 0xbf0b3f80,0xbf0bbfb5,0x3fa73f80,0xbfa7a758,0xbe8d3f80,0xbf97bfa7,0x3f972728,0x3e8d3fa7
.long 0xa5c03f80,0xbfb5bf80,0x2748bf80,0x3fb53f80,0x3e8d3f80,0xbf97bf0b,0xbf97bfb5,0x3e8dbf0b
.long 0x3f0b3f80,0xbf0ba708,0xbfa7bf80,0xbfa7bfb5,0x3f493f80,0x3e8d3f0b,0xbe8da738,0xbf49bf0b
.long 0xbf803f80,0xbf803f80,0xbf803f80,0xbf803f80,0xbf493f80,0xbe8d3f0b,0x3e8d2778,0x3f49bf0b
.long 0x3fa7bf80,0x3fa7bfb5,0x3f0bbf80,0xbf0b2690,0x3e8dbf80,0xbf973f0b,0xbf973fb5,0x3e8d3f0b
.long 0xbfb53f80,0xa81c3f80,0x3fb5bf80,0x27a4bf80,0x3e8d3f80,0x3f97bfa7,0xbf972690,0xbe8d3fa7
.long 0x3fa7bf80,0xbfa726d0,0x3f0b3f80,0x3f0bbfb5,0xbf49bf80,0x3e8d3fa7,0x3e8dbfb5,0xbf493fa7
.long 0xbf803f80,0x3f80bf80,0xbf803f80,0x3f80bf80,0x3f973f80,0xbfb2bf0b,0x3fb227a4,0xbf973f0b
.long 0x3f0bbf80,0x3f0b3fb5,0xbfa7bf80,0x3fa727bc,0xbfb2bf80,0x3f49bf0b,0x3f493fb5,0xbfb2bf0b
.long 0x26903f80,0xbfb5bf80,0xa887bf80,0x3fb53f80,0x3fb23f80,0x3f493fa7,0xbf49a836,0xbfb2bfa7
.long 0xbf0bbf80,0x3f0b27a4,0x3fa73f80,0x3fa73fb5,0xbf97bf80,0xbfb2bfa7,0xbfb2bfb5,0xbf97bfa7
.long 0xbf803f80,0xbf803f80,0xbf803f80,0xbf803f80,0x3f97bf80,0x3fb2bfa7,0x3fb2bfb5,0x3f97bfa7
.long 0xbfa73f80,0xbfa73fb5,0xbf0b3f80,0x3f0b288d,0x3fb2bf80,0x3f49bfa7,0xbf49a5c0,0xbfb23fa7
.long 0xbfb53f80,0xa5c03f80,0x3fb5bf80,0x2893bf80,0x3fb2bf80,0xbf49bf0b,0xbf493fb5,0x3fb2bf0b
.long 0xbfa73f80,0x3fa7a7a4,0xbf0bbf80,0xbf0b3fb5,0x3f97bf80,0xbfb23f0b,0x3fb2a78c,0xbf97bf0b
.long 0xbf803f80,0x3f80bf80,0xbf803f80,0x3f80bf80,0x3f49bf80,0xbe8d3fa7,0xbe8dbfb5,0x3f493fa7
.long 0xbf0b3f80,0xbf0bbfb5,0x3fa73f80,0xbfa7a8cb,0x3e8dbf80,0x3f973fa7,0xbf97a85a,0xbe8dbfa7
.long 0x281c3f80,0xbfb5bf80,0xa728bf80,0x3fb53f80,0xbe8dbf80,0x3f973f0b,0x3f973fb5,0xbe8d3f0b
.long 0x3f0b3f80,0xbf0ba85a,0xbfa7bf80,0xbfa7bfb5,0xbf49bf80,0xbe8dbf0b,0x3e8d280e,0x3f493f0b
.long 0xbf803f80,0xbf803f80,0xbf803f80,0xbf803f80,0x3f49bf80,0x3e8dbf0b,0xbe8da84e,0xbf493f0b
.long 0x3fa7bf80,0x3fa7bfb5,0x3f0bbf80,0xbf0ba85a,0xbe8d3f80,0x3f97bf0b,0x3f97bfb5,0xbe8dbf0b
.long 0xbfb53f80,0xa85a3f80,0x3fb5bf80,0x280ebf80,0xbe8dbf80,0xbf973fa7,0x3f97a728,0x3e8dbfa7
.long 0x3fa7bf80,0xbfa7289f,0x3f0b3f80,0x3f0bbfb5,0x3f493f80,0xbe8dbfa7,0xbe8d3fb5,0x3f49bfa7
.long 0xbf803f80,0x3f80bf80,0xbf803f80,0x3f80bf80,0xbf97bf80,0x3fb23f0b,0xbfb2a8d7,0x3f97bf0b
.long 0x3f0bbf80,0x3f0b3fb5,0xbfa7bf80,0x3fa728b2,0x3fb23f80,0xbf493f0b,0xbf49bfb5,0x3fb23f0b
.long 0x28933f80,0xbfb5bf80,0x2836bf80,0x3fb53f80,0xbfb2bf80,0xbf49bfa7,0x3f492836,0x3fb23fa7
.long 0xbf0bbf80,0x3f0ba8b9,0x3fa73f80,0x3fa73fb5,0x3f973f80,0x3fb23fa7,0x3fb23fb5,0x3f973fa7
.long 0x3f80bf80,0x3f80bf80,0x3f80bf80,0x3f80bf80,0x3f49bf80,0x3e8dbf0b,0xbe8d2620,0xbf493f0b
.long 0x3f0bbf80,0xbf0ba5c0,0xbfa73f80,0xbfa73fb5,0x3e8dbf80,0xbf973f0b,0xbf973fb5,0x3e8d3f0b
.long 0x2580bf80,0xbfb53f80,0x25003f80,0x3fb5bf80,0xbe8dbf80,0xbf973fa7,0x3f97a5c0,0x3e8dbfa7
.long 0xbf0bbf80,0xbf0b3fb5,0x3fa7bf80,0xbfa7a500,0xbf49bf80,0x3e8d3fa7,0x3e8dbfb5,0xbf493fa7
.long 0xbf80bf80,0x3f803f80,0xbf80bf80,0x3f803f80,0xbf97bf80,0x3fb23f0b,0xbfb22500,0x3f97bf0b
.long 0xbfa7bf80,0x3fa7a660,0xbf0b3f80,0xbf0bbfb5,0xbfb2bf80,0x3f49bf0b,0x3f493fb5,0xbfb2bf0b
.long 0xbfb5bf80,0xa5c0bf80,0x3fb53f80,0xa7d43f80,0xbfb2bf80,0xbf49bfa7,0x3f490000,0x3fb23fa7
.long 0xbfa7bf80,0xbfa7bfb5,0xbf0bbf80,0x3f0b2660,0xbf97bf80,0xbfb2bfa7,0xbfb2bfb5,0xbf97bfa7
.long 0x3f80bf80,0x3f80bf80,0x3f80bf80,0x3f80bf80,0xbf973f80,0xbfb23fa7,0xbfb23fb5,0xbf973fa7
.long 0xbf0b3f80,0x3f0b2660,0x3fa7bf80,0x3fa7bfb5,0x3fb2bf80,0x3f49bfa7,0xbf49a7e4,0xbfb23fa7
.long 0x2660bf80,0xbfb53f80,0x27783f80,0x3fb5bf80,0xbfb23f80,0x3f493f0b,0x3f49bfb5,0xbfb23f0b
.long 0x3f0b3f80,0x3f0bbfb5,0xbfa73f80,0x3fa72718,0x3f97bf80,0xbfb23f0b,0x3fb226f0,0xbf97bf0b
.long 0xbf80bf80,0x3f803f80,0xbf80bf80,0x3f803f80,0xbf493f80,0x3e8dbfa7,0x3e8d3fb5,0xbf49bfa7
.long 0x3fa73f80,0xbfa7a7ec,0x3f0bbf80,0x3f0b3fb5,0x3e8dbf80,0x3f973fa7,0xbf97a802,0xbe8dbfa7
.long 0xbfb5bf80,0x285abf80,0x3fb53f80,0xa8a53f80,0x3e8d3f80,0xbf97bf0b,0xbf97bfb5,0x3e8dbf0b
.long 0x3fa73f80,0x3fa73fb5,0x3f0b3f80,0xbf0b26f0,0xbf49bf80,0xbe8dbf0b,0x3e8d2866,0x3f493f0b
.long 0x3f80bf80,0x3f80bf80,0x3f80bf80,0x3f80bf80,0xbf493f80,0xbe8d3f0b,0x3e8d2728,0x3f49bf0b
.long 0x3f0bbf80,0xbf0ba802,0xbfa73f80,0xbfa73fb5,0xbe8d3f80,0x3f97bf0b,0x3f97bfb5,0xbe8dbf0b
.long 0x2728bf80,0xbfb53f80,0x26f03f80,0x3fb5bf80,0x3e8d3f80,0x3f97bfa7,0xbf9726f0,0xbe8d3fa7
.long 0xbf0bbf80,0xbf0b3fb5,0x3fa7bf80,0xbfa7a8ab,0x3f493f80,0xbe8dbfa7,0xbe8d3fb5,0x3f49bfa7
.long 0xbf80bf80,0x3f803f80,0xbf80bf80,0x3f803f80,0x3f973f80,0xbfb2bf0b,0x3fb22880,0xbf973f0b
.long 0xbfa7bf80,0x3fa7278c,0xbf0b3f80,0xbf0bbfb5,0x3fb23f80,0xbf493f0b,0xbf49bfb5,0x3fb23f0b
.long 0xbfb5bf80,0x28ddbf80,0x3fb53f80,0xa8423f80,0x3fb23f80,0x3f493fa7,0xbf49a836,0xbfb2bfa7
.long 0xbfa7bf80,0xbfa7bfb5,0xbf0bbf80,0x3f0b28ea,0x3f973f80,0x3fb23fa7,0x3fb23fb5,0x3f973fa7
.long 0x3f80bf80,0x3f80bf80,0x3f80bf80,0x3f80bf80,0x3f97bf80,0x3fb2bfa7,0x3fb2bfb5,0x3f97bfa7
.long 0xbf0b3f80,0x3f0b278c,0x3fa7bf80,0x3fa7bfb5,0xbfb23f80,0xbf493fa7,0x3f4927a4,0x3fb2bfa7
.long 0xa7d4bf80,0xbfb53f80,0x28363f80,0x3fb5bf80,0x3fb2bf80,0xbf49bf0b,0xbf493fb5,0x3fb2bf0b
.long 0x3f0b3f80,0x3f0bbfb5,0xbfa73f80,0x3fa728ea,0xbf973f80,0x3fb2bf0b,0xbfb2a842,0x3f973f0b
.long 0xbf80bf80,0x3f803f80,0xbf80bf80,0x3f803f80,0x3f49bf80,0xbe8d3fa7,0xbe8dbfb5,0x3f493fa7
.long 0x3fa73f80,0xbfa7a690,0x3f0bbf80,0x3f0b3fb5,0xbe8d3f80,0xbf97bfa7,0x3f97a760,0x3e8d3fa7
.long 0xbfb5bf80,0x2927bf80,0x3fb53f80,0xa8d13f80,0xbe8dbf80,0x3f973f0b,0x3f973fb5,0xbe8d3f0b
.long 0x3fa73f80,0x3fa73fb5,0x3f0b3f80,0xbf0ba872,0x3f493f80,0x3e8d3f0b,0xbe8da8d1,0xbf49bf0b
.size L_tables, .-L_tables
.section .rodata,"a"
.p2align 6
.amdhsa_kernel concat_heads__ssm_conv_h3__spectral_fnet__prompt_kernel
  .amdhsa_next_free_vgpr 256
  .amdhsa_next_free_sgpr 102
  .amdhsa_accum_offset 256
  .amdhsa_group_segment_fixed_size 0
  .amdhsa_kernarg_size 112
  .amdhsa_user_sgpr_count 2
  .amdhsa_user_sgpr_kernarg_segment_ptr 1
  .amdhsa_system_sgpr_workgroup_id_x 1
  .amdhsa_float_denorm_mode_32 3
.end_amdhsa_kernel
```
